```python
import torch

def _softmax(x, axis=-1):
    return torch.softmax(x, dim=axis)
def _gelu(x):
    return torch.nn.functional.gelu(x, approximate="tanh")
def _silu(x):
    return torch.nn.functional.silu(x)
def _sigmoid(x):
    return torch.sigmoid(x)
def _layernorm(x, axis=-1, eps=1e-5):
    m = x.mean(dim=axis, keepdim=True)
    v = x.var(dim=axis, keepdim=True, unbiased=False)
    return (x - m) / torch.sqrt(v + eps)
def _scatter_add(tgt, idx, src, axis=0):
    return tgt.clone().index_add_(axis, idx, src)
def _segment_sum(src, seg, n):
    out = torch.zeros((n,) + src.shape[1:], dtype=src.dtype)
    return out.index_add_(0, seg, src)
def _pad(x, pw):
    flat = tuple(v for pair in reversed(pw) for v in pair)
    return torch.nn.functional.pad(x, flat)

kernel_name = 'concat_heads__gqa_block_cached__mha_block_cached__near_ridge'

def setup_inputs():

    _w = (lambda a: (lambda t: t.to(torch.bfloat16) if t.is_floating_point() else t)(torch.as_tensor(a)))
    def _A_setup():
        B, Sq, D = 8, 112, 448
        Hq, Hkv, Sk, Dh = 16, 8, 2048, 256
        assert Hq % Hkv == 0, (Hq, Hkv)
        return {
            "x": _w((lambda *s: torch.randn(*s, dtype=torch.bfloat16) * 0.8)(B, Sq, D)),
            "k_cache": _w((lambda *s: torch.randn(*s, dtype=torch.bfloat16) * 0.8)(B, Hkv, Sk, Dh)),
            "v_cache": _w((lambda *s: torch.randn(*s, dtype=torch.bfloat16) * 0.05)(B, Hkv, Sk, Dh)),
            "wq": _w((lambda *s: torch.randn(*s, dtype=torch.bfloat16) * 0.8)(D, Hq * Dh) * (D ** -0.5)),
            "wo": _w((lambda *s: torch.randn(*s, dtype=torch.bfloat16) * 0.05)(Hq * Dh, D) * ((Hq * Dh) ** -0.5)),
        }
    _A_in = _A_setup()

    def _B_setup():
        B, Sq, D = 8, 112, 448
        H, Sk, Dh = 16, 2048, 256
        return {
            "x": _w((lambda *s: torch.randn(*s, dtype=torch.bfloat16) * 0.8)(B, Sq, D)),
            "k_cache": _w((lambda *s: torch.randn(*s, dtype=torch.bfloat16) * 0.8)(B, H, Sk, Dh)),
            "v_cache": _w((lambda *s: torch.randn(*s, dtype=torch.bfloat16) * 0.05)(B, H, Sk, Dh)),
            "wq": _w((lambda *s: torch.randn(*s, dtype=torch.bfloat16) * 0.8)(D, H * Dh) * (D ** -0.5)),
            "wo": _w((lambda *s: torch.randn(*s, dtype=torch.bfloat16) * 0.05)(H * Dh, D) * ((H * Dh) ** -0.5)),
        }
    _B_in = _B_setup()

    return {
        "A_x": _A_in["x"],
        "A_k_cache": _A_in["k_cache"],
        "A_v_cache": _A_in["v_cache"],
        "A_wq": _A_in["wq"],
        "A_wo": _A_in["wo"],
        "B_x": _B_in["x"],
        "B_k_cache": _B_in["k_cache"],
        "B_v_cache": _B_in["v_cache"],
        "B_wq": _B_in["wq"],
        "B_wo": _B_in["wo"],
    }

def reference(A_x, A_k_cache, A_v_cache, A_wq, A_wo, B_x, B_k_cache, B_v_cache, B_wq, B_wo):
    def _A_ref(x, k_cache, v_cache, wq, wo):
        B, Sq, D = x.shape
        Hq, Dh = 16, 256
        Hkv = k_cache.shape[1]
        rep = Hq // Hkv
        q = (lambda x, *d: x.permute(*d))((x @ wq).reshape(B, Sq, Hq, Dh), 0, 2, 1, 3)
        k = (lambda x, n, axis: torch.repeat_interleave(x, n, dim=axis))(k_cache, rep, axis=1)
        v = (lambda x, n, axis: torch.repeat_interleave(x, n, dim=axis))(v_cache, rep, axis=1)
        scores = torch.einsum("bhqd,bhkd->bhqk", q, k) * (Dh ** -0.5)
        p = _softmax(scores, axis=-1)
        o = torch.einsum("bhqk,bhkd->bhqd", p, v)
        return (lambda x, *d: x.permute(*d))(o, 0, 2, 1, 3).reshape(B, Sq, Hq * Dh) @ wo

    def _B_ref(x, k_cache, v_cache, wq, wo):
        B, Sq, D = x.shape
        H, Dh = 16, 256
        q = (lambda x, *d: x.permute(*d))((x @ wq).reshape(B, Sq, H, Dh), 0, 2, 1, 3)
        scores = torch.einsum("bhqd,bhkd->bhqk", q, k_cache) * (Dh ** -0.5)
        p = _softmax(scores, axis=-1)
        o = torch.einsum("bhqk,bhkd->bhqd", p, v_cache)
        return (lambda x, *d: x.permute(*d))(o, 0, 2, 1, 3).reshape(B, Sq, H * Dh) @ wo

    a = _A_ref(A_x, A_k_cache, A_v_cache, A_wq, A_wo)
    b = _B_ref(B_x, B_k_cache, B_v_cache, B_wq, B_wo)
    return torch.concatenate([a, b], axis=-1)
```

```asm
; @launch grid=(256,1,1) block=(256,1,1) lds=163840
.amdgcn_target "amdgcn-amd-amdhsa--gfx950"
.text
.globl concat_heads__gqa_block_cached__mha_block_cached__near_ridge_kernel
.p2align 8
.type concat_heads__gqa_block_cached__mha_block_cached__near_ridge_kernel,@function
concat_heads__gqa_block_cached__mha_block_cached__near_ridge_kernel:
  s_getpc_b64 s[94:95]
  s_cmp_lt_u32 s2, 256
  s_cbranch_scc1 L_go
  s_endpgm
L_go:
  s_load_dwordx16 s[8:23], s[0:1], 0
  s_load_dwordx8 s[24:31], s[0:1], 64
  s_load_dwordx2 s[32:33], s[0:1], 96
  v_lshrrev_b32 v2, 6, v0
  v_and_b32 v1, 63, v0
  v_readfirstlane_b32 s34, v2
  s_and_b32 s3, s2, 7
  s_lshr_b32 s7, s2, 3
  s_and_b32 s4, s7, 1
  s_lshl_b32 s3, s3, 1
  s_or_b32 s4, s4, s3
  s_bfe_u32 s5, s7, 0x10001
  s_lshr_b32 s6, s7, 2
  s_mov_b32 s70, 0
L_top:
  v_lshrrev_b32 v3, 5, v1
  v_and_b32 v144, 31, v1
  v_lshl_add_u32 v145, v2, 3, v3
  s_lshl_b32 s62, s34, 15
  s_lshl_b32 s65, s34, 12
  s_add_u32 s65, s65, 131072
  s_cmp_lg_u32 s6, 7
  s_cselect_b32 s3, s6, 0
  s_lshl_b32 s93, s3, 7
  s_mul_i32 s68, s3, 14336
  s_lshr_b32 s7, s4, 1
  s_mul_i32 s7, s7, 1
  s_add_u32 s3, s3, s7
  s_mul_i32 s7, s3, 9363
  s_lshr_b32 s7, s7, 16
  s_mul_i32 s7, s7, 7
  s_sub_u32 s3, s3, s7
  s_lshl_b32 s35, s3, 19
  s_lshl_b32 s69, s3, 7
  v_lshrrev_b32 v146, 3, v1
  v_lshl_add_u32 v146, v2, 5, v146
  v_mul_u32_u24 v146, 896, v146
  v_and_b32 v148, 7, v1
  v_lshrrev_b32 v149, 4, v1
  v_xor_b32 v147, v148, v149
  v_lshl_add_u32 v122, v147, 4, v146
  v_xor_b32 v147, 4, v147
  v_lshl_add_u32 v123, v147, 4, v146
  v_and_b32 v147, 1, v2
  v_lshl_add_u32 v147, v147, 2, v3
  v_lshlrev_b32 v147, 1, v147
  v_xor_b32 v147, v147, v144
  v_lshlrev_b32 v150, 13, v145
  v_lshl_add_u32 v120, v147, 4, v150
  v_xor_b32 v147, 4, v147
  v_lshl_add_u32 v121, v147, 4, v150
  s_waitcnt lgkmcnt(0)
  s_cmp_eq_u32 s5, 0
  s_cselect_b64 s[8:9], s[8:9], s[18:19]
  s_cselect_b64 s[14:15], s[14:15], s[24:25]
  s_cselect_b64 s[10:11], s[10:11], s[20:21]
  s_cselect_b64 s[12:13], s[12:13], s[22:23]
  s_cselect_b64 s[16:17], s[16:17], s[26:27]
  s_mul_i32 s3, s6, 100352
  s_add_u32 s36, s8, s3
  s_addc_u32 s37, s9, 0
  s_mov_b32 s38, 100352
  s_mov_b32 s39, 0x20000
  s_lshl_b32 s3, s4, 9
  s_add_u32 s48, s14, s3
  s_addc_u32 s49, s15, 0
  s_mov_b32 s50, 3662336
  s_mov_b32 s51, 0x20000
  s_lshl_b32 s3, s5, 3
  s_add_u32 s92, s3, s6
  s_lshl_b32 s3, s92, 12
  s_add_u32 s3, s3, 33554432
  s_add_u32 s100, s32, s3
  s_addc_u32 s101, s33, 0
  s_or_b32 s3, s4, s70
  s_or_b32 s3, s3, s34
  s_cbranch_scc1 L_noclr
  v_and_b32 v147, 15, v1
  v_lshlrev_b32 v147, 2, v147
  v_mov_b32 v150, 0
  global_store_dword v147, v150, s[100:101] sc1
L_noclr:
  s_add_u32 m0, s65, 0
  s_add_u32 s66, s69, 0
  buffer_load_dwordx4 v122, s[36:39], s66 offen offset:0 lds
  s_add_u32 s67, s69, 6144
  buffer_load_dwordx4 v123, s[36:39], s67 offen offset:1024 lds
  s_add_u32 s66, s69, 12288
  buffer_load_dwordx4 v122, s[36:39], s66 offen offset:2048 lds
  s_add_u32 s67, s69, 18432
  buffer_load_dwordx4 v123, s[36:39], s67 offen offset:3072 lds
  s_add_u32 m0, s62, 0
  s_add_u32 s66, s35, 0
  buffer_load_dwordx4 v120, s[48:51], s66 offen offset:0 lds
  s_add_u32 s67, s35, 15360
  buffer_load_dwordx4 v121, s[48:51], s67 offen offset:1024 lds
  s_add_u32 s66, s35, 30720
  buffer_load_dwordx4 v120, s[48:51], s66 offen offset:2048 lds
  s_add_u32 s67, s35, 46080
  buffer_load_dwordx4 v121, s[48:51], s67 offen offset:3072 lds
  s_add_u32 m0, s62, 4096
  s_add_u32 s35, s35, 262144
  s_cmp_lg_u32 s35, 3670016
  s_cselect_b32 s35, s35, 0
  s_add_u32 s66, s35, 0
  buffer_load_dwordx4 v120, s[48:51], s66 offen offset:0 lds
  s_lshl_b32 s3, s6, 4
  s_add_u32 s3, s3, s4
  s_lshr_b32 s7, s3, 1
  s_cmp_eq_u32 s5, 0
  s_cselect_b32 s3, s7, s3
  s_mul_i32 s99, s3, 0
  s_and_b32 s99, s99, 31
  s_lshl_b32 s99, s99, 15
  s_lshl_b32 s3, s3, 20
  s_add_u32 s40, s10, s3
  s_addc_u32 s41, s11, 0
  s_mov_b32 s42, 0x100000
  s_mov_b32 s43, 0x20000
  s_add_u32 s44, s12, s3
  s_addc_u32 s45, s13, 0
  s_mov_b32 s46, 0x100000
  s_mov_b32 s47, 0x20000
  v_bfe_u32 v151, v1, 2, 2
  v_and_b32 v152, 3, v1
  v_and_b32 v153, 15, v1
  v_lshlrev_b32 v146, 15, v149
  v_lshl_add_u32 v146, v151, 9, v146
  s_add_u32 s67, s35, 15360
  buffer_load_dwordx4 v121, s[48:51], s67 offen offset:1024 lds
  v_lshl_add_u32 v146, v152, 3, v146
  v_lshrrev_b32 v147, 1, v2
  v_lshl_add_u32 v146, v147, 8, v146
  v_xor_b32 v147, v149, v2
  v_and_b32 v147, 1, v147
  v_lshl_add_u32 v154, v147, 2, v151
  s_add_u32 s66, s35, 30720
  buffer_load_dwordx4 v120, s[48:51], s66 offen offset:2048 lds
  v_xor_b32 v147, 0, v154
  v_lshl_add_u32 v116, v147, 5, v146
  v_xor_b32 v147, 1, v154
  v_lshl_add_u32 v117, v147, 5, v146
  v_xor_b32 v147, 2, v154
  v_lshl_add_u32 v118, v147, 5, v146
  s_add_u32 s67, s35, 46080
  buffer_load_dwordx4 v121, s[48:51], s67 offen offset:3072 lds
  v_xor_b32 v147, 3, v154
  v_lshl_add_u32 v119, v147, 5, v146
  v_lshlrev_b32 v146, 7, v153
  v_lshrrev_b32 v147, 1, v153
  v_xor_b32 v147, v147, v149
  v_lshl_add_u32 v124, v147, 4, v146
  s_add_u32 m0, s65, 16384
  s_add_u32 s69, s69, 128
  s_cmp_lg_u32 s69, 896
  s_cselect_b32 s69, s69, 0
  s_add_u32 s66, s69, 0
  buffer_load_dwordx4 v122, s[36:39], s66 offen offset:0 lds
  v_xor_b32 v147, 4, v147
  v_lshl_add_u32 v125, v147, 4, v146
  v_add_u32 v126, 0x10000, v124
  v_add_u32 v128, 131072, v124
  v_add_u32 v127, 0x10000, v125
  v_add_u32 v129, 131072, v125
  s_add_u32 s67, s69, 6144
  buffer_load_dwordx4 v123, s[36:39], s67 offen offset:1024 lds
  v_lshlrev_b32 v146, 13, v2
  v_lshl_add_u32 v146, v3, 9, v146
  v_or_b32 v147, 0, v3
  v_xor_b32 v147, v147, v144
  v_lshl_add_u32 v14, v147, 4, v146
  v_or_b32 v147, 2, v3
  s_add_u32 s66, s69, 12288
  buffer_load_dwordx4 v122, s[36:39], s66 offen offset:2048 lds
  v_xor_b32 v147, v147, v144
  v_lshl_add_u32 v15, v147, 4, v146
  v_or_b32 v147, 4, v3
  v_xor_b32 v147, v147, v144
  v_lshl_add_u32 v16, v147, 4, v146
  v_or_b32 v147, 6, v3
  s_add_u32 s67, s69, 18432
  buffer_load_dwordx4 v123, s[36:39], s67 offen offset:3072 lds
  v_xor_b32 v147, v147, v144
  v_lshl_add_u32 v17, v147, 4, v146
  v_or_b32 v147, 8, v3
  v_xor_b32 v147, v147, v144
  v_lshl_add_u32 v18, v147, 4, v146
  v_add_u32 v18, 4096, v18
  v_or_b32 v147, 10, v3
  v_xor_b32 v147, v147, v144
  v_lshl_add_u32 v19, v147, 4, v146
  v_add_u32 v19, 4096, v19
  v_or_b32 v147, 12, v3
  v_xor_b32 v147, v147, v144
  v_lshl_add_u32 v20, v147, 4, v146
  v_add_u32 v20, 4096, v20
  v_or_b32 v147, 14, v3
  v_xor_b32 v147, v147, v144
  v_lshl_add_u32 v21, v147, 4, v146
  v_add_u32 v21, 4096, v21
  v_lshlrev_b32 v155, 1, v149
  v_xor_b32 v155, v155, v148
  v_lshrrev_b32 v146, 3, v1
  v_lshlrev_b32 v147, 9, v146
  v_lshl_add_u32 v147, v2, 7, v147
  v_lshl_add_u32 v22, v155, 4, v147
  v_add_u32 v23, 3072, v22
  v_add_u32 v24, 6144, v22
  v_add_u32 v25, 9216, v22
  v_lshl_add_u32 v146, v2, 5, v146
  v_mul_u32_u24 v146, 896, v146
  v_lshl_add_u32 v32, v155, 4, v146
  v_xor_b32 v146, v149, v153
  v_lshlrev_b32 v150, 9, v153
  v_add_u32 v150, s62, v150
  v_xor_b32 v147, 0, v146
  v_lshl_add_u32 v4, v147, 4, v150
  v_xor_b32 v147, 4, v146
  v_lshl_add_u32 v5, v147, 4, v150
  v_xor_b32 v147, 8, v146
  v_lshl_add_u32 v6, v147, 4, v150
  v_xor_b32 v147, 12, v146
  v_lshl_add_u32 v7, v147, 4, v150
  v_lshl_add_u32 v146, v149, 2, v151
  v_bfe_u32 v156, v146, 1, 2
  v_lshlrev_b32 v146, 7, v146
  v_lshl_add_u32 v146, v152, 3, v146
  v_add_u32 v146, s62, v146
  v_add_u32 v146, 16384, v146
  v_xor_b32 v147, 0, v156
  v_lshl_add_u32 v8, v147, 5, v146
  v_xor_b32 v147, 1, v156
  v_lshl_add_u32 v9, v147, 5, v146
  v_xor_b32 v147, 2, v156
  v_lshl_add_u32 v10, v147, 5, v146
  v_xor_b32 v147, 3, v156
  v_lshl_add_u32 v11, v147, 5, v146
  v_lshlrev_b32 v48, 4, v1
  v_add_u32 v49, 0x10000, v48
  v_add_u32 v50, 0x20000, v48
  v_mov_b32 v13, v50
  v_lshrrev_b32 v146, 1, v2
  v_and_b32 v147, 1, v2
  v_lshlrev_b32 v147, 3, v147
  v_lshl_add_u32 v146, v146, 10, v147
  v_add_u32 v12, v146, v13
  s_mul_i32 s3, s4, 229376
  s_add_u32 s52, s16, s3
  s_addc_u32 s53, s17, 0
  s_mov_b32 s54, 229376
  s_mov_b32 s55, 0x20000
  s_mul_i32 s3, s92, 1605632
  s_add_u32 s56, s32, s3
  s_addc_u32 s57, s33, 0
  s_mov_b32 s58, 1605632
  s_mov_b32 s59, 0x20000
  s_mov_b32 s64, 0x3db8aa3b
  s_mov_b32 s71, 0x3f803f80
  v_mov_b32 v40, 0xff800000
  v_mov_b32 v41, 0xff800000
  v_mov_b32 v42, 0xff800000
  v_mov_b32 v43, 0xff800000
  v_mov_b32 v44, 0xff800000
  v_mov_b32 v45, 0xff800000
  v_mov_b32 v46, 0xff800000
  s_lshr_b32 s3, s2, 3
  s_mul_i32 s3, s3, 11
  v_min_u32 v146, 10, v1
  v_add_u32 v146, s3, v146
  v_lshlrev_b32 v146, 7, v146
  v_min_u32 v146, 41508, v146
  v_mov_b32 v147, s95
  v_add_co_u32 v146, vcc, s94, v146
  s_nop 1
  v_addc_co_u32 v147, vcc, 0, v147, vcc
  s_cmp_lg_u32 s34, 3
  s_cbranch_scc1 L_nopf
  global_load_dword v0, v[146:147], off
L_nopf:
  s_waitcnt vmcnt(8)
  s_barrier
  ds_read_b64_tr_b16 a[112:113], v116 offset:0
  ds_read_b64_tr_b16 a[114:115], v116 offset:2048
  ds_read_b64_tr_b16 a[116:117], v117 offset:0
  ds_read_b64_tr_b16 a[118:119], v117 offset:2048
  ds_read_b64_tr_b16 a[120:121], v118 offset:0
  ds_read_b64_tr_b16 a[122:123], v118 offset:2048
  ds_read_b64_tr_b16 a[124:125], v119 offset:0
  ds_read_b64_tr_b16 a[126:127], v119 offset:2048
  ds_read_b128 a[0:3], v128 offset:0
  ds_read_b128 a[4:7], v128 offset:2048
  ds_read_b128 a[8:11], v128 offset:4096
  ds_read_b128 a[12:15], v128 offset:6144
  ds_read_b128 a[16:19], v128 offset:8192
  ds_read_b128 a[20:23], v128 offset:10240
  ds_read_b128 a[24:27], v128 offset:12288
  s_waitcnt vmcnt(4)
  s_barrier
  ds_read_b64_tr_b16 a[128:129], v116 offset:4096
  ds_read_b64_tr_b16 a[130:131], v116 offset:6144
  ds_read_b64_tr_b16 a[132:133], v117 offset:4096
  ds_read_b64_tr_b16 a[134:135], v117 offset:6144
  ds_read_b64_tr_b16 a[136:137], v118 offset:4096
  ds_read_b64_tr_b16 a[138:139], v118 offset:6144
  ds_read_b64_tr_b16 a[140:141], v119 offset:4096
  ds_read_b64_tr_b16 a[142:143], v119 offset:6144
  ds_read_b128 a[28:31], v129 offset:0
  ds_read_b128 a[32:35], v129 offset:2048
  ds_read_b128 a[36:39], v129 offset:4096
  ds_read_b128 a[40:43], v129 offset:6144
  ds_read_b128 a[44:47], v129 offset:8192
  ds_read_b128 a[48:51], v129 offset:10240
  ds_read_b128 a[52:55], v129 offset:12288
  s_add_u32 m0, s62, 16384
  s_add_u32 s35, s35, 262144
  s_cmp_lg_u32 s35, 3670016
  s_cselect_b32 s35, s35, 0
  s_add_u32 s66, s35, 0
  buffer_load_dwordx4 v120, s[48:51], s66 offen offset:0 lds
  s_add_u32 s67, s35, 15360
  buffer_load_dwordx4 v121, s[48:51], s67 offen offset:1024 lds
  s_add_u32 s66, s35, 30720
  buffer_load_dwordx4 v120, s[48:51], s66 offen offset:2048 lds
  s_add_u32 s67, s35, 46080
  buffer_load_dwordx4 v121, s[48:51], s67 offen offset:3072 lds
  s_add_u32 m0, s62, 20480
  s_add_u32 s35, s35, 262144
  s_cmp_lg_u32 s35, 3670016
  s_cselect_b32 s35, s35, 0
  s_add_u32 s66, s35, 0
  buffer_load_dwordx4 v120, s[48:51], s66 offen offset:0 lds
  s_add_u32 s67, s35, 15360
  buffer_load_dwordx4 v121, s[48:51], s67 offen offset:1024 lds
  s_add_u32 s66, s35, 30720
  buffer_load_dwordx4 v120, s[48:51], s66 offen offset:2048 lds
  s_add_u32 s67, s35, 46080
  buffer_load_dwordx4 v121, s[48:51], s67 offen offset:3072 lds
  s_add_u32 m0, s62, 8192
  s_add_u32 s69, s69, 128
  s_cmp_lg_u32 s69, 896
  s_cselect_b32 s69, s69, 0
  s_add_u32 s66, s69, 0
  buffer_load_dwordx4 v122, s[36:39], s66 offen offset:0 lds
  s_add_u32 s67, s69, 6144
  buffer_load_dwordx4 v123, s[36:39], s67 offen offset:1024 lds
  s_add_u32 s66, s69, 12288
  buffer_load_dwordx4 v122, s[36:39], s66 offen offset:2048 lds
  s_add_u32 s67, s69, 18432
  buffer_load_dwordx4 v123, s[36:39], s67 offen offset:3072 lds
  s_waitcnt vmcnt(8) lgkmcnt(0)
  s_barrier
  v_mfma_f32_16x16x32_bf16 v[144:147], a[112:115], a[0:3], 0
  s_add_u32 m0, s62, 24576
  s_add_u32 s35, s35, 262144
  ds_read_b64_tr_b16 a[144:145], v116 offset:16384
  v_mfma_f32_16x16x32_bf16 v[144:147], a[128:131], a[28:31], v[144:147]
  s_cmp_lg_u32 s35, 3670016
  s_cselect_b32 s35, s35, 0
  s_add_u32 s66, s35, 0
  buffer_load_dwordx4 v120, s[48:51], s66 offen offset:0 lds
  v_mfma_f32_16x16x32_bf16 v[148:151], a[132:135], a[28:31], 0
  s_add_u32 s67, s35, 15360
  buffer_load_dwordx4 v121, s[48:51], s67 offen offset:1024 lds
  v_mfma_f32_16x16x32_bf16 v[148:151], a[116:119], a[0:3], v[148:151]
  s_add_u32 s66, s35, 30720
  ds_read_b64_tr_b16 a[146:147], v116 offset:18432
  v_mfma_f32_16x16x32_bf16 v[152:155], a[120:123], a[0:3], 0
  buffer_load_dwordx4 v120, s[48:51], s66 offen offset:2048 lds
  ds_read_b64_tr_b16 a[148:149], v117 offset:16384
  v_mfma_f32_16x16x32_bf16 v[152:155], a[136:139], a[28:31], v[152:155]
  s_add_u32 s67, s35, 46080
  ds_read_b64_tr_b16 a[150:151], v117 offset:18432
  v_mfma_f32_16x16x32_bf16 v[156:159], a[140:143], a[28:31], 0
  ds_read_b64_tr_b16 a[152:153], v118 offset:16384
  ds_read_b64_tr_b16 a[154:155], v118 offset:18432
  v_mfma_f32_16x16x32_bf16 v[156:159], a[124:127], a[0:3], v[156:159]
  buffer_load_dwordx4 v121, s[48:51], s67 offen offset:3072 lds
  s_add_u32 m0, s62, 28672
  v_mfma_f32_16x16x32_bf16 v[160:163], a[112:115], a[4:7], 0
  s_add_u32 s35, s35, 262144
  ds_read_b64_tr_b16 a[156:157], v119 offset:16384
  v_mfma_f32_16x16x32_bf16 v[160:163], a[128:131], a[32:35], v[160:163]
  s_cmp_lg_u32 s35, 3670016
  s_cselect_b32 s35, s35, 0
  v_mfma_f32_16x16x32_bf16 v[164:167], a[132:135], a[32:35], 0
  s_add_u32 s66, s35, 0
  buffer_load_dwordx4 v120, s[48:51], s66 offen offset:0 lds
  v_mfma_f32_16x16x32_bf16 v[164:167], a[116:119], a[4:7], v[164:167]
  s_add_u32 s67, s35, 15360
  buffer_load_dwordx4 v121, s[48:51], s67 offen offset:1024 lds
  v_mfma_f32_16x16x32_bf16 v[168:171], a[120:123], a[4:7], 0
  s_add_u32 s66, s35, 30720
  ds_read_b64_tr_b16 a[158:159], v119 offset:18432
  v_mfma_f32_16x16x32_bf16 v[168:171], a[136:139], a[32:35], v[168:171]
  ds_read_b128 a[56:59], v128 offset:16384
  ds_read_b128 a[60:63], v128 offset:18432
  v_mfma_f32_16x16x32_bf16 v[172:175], a[140:143], a[32:35], 0
  buffer_load_dwordx4 v120, s[48:51], s66 offen offset:2048 lds
  s_add_u32 s67, s35, 46080
  v_mfma_f32_16x16x32_bf16 v[172:175], a[124:127], a[4:7], v[172:175]
  ds_read_b128 a[64:67], v128 offset:20480
  ds_read_b128 a[68:71], v128 offset:22528
  v_mfma_f32_16x16x32_bf16 v[176:179], a[112:115], a[8:11], 0
  buffer_load_dwordx4 v121, s[48:51], s67 offen offset:3072 lds
  s_add_u32 m0, s65, 0
  v_mfma_f32_16x16x32_bf16 v[176:179], a[128:131], a[36:39], v[176:179]
  s_add_u32 s69, s69, 128
  ds_read_b128 a[72:75], v128 offset:24576
  v_mfma_f32_16x16x32_bf16 v[180:183], a[132:135], a[36:39], 0
  s_cmp_lg_u32 s69, 896
  s_cselect_b32 s69, s69, 0
  v_mfma_f32_16x16x32_bf16 v[180:183], a[116:119], a[8:11], v[180:183]
  s_add_u32 s66, s69, 0
  buffer_load_dwordx4 v122, s[36:39], s66 offen offset:0 lds
  v_mfma_f32_16x16x32_bf16 v[184:187], a[120:123], a[8:11], 0
  s_add_u32 s67, s69, 6144
  ds_read_b128 a[76:79], v128 offset:26624
  v_mfma_f32_16x16x32_bf16 v[184:187], a[136:139], a[36:39], v[184:187]
  buffer_load_dwordx4 v123, s[36:39], s67 offen offset:1024 lds
  s_add_u32 s66, s69, 12288
  v_mfma_f32_16x16x32_bf16 v[188:191], a[140:143], a[36:39], 0
  ds_read_b128 a[80:83], v128 offset:28672
  v_mfma_f32_16x16x32_bf16 v[188:191], a[124:127], a[8:11], v[188:191]
  buffer_load_dwordx4 v122, s[36:39], s66 offen offset:2048 lds
  s_add_u32 s67, s69, 18432
  v_mfma_f32_16x16x32_bf16 v[192:195], a[112:115], a[12:15], 0
  v_mfma_f32_16x16x32_bf16 v[192:195], a[128:131], a[40:43], v[192:195]
  buffer_load_dwordx4 v123, s[36:39], s67 offen offset:3072 lds
  v_mfma_f32_16x16x32_bf16 v[196:199], a[132:135], a[40:43], 0
  v_mfma_f32_16x16x32_bf16 v[196:199], a[116:119], a[12:15], v[196:199]
  s_waitcnt vmcnt(16) lgkmcnt(0)
  s_barrier
  v_mfma_f32_16x16x32_bf16 v[200:203], a[120:123], a[12:15], 0
  s_add_u32 m0, s62, 12288
  s_add_u32 s35, s35, 262144
  v_mfma_f32_16x16x32_bf16 v[200:203], a[136:139], a[40:43], v[200:203]
  s_cmp_lg_u32 s35, 3670016
  s_cselect_b32 s35, s35, 0
  v_mfma_f32_16x16x32_bf16 v[204:207], a[140:143], a[40:43], 0
  s_add_u32 s66, s35, 0
  buffer_load_dwordx4 v120, s[48:51], s66 offen offset:0 lds
  v_mfma_f32_16x16x32_bf16 v[204:207], a[124:127], a[12:15], v[204:207]
  s_add_u32 s67, s35, 15360
  buffer_load_dwordx4 v121, s[48:51], s67 offen offset:1024 lds
  v_mfma_f32_16x16x32_bf16 v[208:211], a[112:115], a[16:19], 0
  ds_read_b64_tr_b16 a[160:161], v116 offset:20480
  ds_read_b64_tr_b16 a[162:163], v116 offset:22528
  v_mfma_f32_16x16x32_bf16 v[208:211], a[128:131], a[44:47], v[208:211]
  s_add_u32 s66, s35, 30720
  ds_read_b64_tr_b16 a[164:165], v117 offset:20480
  v_mfma_f32_16x16x32_bf16 v[212:215], a[132:135], a[44:47], 0
  ds_read_b64_tr_b16 a[166:167], v117 offset:22528
  ds_read_b64_tr_b16 a[168:169], v118 offset:20480
  v_mfma_f32_16x16x32_bf16 v[212:215], a[116:119], a[16:19], v[212:215]
  buffer_load_dwordx4 v120, s[48:51], s66 offen offset:2048 lds
  ds_read_b64_tr_b16 a[170:171], v118 offset:22528
  v_mfma_f32_16x16x32_bf16 v[216:219], a[120:123], a[16:19], 0
  s_add_u32 s67, s35, 46080
  ds_read_b64_tr_b16 a[172:173], v119 offset:20480
  v_mfma_f32_16x16x32_bf16 v[216:219], a[136:139], a[44:47], v[216:219]
  ds_read_b64_tr_b16 a[174:175], v119 offset:22528
  ds_read_b128 a[84:87], v129 offset:16384
  v_mfma_f32_16x16x32_bf16 v[220:223], a[140:143], a[44:47], 0
  buffer_load_dwordx4 v121, s[48:51], s67 offen offset:3072 lds
  ds_read_b128 a[88:91], v129 offset:18432
  v_mfma_f32_16x16x32_bf16 v[220:223], a[124:127], a[16:19], v[220:223]
  ds_read_b128 a[92:95], v129 offset:20480
  ds_read_b128 a[96:99], v129 offset:22528
  v_mfma_f32_16x16x32_bf16 v[224:227], a[112:115], a[20:23], 0
  s_add_u32 m0, s62, 16384
  s_add_u32 s35, s35, 262144
  v_mfma_f32_16x16x32_bf16 v[224:227], a[128:131], a[48:51], v[224:227]
  s_cmp_lg_u32 s35, 3670016
  s_cselect_b32 s35, s35, 0
  v_mfma_f32_16x16x32_bf16 v[228:231], a[132:135], a[48:51], 0
  s_add_u32 s66, s35, 0
  buffer_load_dwordx4 v120, s[48:51], s66 offen offset:0 lds
  v_mfma_f32_16x16x32_bf16 v[228:231], a[116:119], a[20:23], v[228:231]
  s_add_u32 s67, s35, 15360
  ds_read_b128 a[100:103], v129 offset:24576
  v_mfma_f32_16x16x32_bf16 v[232:235], a[120:123], a[20:23], 0
  ds_read_b128 a[104:107], v129 offset:26624
  ds_read_b128 a[108:111], v129 offset:28672
  v_mfma_f32_16x16x32_bf16 v[232:235], a[136:139], a[48:51], v[232:235]
  buffer_load_dwordx4 v121, s[48:51], s67 offen offset:1024 lds
  v_mfma_f32_16x16x32_bf16 v[236:239], a[140:143], a[48:51], 0
  v_mfma_f32_16x16x32_bf16 v[236:239], a[124:127], a[20:23], v[236:239]
  s_add_u32 s66, s35, 30720
  v_mfma_f32_16x16x32_bf16 v[240:243], a[112:115], a[24:27], 0
  v_mfma_f32_16x16x32_bf16 v[240:243], a[128:131], a[52:55], v[240:243]
  buffer_load_dwordx4 v120, s[48:51], s66 offen offset:2048 lds
  v_mfma_f32_16x16x32_bf16 v[244:247], a[132:135], a[52:55], 0
  s_add_u32 s67, s35, 46080
  v_mfma_f32_16x16x32_bf16 v[244:247], a[116:119], a[24:27], v[244:247]
  v_mfma_f32_16x16x32_bf16 v[248:251], a[120:123], a[24:27], 0
  buffer_load_dwordx4 v121, s[48:51], s67 offen offset:3072 lds
  v_mfma_f32_16x16x32_bf16 v[248:251], a[136:139], a[52:55], v[248:251]
  v_mfma_f32_16x16x32_bf16 v[252:255], a[140:143], a[52:55], 0
  v_mfma_f32_16x16x32_bf16 v[252:255], a[124:127], a[24:27], v[252:255]
  s_waitcnt vmcnt(16) lgkmcnt(0)
  s_barrier
  v_mfma_f32_16x16x32_bf16 v[144:147], a[144:147], a[56:59], v[144:147]
  s_add_u32 m0, s62, 20480
  s_add_u32 s35, s35, 262144
  v_mfma_f32_16x16x32_bf16 v[144:147], a[160:163], a[84:87], v[144:147]
  s_cmp_lg_u32 s35, 3670016
  s_cselect_b32 s35, s35, 0
  v_mfma_f32_16x16x32_bf16 v[148:151], a[164:167], a[84:87], v[148:151]
  s_add_u32 s66, s35, 0
  buffer_load_dwordx4 v120, s[48:51], s66 offen offset:0 lds
  v_mfma_f32_16x16x32_bf16 v[148:151], a[148:151], a[56:59], v[148:151]
  s_add_u32 s67, s35, 15360
  buffer_load_dwordx4 v121, s[48:51], s67 offen offset:1024 lds
  v_mfma_f32_16x16x32_bf16 v[152:155], a[152:155], a[56:59], v[152:155]
  ds_read_b64_tr_b16 a[112:113], v116 offset:24576
  ds_read_b64_tr_b16 a[114:115], v116 offset:26624
  v_mfma_f32_16x16x32_bf16 v[152:155], a[168:171], a[84:87], v[152:155]
  s_add_u32 s66, s35, 30720
  ds_read_b64_tr_b16 a[116:117], v117 offset:24576
  v_mfma_f32_16x16x32_bf16 v[156:159], a[172:175], a[84:87], v[156:159]
  ds_read_b64_tr_b16 a[118:119], v117 offset:26624
  ds_read_b64_tr_b16 a[120:121], v118 offset:24576
  v_mfma_f32_16x16x32_bf16 v[156:159], a[156:159], a[56:59], v[156:159]
  buffer_load_dwordx4 v120, s[48:51], s66 offen offset:2048 lds
  ds_read_b64_tr_b16 a[122:123], v118 offset:26624
  v_mfma_f32_16x16x32_bf16 v[160:163], a[144:147], a[60:63], v[160:163]
  s_add_u32 s67, s35, 46080
  ds_read_b64_tr_b16 a[124:125], v119 offset:24576
  v_mfma_f32_16x16x32_bf16 v[160:163], a[160:163], a[88:91], v[160:163]
  ds_read_b64_tr_b16 a[126:127], v119 offset:26624
  ds_read_b128 a[0:3], v124 offset:8192
  v_mfma_f32_16x16x32_bf16 v[164:167], a[164:167], a[88:91], v[164:167]
  buffer_load_dwordx4 v121, s[48:51], s67 offen offset:3072 lds
  ds_read_b128 a[4:7], v124 offset:10240
  v_mfma_f32_16x16x32_bf16 v[164:167], a[148:151], a[60:63], v[164:167]
  ds_read_b128 a[8:11], v124 offset:40960
  ds_read_b128 a[12:15], v124 offset:43008
  v_mfma_f32_16x16x32_bf16 v[168:171], a[152:155], a[60:63], v[168:171]
  s_add_u32 m0, s65, 16384
  s_add_u32 s69, s69, 128
  v_mfma_f32_16x16x32_bf16 v[168:171], a[168:171], a[88:91], v[168:171]
  s_cmp_lg_u32 s69, 896
  s_cselect_b32 s69, s69, 0
  v_mfma_f32_16x16x32_bf16 v[172:175], a[172:175], a[88:91], v[172:175]
  s_add_u32 s66, s69, 0
  buffer_load_dwordx4 v122, s[36:39], s66 offen offset:0 lds
  v_mfma_f32_16x16x32_bf16 v[172:175], a[156:159], a[60:63], v[172:175]
  s_add_u32 s67, s69, 6144
  ds_read_b128 a[16:19], v126 offset:8192
  v_mfma_f32_16x16x32_bf16 v[176:179], a[144:147], a[64:67], v[176:179]
  ds_read_b128 a[20:23], v126 offset:10240
  ds_read_b128 a[24:27], v126 offset:40960
  v_mfma_f32_16x16x32_bf16 v[176:179], a[160:163], a[92:95], v[176:179]
  buffer_load_dwordx4 v123, s[36:39], s67 offen offset:1024 lds
  v_mfma_f32_16x16x32_bf16 v[180:183], a[164:167], a[92:95], v[180:183]
  v_mfma_f32_16x16x32_bf16 v[180:183], a[148:151], a[64:67], v[180:183]
  s_add_u32 s66, s69, 12288
  v_mfma_f32_16x16x32_bf16 v[184:187], a[152:155], a[64:67], v[184:187]
  v_mfma_f32_16x16x32_bf16 v[184:187], a[168:171], a[92:95], v[184:187]
  buffer_load_dwordx4 v122, s[36:39], s66 offen offset:2048 lds
  v_mfma_f32_16x16x32_bf16 v[188:191], a[172:175], a[92:95], v[188:191]
  s_add_u32 s67, s69, 18432
  v_mfma_f32_16x16x32_bf16 v[188:191], a[156:159], a[64:67], v[188:191]
  v_mfma_f32_16x16x32_bf16 v[192:195], a[144:147], a[68:71], v[192:195]
  buffer_load_dwordx4 v123, s[36:39], s67 offen offset:3072 lds
  v_mfma_f32_16x16x32_bf16 v[192:195], a[160:163], a[96:99], v[192:195]
  v_mfma_f32_16x16x32_bf16 v[196:199], a[164:167], a[96:99], v[196:199]
  v_mfma_f32_16x16x32_bf16 v[196:199], a[148:151], a[68:71], v[196:199]
  s_waitcnt vmcnt(20) lgkmcnt(0)
  s_barrier
  v_mfma_f32_16x16x32_bf16 v[200:203], a[152:155], a[68:71], v[200:203]
  s_add_u32 m0, s62, 24576
  s_add_u32 s35, s35, 262144
  v_mfma_f32_16x16x32_bf16 v[200:203], a[168:171], a[96:99], v[200:203]
  ds_read_b64_tr_b16 a[128:129], v116 offset:28672
  ds_read_b64_tr_b16 a[130:131], v116 offset:30720
  v_mfma_f32_16x16x32_bf16 v[204:207], a[172:175], a[96:99], v[204:207]
  s_cmp_lg_u32 s35, 3670016
  s_cselect_b32 s35, s35, 0
  v_mfma_f32_16x16x32_bf16 v[204:207], a[156:159], a[68:71], v[204:207]
  ds_read_b64_tr_b16 a[132:133], v117 offset:28672
  ds_read_b64_tr_b16 a[134:135], v117 offset:30720
  v_mfma_f32_16x16x32_bf16 v[208:211], a[144:147], a[72:75], v[208:211]
  s_add_u32 s66, s35, 0
  ds_read_b64_tr_b16 a[136:137], v118 offset:28672
  v_mfma_f32_16x16x32_bf16 v[208:211], a[160:163], a[100:103], v[208:211]
  ds_read_b64_tr_b16 a[138:139], v118 offset:30720
  buffer_load_dwordx4 v120, s[48:51], s66 offen offset:0 lds
  v_mfma_f32_16x16x32_bf16 v[212:215], a[164:167], a[100:103], v[212:215]
  ds_read_b64_tr_b16 a[140:141], v119 offset:28672
  ds_read_b64_tr_b16 a[142:143], v119 offset:30720
  v_mfma_f32_16x16x32_bf16 v[212:215], a[148:151], a[72:75], v[212:215]
  ds_read_b128 a[28:31], v125 offset:8192
  s_add_u32 s67, s35, 15360
  v_mfma_f32_16x16x32_bf16 v[216:219], a[152:155], a[72:75], v[216:219]
  ds_read_b128 a[32:35], v125 offset:10240
  ds_read_b128 a[36:39], v125 offset:40960
  v_mfma_f32_16x16x32_bf16 v[216:219], a[168:171], a[100:103], v[216:219]
  ds_read_b128 a[40:43], v125 offset:43008
  buffer_load_dwordx4 v121, s[48:51], s67 offen offset:1024 lds
  v_mfma_f32_16x16x32_bf16 v[220:223], a[172:175], a[100:103], v[220:223]
  ds_read_b128 a[44:47], v127 offset:8192
  ds_read_b128 a[48:51], v127 offset:10240
  v_mfma_f32_16x16x32_bf16 v[220:223], a[156:159], a[72:75], v[220:223]
  ds_read_b128 a[52:55], v127 offset:40960
  v_mfma_f32_16x16x32_bf16 v[224:227], a[144:147], a[76:79], v[224:227]
  s_add_u32 s66, s35, 30720
  v_mfma_f32_16x16x32_bf16 v[224:227], a[160:163], a[104:107], v[224:227]
  v_mfma_f32_16x16x32_bf16 v[228:231], a[164:167], a[104:107], v[228:231]
  buffer_load_dwordx4 v120, s[48:51], s66 offen offset:2048 lds
  v_mfma_f32_16x16x32_bf16 v[228:231], a[148:151], a[76:79], v[228:231]
  v_mfma_f32_16x16x32_bf16 v[232:235], a[152:155], a[76:79], v[232:235]
  v_mfma_f32_16x16x32_bf16 v[232:235], a[168:171], a[104:107], v[232:235]
  v_mfma_f32_16x16x32_bf16 v[236:239], a[172:175], a[104:107], v[236:239]
  v_mfma_f32_16x16x32_bf16 v[236:239], a[156:159], a[76:79], v[236:239]
  s_add_u32 s67, s35, 46080
  v_mfma_f32_16x16x32_bf16 v[240:243], a[144:147], a[80:83], v[240:243]
  v_mfma_f32_16x16x32_bf16 v[240:243], a[160:163], a[108:111], v[240:243]
  buffer_load_dwordx4 v121, s[48:51], s67 offen offset:3072 lds
  v_mfma_f32_16x16x32_bf16 v[244:247], a[164:167], a[108:111], v[244:247]
  v_mfma_f32_16x16x32_bf16 v[244:247], a[148:151], a[80:83], v[244:247]
  v_mfma_f32_16x16x32_bf16 v[248:251], a[152:155], a[80:83], v[248:251]
  v_mfma_f32_16x16x32_bf16 v[248:251], a[168:171], a[108:111], v[248:251]
  v_mfma_f32_16x16x32_bf16 v[252:255], a[172:175], a[108:111], v[252:255]
  v_mfma_f32_16x16x32_bf16 v[252:255], a[156:159], a[80:83], v[252:255]
  s_waitcnt vmcnt(16) lgkmcnt(0)
  s_barrier
  v_mfma_f32_16x16x32_bf16 v[144:147], a[112:115], a[0:3], v[144:147]
  s_add_u32 m0, s62, 28672
  s_add_u32 s35, s35, 262144
  v_mfma_f32_16x16x32_bf16 v[144:147], a[128:131], a[28:31], v[144:147]
  s_cmp_lg_u32 s35, 3670016
  s_cselect_b32 s35, s35, 0
  v_mfma_f32_16x16x32_bf16 v[148:151], a[132:135], a[28:31], v[148:151]
  s_add_u32 s66, s35, 0
  buffer_load_dwordx4 v120, s[48:51], s66 offen offset:0 lds
  v_mfma_f32_16x16x32_bf16 v[148:151], a[116:119], a[0:3], v[148:151]
  s_add_u32 s67, s35, 15360
  buffer_load_dwordx4 v121, s[48:51], s67 offen offset:1024 lds
  v_mfma_f32_16x16x32_bf16 v[152:155], a[120:123], a[0:3], v[152:155]
  ds_read_b64_tr_b16 a[144:145], v116 offset:12288
  ds_read_b64_tr_b16 a[146:147], v116 offset:14336
  v_mfma_f32_16x16x32_bf16 v[152:155], a[136:139], a[28:31], v[152:155]
  s_add_u32 s66, s35, 30720
  ds_read_b64_tr_b16 a[148:149], v117 offset:12288
  v_mfma_f32_16x16x32_bf16 v[156:159], a[140:143], a[28:31], v[156:159]
  ds_read_b64_tr_b16 a[150:151], v117 offset:14336
  ds_read_b64_tr_b16 a[152:153], v118 offset:12288
  v_mfma_f32_16x16x32_bf16 v[156:159], a[124:127], a[0:3], v[156:159]
  buffer_load_dwordx4 v120, s[48:51], s66 offen offset:2048 lds
  ds_read_b64_tr_b16 a[154:155], v118 offset:14336
  v_mfma_f32_16x16x32_bf16 v[160:163], a[112:115], a[4:7], v[160:163]
  s_add_u32 s67, s35, 46080
  ds_read_b64_tr_b16 a[156:157], v119 offset:12288
  v_mfma_f32_16x16x32_bf16 v[160:163], a[128:131], a[32:35], v[160:163]
  ds_read_b64_tr_b16 a[158:159], v119 offset:14336
  ds_read_b128 a[56:59], v128 offset:0
  v_mfma_f32_16x16x32_bf16 v[164:167], a[132:135], a[32:35], v[164:167]
  buffer_load_dwordx4 v121, s[48:51], s67 offen offset:3072 lds
  ds_read_b128 a[60:63], v128 offset:2048
  v_mfma_f32_16x16x32_bf16 v[164:167], a[116:119], a[4:7], v[164:167]
  ds_read_b128 a[64:67], v128 offset:4096
  ds_read_b128 a[68:71], v128 offset:6144
  v_mfma_f32_16x16x32_bf16 v[168:171], a[120:123], a[4:7], v[168:171]
  s_add_u32 m0, s62, 8192
  s_add_u32 s69, s69, 128
  v_mfma_f32_16x16x32_bf16 v[168:171], a[136:139], a[32:35], v[168:171]
  s_cmp_lg_u32 s69, 896
  s_cselect_b32 s69, s69, 0
  v_mfma_f32_16x16x32_bf16 v[172:175], a[140:143], a[32:35], v[172:175]
  s_add_u32 s66, s69, 0
  buffer_load_dwordx4 v122, s[36:39], s66 offen offset:0 lds
  v_mfma_f32_16x16x32_bf16 v[172:175], a[124:127], a[4:7], v[172:175]
  s_add_u32 s67, s69, 6144
  ds_read_b128 a[72:75], v128 offset:8192
  v_mfma_f32_16x16x32_bf16 v[176:179], a[112:115], a[8:11], v[176:179]
  ds_read_b128 a[76:79], v128 offset:10240
  ds_read_b128 a[80:83], v128 offset:12288
  v_mfma_f32_16x16x32_bf16 v[176:179], a[128:131], a[36:39], v[176:179]
  buffer_load_dwordx4 v123, s[36:39], s67 offen offset:1024 lds
  v_mfma_f32_16x16x32_bf16 v[180:183], a[132:135], a[36:39], v[180:183]
  v_mfma_f32_16x16x32_bf16 v[180:183], a[116:119], a[8:11], v[180:183]
  s_add_u32 s66, s69, 12288
  v_mfma_f32_16x16x32_bf16 v[184:187], a[120:123], a[8:11], v[184:187]
  v_mfma_f32_16x16x32_bf16 v[184:187], a[136:139], a[36:39], v[184:187]
  buffer_load_dwordx4 v122, s[36:39], s66 offen offset:2048 lds
  v_mfma_f32_16x16x32_bf16 v[188:191], a[140:143], a[36:39], v[188:191]
  s_add_u32 s67, s69, 18432
  v_mfma_f32_16x16x32_bf16 v[188:191], a[124:127], a[8:11], v[188:191]
  v_mfma_f32_16x16x32_bf16 v[192:195], a[112:115], a[12:15], v[192:195]
  buffer_load_dwordx4 v123, s[36:39], s67 offen offset:3072 lds
  v_mfma_f32_16x16x32_bf16 v[192:195], a[128:131], a[40:43], v[192:195]
  v_mfma_f32_16x16x32_bf16 v[196:199], a[132:135], a[40:43], v[196:199]
  v_mfma_f32_16x16x32_bf16 v[196:199], a[116:119], a[12:15], v[196:199]
  s_waitcnt vmcnt(20) lgkmcnt(0)
  s_barrier
  v_mfma_f32_16x16x32_bf16 v[200:203], a[120:123], a[12:15], v[200:203]
  s_add_u32 m0, s62, 12288
  s_add_u32 s35, s35, 262144
  v_mfma_f32_16x16x32_bf16 v[200:203], a[136:139], a[40:43], v[200:203]
  ds_read_b64_tr_b16 a[160:161], v116 offset:16384
  ds_read_b64_tr_b16 a[162:163], v116 offset:18432
  v_mfma_f32_16x16x32_bf16 v[204:207], a[140:143], a[40:43], v[204:207]
  s_cmp_lg_u32 s35, 3670016
  s_cselect_b32 s35, s35, 0
  v_mfma_f32_16x16x32_bf16 v[204:207], a[124:127], a[12:15], v[204:207]
  ds_read_b64_tr_b16 a[164:165], v117 offset:16384
  ds_read_b64_tr_b16 a[166:167], v117 offset:18432
  v_mfma_f32_16x16x32_bf16 v[208:211], a[112:115], a[16:19], v[208:211]
  s_add_u32 s66, s35, 0
  ds_read_b64_tr_b16 a[168:169], v118 offset:16384
  v_mfma_f32_16x16x32_bf16 v[208:211], a[128:131], a[44:47], v[208:211]
  ds_read_b64_tr_b16 a[170:171], v118 offset:18432
  buffer_load_dwordx4 v120, s[48:51], s66 offen offset:0 lds
  v_mfma_f32_16x16x32_bf16 v[212:215], a[132:135], a[44:47], v[212:215]
  ds_read_b64_tr_b16 a[172:173], v119 offset:16384
  ds_read_b64_tr_b16 a[174:175], v119 offset:18432
  v_mfma_f32_16x16x32_bf16 v[212:215], a[116:119], a[16:19], v[212:215]
  ds_read_b128 a[84:87], v129 offset:0
  s_add_u32 s67, s35, 15360
  v_mfma_f32_16x16x32_bf16 v[216:219], a[120:123], a[16:19], v[216:219]
  ds_read_b128 a[88:91], v129 offset:2048
  ds_read_b128 a[92:95], v129 offset:4096
  v_mfma_f32_16x16x32_bf16 v[216:219], a[136:139], a[44:47], v[216:219]
  ds_read_b128 a[96:99], v129 offset:6144
  buffer_load_dwordx4 v121, s[48:51], s67 offen offset:1024 lds
  v_mfma_f32_16x16x32_bf16 v[220:223], a[140:143], a[44:47], v[220:223]
  ds_read_b128 a[100:103], v129 offset:8192
  ds_read_b128 a[104:107], v129 offset:10240
  v_mfma_f32_16x16x32_bf16 v[220:223], a[124:127], a[16:19], v[220:223]
  ds_read_b128 a[108:111], v129 offset:12288
  v_mfma_f32_16x16x32_bf16 v[224:227], a[112:115], a[20:23], v[224:227]
  s_add_u32 s66, s35, 30720
  v_mfma_f32_16x16x32_bf16 v[224:227], a[128:131], a[48:51], v[224:227]
  v_mfma_f32_16x16x32_bf16 v[228:231], a[132:135], a[48:51], v[228:231]
  buffer_load_dwordx4 v120, s[48:51], s66 offen offset:2048 lds
  v_mfma_f32_16x16x32_bf16 v[228:231], a[116:119], a[20:23], v[228:231]
  v_mfma_f32_16x16x32_bf16 v[232:235], a[120:123], a[20:23], v[232:235]
  v_mfma_f32_16x16x32_bf16 v[232:235], a[136:139], a[48:51], v[232:235]
  v_mfma_f32_16x16x32_bf16 v[236:239], a[140:143], a[48:51], v[236:239]
  v_mfma_f32_16x16x32_bf16 v[236:239], a[124:127], a[20:23], v[236:239]
  s_add_u32 s67, s35, 46080
  v_mfma_f32_16x16x32_bf16 v[240:243], a[112:115], a[24:27], v[240:243]
  v_mfma_f32_16x16x32_bf16 v[240:243], a[128:131], a[52:55], v[240:243]
  buffer_load_dwordx4 v121, s[48:51], s67 offen offset:3072 lds
  v_mfma_f32_16x16x32_bf16 v[244:247], a[132:135], a[52:55], v[244:247]
  v_mfma_f32_16x16x32_bf16 v[244:247], a[116:119], a[24:27], v[244:247]
  v_mfma_f32_16x16x32_bf16 v[248:251], a[120:123], a[24:27], v[248:251]
  v_mfma_f32_16x16x32_bf16 v[248:251], a[136:139], a[52:55], v[248:251]
  v_mfma_f32_16x16x32_bf16 v[252:255], a[140:143], a[52:55], v[252:255]
  v_mfma_f32_16x16x32_bf16 v[252:255], a[124:127], a[24:27], v[252:255]
  s_waitcnt vmcnt(16) lgkmcnt(0)
  s_barrier
  v_mfma_f32_16x16x32_bf16 v[144:147], a[144:147], a[56:59], v[144:147]
  s_add_u32 m0, s62, 16384
  s_add_u32 s35, s35, 262144
  v_mfma_f32_16x16x32_bf16 v[144:147], a[160:163], a[84:87], v[144:147]
  s_cmp_lg_u32 s35, 3670016
  s_cselect_b32 s35, s35, 0
  v_mfma_f32_16x16x32_bf16 v[148:151], a[164:167], a[84:87], v[148:151]
  s_add_u32 s66, s35, 0
  buffer_load_dwordx4 v120, s[48:51], s66 offen offset:0 lds
  v_mfma_f32_16x16x32_bf16 v[148:151], a[148:151], a[56:59], v[148:151]
  s_add_u32 s67, s35, 15360
  buffer_load_dwordx4 v121, s[48:51], s67 offen offset:1024 lds
  v_mfma_f32_16x16x32_bf16 v[152:155], a[152:155], a[56:59], v[152:155]
  ds_read_b64_tr_b16 a[112:113], v116 offset:20480
  ds_read_b64_tr_b16 a[114:115], v116 offset:22528
  v_mfma_f32_16x16x32_bf16 v[152:155], a[168:171], a[84:87], v[152:155]
  s_add_u32 s66, s35, 30720
  ds_read_b64_tr_b16 a[116:117], v117 offset:20480
  v_mfma_f32_16x16x32_bf16 v[156:159], a[172:175], a[84:87], v[156:159]
  ds_read_b64_tr_b16 a[118:119], v117 offset:22528
  ds_read_b64_tr_b16 a[120:121], v118 offset:20480
  v_mfma_f32_16x16x32_bf16 v[156:159], a[156:159], a[56:59], v[156:159]
  buffer_load_dwordx4 v120, s[48:51], s66 offen offset:2048 lds
  ds_read_b64_tr_b16 a[122:123], v118 offset:22528
  v_mfma_f32_16x16x32_bf16 v[160:163], a[144:147], a[60:63], v[160:163]
  s_add_u32 s67, s35, 46080
  ds_read_b64_tr_b16 a[124:125], v119 offset:20480
  v_mfma_f32_16x16x32_bf16 v[160:163], a[160:163], a[88:91], v[160:163]
  ds_read_b64_tr_b16 a[126:127], v119 offset:22528
  ds_read_b128 a[0:3], v128 offset:16384
  v_mfma_f32_16x16x32_bf16 v[164:167], a[164:167], a[88:91], v[164:167]
  buffer_load_dwordx4 v121, s[48:51], s67 offen offset:3072 lds
  ds_read_b128 a[4:7], v128 offset:18432
  v_mfma_f32_16x16x32_bf16 v[164:167], a[148:151], a[60:63], v[164:167]
  ds_read_b128 a[8:11], v128 offset:20480
  ds_read_b128 a[12:15], v128 offset:22528
  v_mfma_f32_16x16x32_bf16 v[168:171], a[152:155], a[60:63], v[168:171]
  s_add_u32 m0, s65, 0
  s_add_u32 s69, s69, 128
  v_mfma_f32_16x16x32_bf16 v[168:171], a[168:171], a[88:91], v[168:171]
  s_cmp_lg_u32 s69, 896
  s_cselect_b32 s69, s69, 0
  v_mfma_f32_16x16x32_bf16 v[172:175], a[172:175], a[88:91], v[172:175]
  s_add_u32 s66, s69, 0
  buffer_load_dwordx4 v122, s[36:39], s66 offen offset:0 lds
  v_mfma_f32_16x16x32_bf16 v[172:175], a[156:159], a[60:63], v[172:175]
  s_add_u32 s67, s69, 6144
  ds_read_b128 a[16:19], v128 offset:24576
  v_mfma_f32_16x16x32_bf16 v[176:179], a[144:147], a[64:67], v[176:179]
  ds_read_b128 a[20:23], v128 offset:26624
  ds_read_b128 a[24:27], v128 offset:28672
  v_mfma_f32_16x16x32_bf16 v[176:179], a[160:163], a[92:95], v[176:179]
  buffer_load_dwordx4 v123, s[36:39], s67 offen offset:1024 lds
  v_mfma_f32_16x16x32_bf16 v[180:183], a[164:167], a[92:95], v[180:183]
  v_mfma_f32_16x16x32_bf16 v[180:183], a[148:151], a[64:67], v[180:183]
  s_add_u32 s66, s69, 12288
  v_mfma_f32_16x16x32_bf16 v[184:187], a[152:155], a[64:67], v[184:187]
  v_mfma_f32_16x16x32_bf16 v[184:187], a[168:171], a[92:95], v[184:187]
  buffer_load_dwordx4 v122, s[36:39], s66 offen offset:2048 lds
  v_mfma_f32_16x16x32_bf16 v[188:191], a[172:175], a[92:95], v[188:191]
  s_add_u32 s67, s69, 18432
  v_mfma_f32_16x16x32_bf16 v[188:191], a[156:159], a[64:67], v[188:191]
  v_mfma_f32_16x16x32_bf16 v[192:195], a[144:147], a[68:71], v[192:195]
  buffer_load_dwordx4 v123, s[36:39], s67 offen offset:3072 lds
  v_mfma_f32_16x16x32_bf16 v[192:195], a[160:163], a[96:99], v[192:195]
  v_mfma_f32_16x16x32_bf16 v[196:199], a[164:167], a[96:99], v[196:199]
  v_mfma_f32_16x16x32_bf16 v[196:199], a[148:151], a[68:71], v[196:199]
  s_waitcnt vmcnt(20) lgkmcnt(0)
  s_barrier
  v_mfma_f32_16x16x32_bf16 v[200:203], a[152:155], a[68:71], v[200:203]
  s_add_u32 m0, s62, 20480
  s_add_u32 s35, s35, 262144
  ds_read_b64_tr_b16 a[128:129], v116 offset:24576
  v_mfma_f32_16x16x32_bf16 v[200:203], a[168:171], a[96:99], v[200:203]
  s_cmp_lg_u32 s35, 3670016
  s_cselect_b32 s35, s35, 0
  s_add_u32 s66, s35, 0
  buffer_load_dwordx4 v120, s[48:51], s66 offen offset:0 lds
  v_mfma_f32_16x16x32_bf16 v[204:207], a[172:175], a[96:99], v[204:207]
  s_add_u32 s67, s35, 15360
  buffer_load_dwordx4 v121, s[48:51], s67 offen offset:1024 lds
  v_mfma_f32_16x16x32_bf16 v[204:207], a[156:159], a[68:71], v[204:207]
  s_add_u32 s66, s35, 30720
  ds_read_b64_tr_b16 a[130:131], v116 offset:26624
  v_mfma_f32_16x16x32_bf16 v[208:211], a[144:147], a[72:75], v[208:211]
  buffer_load_dwordx4 v120, s[48:51], s66 offen offset:2048 lds
  ds_read_b64_tr_b16 a[132:133], v117 offset:24576
  v_mfma_f32_16x16x32_bf16 v[208:211], a[160:163], a[100:103], v[208:211]
  s_add_u32 s67, s35, 46080
  ds_read_b64_tr_b16 a[134:135], v117 offset:26624
  v_mfma_f32_16x16x32_bf16 v[212:215], a[164:167], a[100:103], v[212:215]
  ds_read_b64_tr_b16 a[136:137], v118 offset:24576
  ds_read_b64_tr_b16 a[138:139], v118 offset:26624
  v_mfma_f32_16x16x32_bf16 v[212:215], a[148:151], a[72:75], v[212:215]
  buffer_load_dwordx4 v121, s[48:51], s67 offen offset:3072 lds
  s_add_u32 m0, s62, 0
  v_mfma_f32_16x16x32_bf16 v[216:219], a[152:155], a[72:75], v[216:219]
  s_mov_b32 s60, 0
  ds_read_b64_tr_b16 a[140:141], v119 offset:24576
  v_mfma_f32_16x16x32_bf16 v[216:219], a[168:171], a[100:103], v[216:219]
  buffer_load_dwordx4 v14, s[40:43], s60 offen offset:0 nt lds
  ds_read_b64_tr_b16 a[142:143], v119 offset:26624
  v_mfma_f32_16x16x32_bf16 v[220:223], a[172:175], a[100:103], v[220:223]
  ds_read_b128 a[28:31], v129 offset:16384
  ds_read_b128 a[32:35], v129 offset:18432
  v_mfma_f32_16x16x32_bf16 v[220:223], a[156:159], a[72:75], v[220:223]
  buffer_load_dwordx4 v15, s[40:43], s60 offen offset:1024 nt lds
  ds_read_b128 a[36:39], v129 offset:20480
  v_mfma_f32_16x16x32_bf16 v[224:227], a[144:147], a[76:79], v[224:227]
  ds_read_b128 a[40:43], v129 offset:22528
  ds_read_b128 a[44:47], v129 offset:24576
  v_mfma_f32_16x16x32_bf16 v[224:227], a[160:163], a[104:107], v[224:227]
  ds_read_b128 a[48:51], v129 offset:26624
  v_mfma_f32_16x16x32_bf16 v[228:231], a[164:167], a[104:107], v[228:231]
  buffer_load_dwordx4 v16, s[40:43], s60 offen offset:2048 nt lds
  ds_read_b128 a[52:55], v129 offset:28672
  v_mfma_f32_16x16x32_bf16 v[228:231], a[148:151], a[76:79], v[228:231]
  v_mfma_f32_16x16x32_bf16 v[232:235], a[152:155], a[76:79], v[232:235]
  buffer_load_dwordx4 v17, s[40:43], s60 offen offset:3072 nt lds
  v_mfma_f32_16x16x32_bf16 v[232:235], a[168:171], a[104:107], v[232:235]
  s_add_u32 m0, s62, 4096
  s_nop 0
  v_mfma_f32_16x16x32_bf16 v[236:239], a[172:175], a[104:107], v[236:239]
  buffer_load_dwordx4 v18, s[40:43], s60 offen offset:0 nt lds
  v_mfma_f32_16x16x32_bf16 v[236:239], a[156:159], a[76:79], v[236:239]
  v_mfma_f32_16x16x32_bf16 v[240:243], a[144:147], a[80:83], v[240:243]
  v_mfma_f32_16x16x32_bf16 v[240:243], a[160:163], a[108:111], v[240:243]
  buffer_load_dwordx4 v19, s[40:43], s60 offen offset:1024 nt lds
  v_mfma_f32_16x16x32_bf16 v[244:247], a[164:167], a[108:111], v[244:247]
  v_mfma_f32_16x16x32_bf16 v[244:247], a[148:151], a[80:83], v[244:247]
  buffer_load_dwordx4 v20, s[40:43], s60 offen offset:2048 nt lds
  v_mfma_f32_16x16x32_bf16 v[248:251], a[152:155], a[80:83], v[248:251]
  v_mfma_f32_16x16x32_bf16 v[248:251], a[168:171], a[108:111], v[248:251]
  buffer_load_dwordx4 v21, s[40:43], s60 offen offset:3072 nt lds
  v_mfma_f32_16x16x32_bf16 v[252:255], a[172:175], a[108:111], v[252:255]
  v_mfma_f32_16x16x32_bf16 v[252:255], a[156:159], a[80:83], v[252:255]
  s_waitcnt vmcnt(24) lgkmcnt(0)
  s_barrier
  v_mfma_f32_16x16x32_bf16 v[144:147], a[112:115], a[0:3], v[144:147]
  ds_read_b64_tr_b16 a[144:145], v116 offset:28672
  ds_read_b64_tr_b16 a[146:147], v116 offset:30720
  v_mfma_f32_16x16x32_bf16 v[144:147], a[128:131], a[28:31], v[144:147]
  ds_read_b64_tr_b16 a[148:149], v117 offset:28672
  v_mfma_f32_16x16x32_bf16 v[148:151], a[132:135], a[28:31], v[148:151]
  ds_read_b64_tr_b16 a[150:151], v117 offset:30720
  ds_read_b64_tr_b16 a[152:153], v118 offset:28672
  v_mfma_f32_16x16x32_bf16 v[148:151], a[116:119], a[0:3], v[148:151]
  ds_read_b64_tr_b16 a[154:155], v118 offset:30720
  v_mfma_f32_16x16x32_bf16 v[152:155], a[120:123], a[0:3], v[152:155]
  ds_read_b64_tr_b16 a[156:157], v119 offset:28672
  ds_read_b64_tr_b16 a[158:159], v119 offset:30720
  v_mfma_f32_16x16x32_bf16 v[152:155], a[136:139], a[28:31], v[152:155]
  ds_read_b128 a[56:59], v124 offset:8192
  v_mfma_f32_16x16x32_bf16 v[156:159], a[140:143], a[28:31], v[156:159]
  ds_read_b128 a[60:63], v124 offset:10240
  ds_read_b128 a[64:67], v124 offset:40960
  v_mfma_f32_16x16x32_bf16 v[156:159], a[124:127], a[0:3], v[156:159]
  ds_read_b128 a[68:71], v124 offset:43008
  v_mfma_f32_16x16x32_bf16 v[160:163], a[112:115], a[4:7], v[160:163]
  ds_read_b128 a[72:75], v126 offset:8192
  ds_read_b128 a[76:79], v126 offset:10240
  v_mfma_f32_16x16x32_bf16 v[160:163], a[128:131], a[32:35], v[160:163]
  ds_read_b128 a[80:83], v126 offset:40960
  v_mfma_f32_16x16x32_bf16 v[164:167], a[132:135], a[32:35], v[164:167]
  v_mfma_f32_16x16x32_bf16 v[164:167], a[116:119], a[4:7], v[164:167]
  v_mfma_f32_16x16x32_bf16 v[168:171], a[120:123], a[4:7], v[168:171]
  v_mfma_f32_16x16x32_bf16 v[168:171], a[136:139], a[32:35], v[168:171]
  v_mfma_f32_16x16x32_bf16 v[172:175], a[140:143], a[32:35], v[172:175]
  v_mfma_f32_16x16x32_bf16 v[172:175], a[124:127], a[4:7], v[172:175]
  v_mfma_f32_16x16x32_bf16 v[176:179], a[112:115], a[8:11], v[176:179]
  v_mfma_f32_16x16x32_bf16 v[176:179], a[128:131], a[36:39], v[176:179]
  v_mfma_f32_16x16x32_bf16 v[180:183], a[132:135], a[36:39], v[180:183]
  v_mfma_f32_16x16x32_bf16 v[180:183], a[116:119], a[8:11], v[180:183]
  v_mfma_f32_16x16x32_bf16 v[184:187], a[120:123], a[8:11], v[184:187]
  v_mfma_f32_16x16x32_bf16 v[184:187], a[136:139], a[36:39], v[184:187]
  v_mfma_f32_16x16x32_bf16 v[188:191], a[140:143], a[36:39], v[188:191]
  v_mfma_f32_16x16x32_bf16 v[188:191], a[124:127], a[8:11], v[188:191]
  v_mfma_f32_16x16x32_bf16 v[192:195], a[112:115], a[12:15], v[192:195]
  v_mfma_f32_16x16x32_bf16 v[192:195], a[128:131], a[40:43], v[192:195]
  v_mfma_f32_16x16x32_bf16 v[196:199], a[132:135], a[40:43], v[196:199]
  v_mfma_f32_16x16x32_bf16 v[196:199], a[116:119], a[12:15], v[196:199]
  s_waitcnt vmcnt(20) lgkmcnt(0)
  s_barrier
  v_mfma_f32_16x16x32_bf16 v[200:203], a[120:123], a[12:15], v[200:203]
  ds_read_b64_tr_b16 a[160:161], v116 offset:12288
  ds_read_b64_tr_b16 a[162:163], v116 offset:14336
  v_mfma_f32_16x16x32_bf16 v[200:203], a[136:139], a[40:43], v[200:203]
  ds_read_b64_tr_b16 a[164:165], v117 offset:12288
  v_mfma_f32_16x16x32_bf16 v[204:207], a[140:143], a[40:43], v[204:207]
  ds_read_b64_tr_b16 a[166:167], v117 offset:14336
  ds_read_b64_tr_b16 a[168:169], v118 offset:12288
  v_mfma_f32_16x16x32_bf16 v[204:207], a[124:127], a[12:15], v[204:207]
  ds_read_b64_tr_b16 a[170:171], v118 offset:14336
  v_mfma_f32_16x16x32_bf16 v[208:211], a[112:115], a[16:19], v[208:211]
  ds_read_b64_tr_b16 a[172:173], v119 offset:12288
  ds_read_b64_tr_b16 a[174:175], v119 offset:14336
  v_mfma_f32_16x16x32_bf16 v[208:211], a[128:131], a[44:47], v[208:211]
  ds_read_b128 a[84:87], v125 offset:8192
  v_mfma_f32_16x16x32_bf16 v[212:215], a[132:135], a[44:47], v[212:215]
  ds_read_b128 a[88:91], v125 offset:10240
  ds_read_b128 a[92:95], v125 offset:40960
  v_mfma_f32_16x16x32_bf16 v[212:215], a[116:119], a[16:19], v[212:215]
  ds_read_b128 a[96:99], v125 offset:43008
  v_mfma_f32_16x16x32_bf16 v[216:219], a[120:123], a[16:19], v[216:219]
  ds_read_b128 a[100:103], v127 offset:8192
  ds_read_b128 a[104:107], v127 offset:10240
  v_mfma_f32_16x16x32_bf16 v[216:219], a[136:139], a[44:47], v[216:219]
  ds_read_b128 a[108:111], v127 offset:40960
  v_mfma_f32_16x16x32_bf16 v[220:223], a[140:143], a[44:47], v[220:223]
  v_mfma_f32_16x16x32_bf16 v[220:223], a[124:127], a[16:19], v[220:223]
  v_mfma_f32_16x16x32_bf16 v[224:227], a[112:115], a[20:23], v[224:227]
  v_mfma_f32_16x16x32_bf16 v[224:227], a[128:131], a[48:51], v[224:227]
  v_mfma_f32_16x16x32_bf16 v[228:231], a[132:135], a[48:51], v[228:231]
  v_mfma_f32_16x16x32_bf16 v[228:231], a[116:119], a[20:23], v[228:231]
  v_mfma_f32_16x16x32_bf16 v[232:235], a[120:123], a[20:23], v[232:235]
  v_mfma_f32_16x16x32_bf16 v[232:235], a[136:139], a[48:51], v[232:235]
  v_mfma_f32_16x16x32_bf16 v[236:239], a[140:143], a[48:51], v[236:239]
  v_mfma_f32_16x16x32_bf16 v[236:239], a[124:127], a[20:23], v[236:239]
  v_mfma_f32_16x16x32_bf16 v[240:243], a[112:115], a[24:27], v[240:243]
  v_mfma_f32_16x16x32_bf16 v[240:243], a[128:131], a[52:55], v[240:243]
  v_mfma_f32_16x16x32_bf16 v[244:247], a[132:135], a[52:55], v[244:247]
  v_mfma_f32_16x16x32_bf16 v[244:247], a[116:119], a[24:27], v[244:247]
  v_mfma_f32_16x16x32_bf16 v[248:251], a[120:123], a[24:27], v[248:251]
  v_mfma_f32_16x16x32_bf16 v[248:251], a[136:139], a[52:55], v[248:251]
  v_mfma_f32_16x16x32_bf16 v[252:255], a[140:143], a[52:55], v[252:255]
  v_mfma_f32_16x16x32_bf16 v[252:255], a[124:127], a[24:27], v[252:255]
  s_waitcnt vmcnt(12) lgkmcnt(0)
  s_barrier
  v_mfma_f32_16x16x32_bf16 v[144:147], a[144:147], a[56:59], v[144:147]
  s_add_u32 m0, s62, 8192
  s_mov_b32 s60, 32768
  v_mfma_f32_16x16x32_bf16 v[144:147], a[160:163], a[84:87], v[144:147]
  ds_read_b64_tr_b16 a[112:113], v116 offset:16384
  ds_read_b64_tr_b16 a[114:115], v116 offset:18432
  v_mfma_f32_16x16x32_bf16 v[148:151], a[164:167], a[84:87], v[148:151]
  buffer_load_dwordx4 v14, s[40:43], s60 offen offset:0 nt lds
  ds_read_b64_tr_b16 a[116:117], v117 offset:16384
  v_mfma_f32_16x16x32_bf16 v[148:151], a[148:151], a[56:59], v[148:151]
  ds_read_b64_tr_b16 a[118:119], v117 offset:18432
  v_mbcnt_lo_u32_b32 v1, -1, 0
  v_mfma_f32_16x16x32_bf16 v[152:155], a[152:155], a[56:59], v[152:155]
  ds_read_b64_tr_b16 a[120:121], v118 offset:16384
  v_mbcnt_hi_u32_b32 v1, -1, v1
  v_mfma_f32_16x16x32_bf16 v[152:155], a[168:171], a[84:87], v[152:155]
  ds_read_b64_tr_b16 a[122:123], v118 offset:18432
  v_and_b32 v2, 15, v1
  v_mfma_f32_16x16x32_bf16 v[156:159], a[172:175], a[84:87], v[156:159]
  buffer_load_dwordx4 v15, s[40:43], s60 offen offset:1024 nt lds
  ds_read_b64_tr_b16 a[124:125], v119 offset:16384
  v_mfma_f32_16x16x32_bf16 v[156:159], a[156:159], a[56:59], v[156:159]
  buffer_load_dwordx4 v16, s[40:43], s60 offen offset:2048 nt lds
  v_lshrrev_b32 v3, 5, v1
  v_mfma_f32_16x16x32_bf16 v[160:163], a[144:147], a[60:63], v[160:163]
  ds_read_b64_tr_b16 a[126:127], v119 offset:18432
  v_lshl_add_u32 v2, v3, 4, v2
  v_mfma_f32_16x16x32_bf16 v[160:163], a[160:163], a[88:91], v[160:163]
  ds_read_b128 a[0:3], v128 offset:0
  v_bfe_u32 v3, v1, 4, 1
  v_mfma_f32_16x16x32_bf16 v[164:167], a[164:167], a[88:91], v[164:167]
  buffer_load_dwordx4 v17, s[40:43], s60 offen offset:3072 nt lds
  ds_read_b128 a[4:7], v128 offset:2048
  v_mfma_f32_16x16x32_bf16 v[164:167], a[148:151], a[60:63], v[164:167]
  ds_read_b128 a[8:11], v128 offset:4096
  v_lshl_add_u32 v2, v3, 5, v2
  v_mfma_f32_16x16x32_bf16 v[168:171], a[152:155], a[60:63], v[168:171]
  s_add_u32 m0, s62, 12288
  s_nop 0
  v_mfma_f32_16x16x32_bf16 v[168:171], a[168:171], a[88:91], v[168:171]
  ds_read_b128 a[12:15], v128 offset:6144
  v_lshlrev_b32 v2, 4, v2
  v_mfma_f32_16x16x32_bf16 v[172:175], a[172:175], a[88:91], v[172:175]
  s_mul_i32 s3, s34, 6144
  v_add_u32 v104, s62, v2
  v_mfma_f32_16x16x32_bf16 v[172:175], a[156:159], a[60:63], v[172:175]
  buffer_load_dwordx4 v18, s[40:43], s60 offen offset:0 nt lds
  ds_read_b128 a[16:19], v128 offset:8192
  v_mfma_f32_16x16x32_bf16 v[176:179], a[144:147], a[64:67], v[176:179]
  s_add_u32 s3, s3, 131072
  ds_read_b128 a[20:23], v128 offset:10240
  v_mfma_f32_16x16x32_bf16 v[176:179], a[160:163], a[92:95], v[176:179]
  buffer_load_dwordx4 v19, s[40:43], s60 offen offset:1024 nt lds
  v_add_u32 v105, s3, v2
  v_mfma_f32_16x16x32_bf16 v[180:183], a[164:167], a[92:95], v[180:183]
  ds_read_b128 a[24:27], v128 offset:12288
  v_mov_b32 v106, s64
  v_mfma_f32_16x16x32_bf16 v[180:183], a[148:151], a[64:67], v[180:183]
  v_mov_b32 v107, s64
  v_mfma_f32_16x16x32_bf16 v[184:187], a[152:155], a[64:67], v[184:187]
  v_mfma_f32_16x16x32_bf16 v[184:187], a[168:171], a[92:95], v[184:187]
  buffer_load_dwordx4 v20, s[40:43], s60 offen offset:2048 nt lds
  v_mfma_f32_16x16x32_bf16 v[188:191], a[172:175], a[92:95], v[188:191]
  v_mfma_f32_16x16x32_bf16 v[188:191], a[156:159], a[64:67], v[188:191]
  v_mfma_f32_16x16x32_bf16 v[192:195], a[144:147], a[68:71], v[192:195]
  buffer_load_dwordx4 v21, s[40:43], s60 offen offset:3072 nt lds
  v_mfma_f32_16x16x32_bf16 v[192:195], a[160:163], a[96:99], v[192:195]
  v_mfma_f32_16x16x32_bf16 v[196:199], a[164:167], a[96:99], v[196:199]
  v_mfma_f32_16x16x32_bf16 v[196:199], a[148:151], a[68:71], v[196:199]
  s_waitcnt vmcnt(16) lgkmcnt(0)
  s_barrier
  v_mfma_f32_16x16x32_bf16 v[200:203], a[152:155], a[68:71], v[200:203]
  ds_read_b64_tr_b16 a[128:129], v116 offset:20480
  ds_read_b64_tr_b16 a[130:131], v116 offset:22528
  v_mfma_f32_16x16x32_bf16 v[200:203], a[168:171], a[96:99], v[200:203]
  ds_read_b64_tr_b16 a[132:133], v117 offset:20480
  v_mfma_f32_16x16x32_bf16 v[204:207], a[172:175], a[96:99], v[204:207]
  ds_read_b64_tr_b16 a[134:135], v117 offset:22528
  ds_read_b64_tr_b16 a[136:137], v118 offset:20480
  v_mfma_f32_16x16x32_bf16 v[204:207], a[156:159], a[68:71], v[204:207]
  ds_read_b64_tr_b16 a[138:139], v118 offset:22528
  v_mfma_f32_16x16x32_bf16 v[208:211], a[144:147], a[72:75], v[208:211]
  ds_read_b64_tr_b16 a[140:141], v119 offset:20480
  ds_read_b64_tr_b16 a[142:143], v119 offset:22528
  v_mfma_f32_16x16x32_bf16 v[208:211], a[160:163], a[100:103], v[208:211]
  ds_read_b128 a[28:31], v129 offset:0
  v_mfma_f32_16x16x32_bf16 v[212:215], a[164:167], a[100:103], v[212:215]
  ds_read_b128 a[32:35], v129 offset:2048
  ds_read_b128 a[36:39], v129 offset:4096
  v_mfma_f32_16x16x32_bf16 v[212:215], a[148:151], a[72:75], v[212:215]
  ds_read_b128 a[40:43], v129 offset:6144
  v_mfma_f32_16x16x32_bf16 v[216:219], a[152:155], a[72:75], v[216:219]
  ds_read_b128 a[44:47], v129 offset:8192
  ds_read_b128 a[48:51], v129 offset:10240
  v_mfma_f32_16x16x32_bf16 v[216:219], a[168:171], a[100:103], v[216:219]
  ds_read_b128 a[52:55], v129 offset:12288
  v_mfma_f32_16x16x32_bf16 v[220:223], a[172:175], a[100:103], v[220:223]
  v_mfma_f32_16x16x32_bf16 v[220:223], a[156:159], a[72:75], v[220:223]
  v_mfma_f32_16x16x32_bf16 v[224:227], a[144:147], a[76:79], v[224:227]
  v_mfma_f32_16x16x32_bf16 v[224:227], a[160:163], a[104:107], v[224:227]
  v_mfma_f32_16x16x32_bf16 v[228:231], a[164:167], a[104:107], v[228:231]
  v_mfma_f32_16x16x32_bf16 v[228:231], a[148:151], a[76:79], v[228:231]
  v_mfma_f32_16x16x32_bf16 v[232:235], a[152:155], a[76:79], v[232:235]
  v_mfma_f32_16x16x32_bf16 v[232:235], a[168:171], a[104:107], v[232:235]
  v_mfma_f32_16x16x32_bf16 v[236:239], a[172:175], a[104:107], v[236:239]
  v_mfma_f32_16x16x32_bf16 v[236:239], a[156:159], a[76:79], v[236:239]
  v_mfma_f32_16x16x32_bf16 v[240:243], a[144:147], a[80:83], v[240:243]
  v_mfma_f32_16x16x32_bf16 v[240:243], a[160:163], a[108:111], v[240:243]
  v_mfma_f32_16x16x32_bf16 v[244:247], a[164:167], a[108:111], v[244:247]
  v_mfma_f32_16x16x32_bf16 v[244:247], a[148:151], a[80:83], v[244:247]
  v_mfma_f32_16x16x32_bf16 v[248:251], a[152:155], a[80:83], v[248:251]
  v_mfma_f32_16x16x32_bf16 v[248:251], a[168:171], a[108:111], v[248:251]
  v_mfma_f32_16x16x32_bf16 v[252:255], a[172:175], a[108:111], v[252:255]
  v_mfma_f32_16x16x32_bf16 v[252:255], a[156:159], a[80:83], v[252:255]
  s_waitcnt vmcnt(8) lgkmcnt(0)
  s_barrier
  v_mfma_f32_16x16x32_bf16 v[144:147], a[112:115], a[0:3], v[144:147]
  s_add_u32 m0, s62, 16384
  ds_read_b128 a[224:227], v4 offset:0
  ds_read_b128 a[228:231], v5 offset:0
  v_mfma_f32_16x16x32_bf16 v[144:147], a[128:131], a[28:31], v[144:147]
  s_mov_b32 s61, 0
  ds_read_b128 a[232:235], v6 offset:0
  buffer_load_dwordx4 v22, s[44:47], s61 offen offset:0 nt lds
  v_mfma_f32_16x16x32_bf16 v[148:151], a[132:135], a[28:31], v[148:151]
  ds_read_b128 a[236:239], v7 offset:0
  ds_read_b128 a[240:243], v4 offset:256
  v_mfma_f32_16x16x32_bf16 v[148:151], a[116:119], a[0:3], v[148:151]
  ds_read_b128 a[244:247], v5 offset:256
  v_mfma_f32_16x16x32_bf16 v[152:155], a[120:123], a[0:3], v[152:155]
  ds_read_b128 a[248:251], v6 offset:256
  ds_read_b128 a[252:255], v7 offset:256
  v_mfma_f32_16x16x32_bf16 v[152:155], a[136:139], a[28:31], v[152:155]
  v_mfma_f32_16x16x32_bf16 v[156:159], a[140:143], a[28:31], v[156:159]
  v_mfma_f32_16x16x32_bf16 v[156:159], a[124:127], a[0:3], v[156:159]
  buffer_load_dwordx4 v23, s[44:47], s61 offen offset:1024 nt lds
  v_mfma_f32_16x16x32_bf16 v[160:163], a[112:115], a[4:7], v[160:163]
  v_mfma_f32_16x16x32_bf16 v[160:163], a[128:131], a[32:35], v[160:163]
  v_mfma_f32_16x16x32_bf16 v[164:167], a[132:135], a[32:35], v[164:167]
  v_mul_f32 v144, s64, v144
  v_mul_f32 v145, s64, v145
  v_mul_f32 v146, s64, v146
  v_mul_f32 v147, s64, v147
  v_mul_f32 v148, s64, v148
  v_mul_f32 v149, s64, v149
  v_mfma_f32_16x16x32_bf16 v[164:167], a[116:119], a[4:7], v[164:167]
  v_mul_f32 v150, s64, v150
  v_mul_f32 v151, s64, v151
  v_cvt_pk_bf16_f32 v88, v144, v145
  v_mfma_f32_16x16x32_bf16 v[168:171], a[120:123], a[4:7], v[168:171]
  v_cvt_pk_bf16_f32 v89, v146, v147
  v_cvt_pk_bf16_f32 v90, v148, v149
  v_cvt_pk_bf16_f32 v91, v150, v151
  v_mfma_f32_16x16x32_bf16 v[168:171], a[136:139], a[32:35], v[168:171]
  v_mfma_f32_16x16x32_bf16 v[172:175], a[140:143], a[32:35], v[172:175]
  v_mul_f32 v152, s64, v152
  v_mul_f32 v153, s64, v153
  v_permlane16_swap_b32 v88, v90
  v_permlane16_swap_b32 v89, v91
  v_mul_f32 v154, s64, v154
  v_mul_f32 v155, s64, v155
  v_mfma_f32_16x16x32_bf16 v[172:175], a[124:127], a[4:7], v[172:175]
  v_mul_f32 v156, s64, v156
  v_mul_f32 v157, s64, v157
  v_mul_f32 v158, s64, v158
  v_mfma_f32_16x16x32_bf16 v[176:179], a[112:115], a[8:11], v[176:179]
  v_mul_f32 v159, s64, v159
  v_cvt_pk_bf16_f32 v92, v152, v153
  v_cvt_pk_bf16_f32 v93, v154, v155
  v_cvt_pk_bf16_f32 v94, v156, v157
  v_mfma_f32_16x16x32_bf16 v[176:179], a[128:131], a[36:39], v[176:179]
  buffer_load_dwordx4 v24, s[44:47], s61 offen offset:2048 nt lds
  v_cvt_pk_bf16_f32 v95, v158, v159
  v_mfma_f32_16x16x32_bf16 v[180:183], a[132:135], a[36:39], v[180:183]
  ds_write_b128 v104, v[88:91] offset:24576
  v_mul_f32 v160, s64, v160
  v_mul_f32 v161, s64, v161
  v_permlane16_swap_b32 v92, v94
  v_permlane16_swap_b32 v93, v95
  v_mul_f32 v162, s64, v162
  v_mfma_f32_16x16x32_bf16 v[180:183], a[116:119], a[8:11], v[180:183]
  v_mul_f32 v163, s64, v163
  v_mul_f32 v164, s64, v164
  v_mul_f32 v165, s64, v165
  v_mfma_f32_16x16x32_bf16 v[184:187], a[120:123], a[8:11], v[184:187]
  v_mul_f32 v166, s64, v166
  v_mul_f32 v167, s64, v167
  v_cvt_pk_bf16_f32 v96, v160, v161
  v_cvt_pk_bf16_f32 v97, v162, v163
  v_mfma_f32_16x16x32_bf16 v[184:187], a[136:139], a[36:39], v[184:187]
  buffer_load_dwordx4 v25, s[44:47], s61 offen offset:3072 nt lds
  v_cvt_pk_bf16_f32 v98, v164, v165
  v_cvt_pk_bf16_f32 v99, v166, v167
  v_mfma_f32_16x16x32_bf16 v[188:191], a[140:143], a[36:39], v[188:191]
  ds_write_b128 v104, v[92:95] offset:25600
  v_mul_f32 v168, s64, v168
  v_mul_f32 v169, s64, v169
  v_permlane16_swap_b32 v96, v98
  v_mfma_f32_16x16x32_bf16 v[188:191], a[124:127], a[8:11], v[188:191]
  v_permlane16_swap_b32 v97, v99
  v_mul_f32 v170, s64, v170
  v_mul_f32 v171, s64, v171
  v_mul_f32 v172, s64, v172
  v_mfma_f32_16x16x32_bf16 v[192:195], a[112:115], a[12:15], v[192:195]
  v_mul_f32 v173, s64, v173
  v_mul_f32 v174, s64, v174
  v_mul_f32 v175, s64, v175
  v_cvt_pk_bf16_f32 v100, v168, v169
  v_mfma_f32_16x16x32_bf16 v[192:195], a[128:131], a[40:43], v[192:195]
  v_cvt_pk_bf16_f32 v101, v170, v171
  v_cvt_pk_bf16_f32 v102, v172, v173
  v_cvt_pk_bf16_f32 v103, v174, v175
  v_mfma_f32_16x16x32_bf16 v[196:199], a[132:135], a[40:43], v[196:199]
  ds_write_b128 v104, v[96:99] offset:26624
  v_mul_f32 v176, s64, v176
  v_mul_f32 v177, s64, v177
  v_permlane16_swap_b32 v100, v102
  v_mfma_f32_16x16x32_bf16 v[196:199], a[116:119], a[12:15], v[196:199]
  v_permlane16_swap_b32 v101, v103
  v_mul_f32 v178, s64, v178
  v_mul_f32 v179, s64, v179
  v_mul_f32 v180, s64, v180
  v_mfma_f32_16x16x32_bf16 v[200:203], a[120:123], a[12:15], v[200:203]
  v_mul_f32 v181, s64, v181
  v_mul_f32 v182, s64, v182
  v_mul_f32 v183, s64, v183
  v_mfma_f32_16x16x32_bf16 v[200:203], a[136:139], a[40:43], v[200:203]
  v_cvt_pk_bf16_f32 v88, v176, v177
  v_cvt_pk_bf16_f32 v89, v178, v179
  v_cvt_pk_bf16_f32 v90, v180, v181
  v_cvt_pk_bf16_f32 v91, v182, v183
  v_mfma_f32_16x16x32_bf16 v[204:207], a[140:143], a[40:43], v[204:207]
  ds_write_b128 v104, v[100:103] offset:27648
  v_mul_f32 v184, s64, v184
  v_mul_f32 v185, s64, v185
  v_permlane16_swap_b32 v88, v90
  v_mfma_f32_16x16x32_bf16 v[204:207], a[124:127], a[12:15], v[204:207]
  v_permlane16_swap_b32 v89, v91
  v_mul_f32 v186, s64, v186
  v_mul_f32 v187, s64, v187
  v_mul_f32 v188, s64, v188
  v_mfma_f32_16x16x32_bf16 v[208:211], a[112:115], a[16:19], v[208:211]
  v_mul_f32 v189, s64, v189
  v_mul_f32 v190, s64, v190
  v_mul_f32 v191, s64, v191
  v_mfma_f32_16x16x32_bf16 v[208:211], a[128:131], a[44:47], v[208:211]
  v_cvt_pk_bf16_f32 v92, v184, v185
  v_cvt_pk_bf16_f32 v93, v186, v187
  v_cvt_pk_bf16_f32 v94, v188, v189
  v_cvt_pk_bf16_f32 v95, v190, v191
  v_mfma_f32_16x16x32_bf16 v[212:215], a[132:135], a[44:47], v[212:215]
  s_add_u32 m0, s62, 20480
  s_add_u32 s66, s61, 16384
  buffer_load_dwordx4 v22, s[44:47], s66 offen offset:0 nt lds
  ds_write_b128 v104, v[88:91] offset:28672
  v_mfma_f32_16x16x32_bf16 v[212:215], a[116:119], a[16:19], v[212:215]
  v_mul_f32 v192, s64, v192
  v_mul_f32 v193, s64, v193
  v_permlane16_swap_b32 v92, v94
  v_mfma_f32_16x16x32_bf16 v[216:219], a[120:123], a[16:19], v[216:219]
  v_permlane16_swap_b32 v93, v95
  v_mul_f32 v194, s64, v194
  v_mul_f32 v195, s64, v195
  v_mul_f32 v196, s64, v196
  v_mfma_f32_16x16x32_bf16 v[216:219], a[136:139], a[44:47], v[216:219]
  v_mul_f32 v197, s64, v197
  v_mul_f32 v198, s64, v198
  v_mul_f32 v199, s64, v199
  v_cvt_pk_bf16_f32 v96, v192, v193
  v_mfma_f32_16x16x32_bf16 v[220:223], a[140:143], a[44:47], v[220:223]
  v_cvt_pk_bf16_f32 v97, v194, v195
  v_cvt_pk_bf16_f32 v98, v196, v197
  v_cvt_pk_bf16_f32 v99, v198, v199
  v_mfma_f32_16x16x32_bf16 v[220:223], a[124:127], a[16:19], v[220:223]
  ds_write_b128 v104, v[92:95] offset:29696
  v_mul_f32 v200, s64, v200
  v_mul_f32 v201, s64, v201
  v_permlane16_swap_b32 v96, v98
  v_mfma_f32_16x16x32_bf16 v[224:227], a[112:115], a[20:23], v[224:227]
  v_permlane16_swap_b32 v97, v99
  v_mul_f32 v202, s64, v202
  v_mul_f32 v203, s64, v203
  v_mul_f32 v204, s64, v204
  v_mfma_f32_16x16x32_bf16 v[224:227], a[128:131], a[48:51], v[224:227]
  buffer_load_dwordx4 v23, s[44:47], s66 offen offset:1024 nt lds
  v_mul_f32 v205, s64, v205
  v_mul_f32 v206, s64, v206
  v_mfma_f32_16x16x32_bf16 v[228:231], a[132:135], a[48:51], v[228:231]
  v_mul_f32 v207, s64, v207
  v_cvt_pk_bf16_f32 v100, v200, v201
  v_cvt_pk_bf16_f32 v101, v202, v203
  v_cvt_pk_bf16_f32 v102, v204, v205
  v_mfma_f32_16x16x32_bf16 v[228:231], a[116:119], a[20:23], v[228:231]
  buffer_load_dwordx4 v24, s[44:47], s66 offen offset:2048 nt lds
  v_cvt_pk_bf16_f32 v103, v206, v207
  v_mfma_f32_16x16x32_bf16 v[232:235], a[120:123], a[20:23], v[232:235]
  ds_write_b128 v104, v[96:99] offset:30720
  v_mul_f32 v208, s64, v208
  v_mul_f32 v209, s64, v209
  v_permlane16_swap_b32 v100, v102
  v_permlane16_swap_b32 v101, v103
  v_mul_f32 v210, s64, v210
  v_mfma_f32_16x16x32_bf16 v[232:235], a[136:139], a[48:51], v[232:235]
  v_mul_f32 v211, s64, v211
  v_mul_f32 v212, s64, v212
  v_mul_f32 v213, s64, v213
  v_mfma_f32_16x16x32_bf16 v[236:239], a[140:143], a[48:51], v[236:239]
  v_mul_f32 v214, s64, v214
  v_mul_f32 v215, s64, v215
  v_cvt_pk_bf16_f32 v88, v208, v209
  v_cvt_pk_bf16_f32 v89, v210, v211
  v_mfma_f32_16x16x32_bf16 v[236:239], a[124:127], a[20:23], v[236:239]
  v_cvt_pk_bf16_f32 v90, v212, v213
  v_cvt_pk_bf16_f32 v91, v214, v215
  v_mfma_f32_16x16x32_bf16 v[240:243], a[112:115], a[24:27], v[240:243]
  ds_write_b128 v104, v[100:103] offset:31744
  v_mul_f32 v216, s64, v216
  v_mul_f32 v217, s64, v217
  v_permlane16_swap_b32 v88, v90
  v_permlane16_swap_b32 v89, v91
  v_mfma_f32_16x16x32_bf16 v[240:243], a[128:131], a[52:55], v[240:243]
  v_mul_f32 v218, s64, v218
  v_mul_f32 v219, s64, v219
  v_mul_f32 v220, s64, v220
  v_mul_f32 v221, s64, v221
  v_mfma_f32_16x16x32_bf16 v[244:247], a[132:135], a[52:55], v[244:247]
  v_mul_f32 v222, s64, v222
  v_mul_f32 v223, s64, v223
  v_cvt_pk_bf16_f32 v92, v216, v217
  v_cvt_pk_bf16_f32 v93, v218, v219
  v_mfma_f32_16x16x32_bf16 v[244:247], a[116:119], a[24:27], v[244:247]
  buffer_load_dwordx4 v25, s[44:47], s66 offen offset:3072 nt lds
  v_cvt_pk_bf16_f32 v94, v220, v221
  v_cvt_pk_bf16_f32 v95, v222, v223
  v_mfma_f32_16x16x32_bf16 v[248:251], a[120:123], a[24:27], v[248:251]
  ds_write_b128 v105, v[88:91] offset:0
  v_mul_f32 v224, s64, v224
  v_mul_f32 v225, s64, v225
  v_permlane16_swap_b32 v92, v94
  v_mfma_f32_16x16x32_bf16 v[248:251], a[136:139], a[52:55], v[248:251]
  v_permlane16_swap_b32 v93, v95
  v_mul_f32 v226, s64, v226
  v_mul_f32 v227, s64, v227
  v_mul_f32 v228, s64, v228
  v_mfma_f32_16x16x32_bf16 v[252:255], a[140:143], a[52:55], v[252:255]
  v_mul_f32 v229, s64, v229
  v_mul_f32 v230, s64, v230
  v_mul_f32 v231, s64, v231
  v_mfma_f32_16x16x32_bf16 v[252:255], a[124:127], a[24:27], v[252:255]
  v_cvt_pk_bf16_f32 v96, v224, v225
  v_cvt_pk_bf16_f32 v97, v226, v227
  v_cvt_pk_bf16_f32 v98, v228, v229
  v_cvt_pk_bf16_f32 v99, v230, v231
  ds_write_b128 v105, v[92:95] offset:1024
  s_nop 1
  v_pk_mul_f32 v[232:233], v[232:233], v[106:107]
  v_pk_mul_f32 v[234:235], v[234:235], v[106:107]
  v_permlane16_swap_b32 v96, v98
  v_permlane16_swap_b32 v97, v99
  v_pk_mul_f32 v[236:237], v[236:237], v[106:107]
  ds_write_b128 v105, v[96:99] offset:2048
  v_pk_mul_f32 v[238:239], v[238:239], v[106:107]
  v_cvt_pk_bf16_f32 v100, v232, v233
  v_cvt_pk_bf16_f32 v101, v234, v235
  v_cvt_pk_bf16_f32 v102, v236, v237
  v_cvt_pk_bf16_f32 v103, v238, v239
  v_pk_mul_f32 v[240:241], v[240:241], v[106:107]
  v_pk_mul_f32 v[242:243], v[242:243], v[106:107]
  v_permlane16_swap_b32 v100, v102
  v_permlane16_swap_b32 v101, v103
  v_pk_mul_f32 v[244:245], v[244:245], v[106:107]
  ds_write_b128 v105, v[100:103] offset:3072
  v_pk_mul_f32 v[246:247], v[246:247], v[106:107]
  v_cvt_pk_bf16_f32 v88, v240, v241
  v_cvt_pk_bf16_f32 v89, v242, v243
  v_cvt_pk_bf16_f32 v90, v244, v245
  v_cvt_pk_bf16_f32 v91, v246, v247
  v_pk_mul_f32 v[248:249], v[248:249], v[106:107]
  v_pk_mul_f32 v[250:251], v[250:251], v[106:107]
  v_permlane16_swap_b32 v88, v90
  v_permlane16_swap_b32 v89, v91
  v_pk_mul_f32 v[252:253], v[252:253], v[106:107]
  ds_write_b128 v105, v[88:91] offset:4096
  v_pk_mul_f32 v[254:255], v[254:255], v[106:107]
  v_cvt_pk_bf16_f32 v92, v248, v249
  v_cvt_pk_bf16_f32 v93, v250, v251
  v_cvt_pk_bf16_f32 v94, v252, v253
  v_cvt_pk_bf16_f32 v95, v254, v255
  s_nop 1
  v_permlane16_swap_b32 v92, v94
  v_permlane16_swap_b32 v93, v95
  ds_write_b128 v105, v[92:95] offset:5120
  s_waitcnt lgkmcnt(0)
  s_cmp_eq_u32 s70, 0
  s_cbranch_scc0 L_safe
L_safe_ret0:
  s_barrier
  ds_read_b128 a[0:3], v48 offset:24576
  ds_read_b128 a[4:7], v48 offset:25600
  ds_read_b128 a[8:11], v48 offset:57344
  ds_read_b128 a[12:15], v48 offset:58368
  ds_read_b128 a[16:19], v49 offset:24576
  ds_read_b128 a[20:23], v49 offset:25600
  ds_read_b128 a[24:27], v49 offset:57344
  ds_read_b128 a[28:31], v49 offset:58368
  ds_read_b128 a[32:35], v48 offset:26624
  ds_read_b128 a[36:39], v48 offset:27648
  ds_read_b128 a[40:43], v48 offset:59392
  ds_read_b128 a[44:47], v48 offset:60416
  ds_read_b128 a[48:51], v49 offset:26624
  ds_read_b128 a[52:55], v49 offset:27648
  s_waitcnt lgkmcnt(10)
  v_mfma_f32_16x16x32_bf16 v[144:147], a[224:227], a[0:3], 0
  ds_read_b128 a[56:59], v49 offset:59392
  ds_read_b128 a[60:63], v49 offset:60416
  v_mfma_f32_16x16x32_bf16 v[144:147], a[228:231], a[4:7], v[144:147]
  ds_read_b128 a[64:67], v48 offset:28672
  v_and_b32 v2, 15, v1
  v_lshlrev_b32 v2, 4, v2
  v_mfma_f32_16x16x32_bf16 v[144:147], a[232:235], a[8:11], v[144:147]
  ds_read_b128 a[68:71], v48 offset:29696
  v_add_u32 v2, 159744, v2
  v_mfma_f32_16x16x32_bf16 v[144:147], a[236:239], a[12:15], v[144:147]
  s_waitcnt lgkmcnt(9)
  s_add_u32 m0, s62, 0
  ds_read_b128 a[72:75], v48 offset:61440
  v_mfma_f32_16x16x32_bf16 v[144:147], a[240:243], a[16:19], v[144:147]
  s_mov_b32 s60, 65536
  buffer_load_dwordx4 v14, s[40:43], s60 offen offset:0 nt lds
  v_mfma_f32_16x16x32_bf16 v[144:147], a[244:247], a[20:23], v[144:147]
  ds_read_b128 a[76:79], v48 offset:62464
  ds_read_b128 a[80:83], v49 offset:28672
  v_mfma_f32_16x16x32_bf16 v[144:147], a[248:251], a[24:27], v[144:147]
  ds_read_b128 a[84:87], v49 offset:29696
  s_lshl_b32 s3, s34, 2
  v_add_u32 v3, s3, v2
  v_mfma_f32_16x16x32_bf16 v[144:147], a[252:255], a[28:31], v[144:147]
  s_waitcnt lgkmcnt(9)
  ds_read_b128 a[88:91], v49 offset:61440
  v_mfma_f32_16x16x32_bf16 v[148:151], a[224:227], a[32:35], 0
  ds_read_b128 a[92:95], v49 offset:62464
  ds_read_b128 a[96:99], v48 offset:30720
  v_mov_b32 v33, 0
  v_mfma_f32_16x16x32_bf16 v[148:151], a[228:231], a[36:39], v[148:151]
  ds_read_b128 a[100:103], v48 offset:31744
  v_mov_b32 v34, 0
  v_mfma_f32_16x16x32_bf16 v[148:151], a[232:235], a[40:43], v[148:151]
  buffer_load_dwordx4 v15, s[40:43], s60 offen offset:1024 nt lds
  v_mov_b32 v35, 0
  v_mfma_f32_16x16x32_bf16 v[148:151], a[236:239], a[44:47], v[148:151]
  s_waitcnt lgkmcnt(9)
  ds_read_b128 a[104:107], v48 offset:63488
  v_mov_b32 v36, 0
  v_mfma_f32_16x16x32_bf16 v[148:151], a[240:243], a[48:51], v[148:151]
  ds_read_b128 a[108:111], v48 offset:64512
  v_mov_b32 v37, 0
  v_mfma_f32_16x16x32_bf16 v[148:151], a[244:247], a[52:55], v[148:151]
  ds_read_b128 a[112:115], v49 offset:30720
  ds_read_b128 a[116:119], v49 offset:31744
  v_mov_b32 v38, 0
  v_mfma_f32_16x16x32_bf16 v[148:151], a[248:251], a[56:59], v[148:151]
  buffer_load_dwordx4 v16, s[40:43], s60 offen offset:2048 nt lds
  v_mov_b32 v39, 0
  v_mfma_f32_16x16x32_bf16 v[148:151], a[252:255], a[60:63], v[148:151]
  s_waitcnt lgkmcnt(9)
  ds_read_b128 a[120:123], v49 offset:63488
  v_mfma_f32_16x16x32_bf16 v[152:155], a[224:227], a[64:67], 0
  ds_read_b128 a[124:127], v49 offset:64512
  ds_read_b128 a[128:131], v50 offset:0
  buffer_load_dwordx4 v17, s[40:43], s60 offen offset:3072 nt lds
  v_mfma_f32_16x16x32_bf16 v[152:155], a[228:231], a[68:71], v[152:155]
  ds_read_b128 a[132:135], v50 offset:1024
  v_mfma_f32_16x16x32_bf16 v[152:155], a[232:235], a[72:75], v[152:155]
  v_mfma_f32_16x16x32_bf16 v[152:155], a[236:239], a[76:79], v[152:155]
  s_waitcnt lgkmcnt(9)
  ds_read_b128 a[136:139], v50 offset:6144
  ds_read_b128 a[140:143], v50 offset:7168
  ds_read_b128 a[144:147], v50 offset:12288
  v_mfma_f32_16x16x32_bf16 v[152:155], a[240:243], a[80:83], v[152:155]
  s_add_u32 m0, s62, 4096
  s_nop 0
  v_mfma_f32_16x16x32_bf16 v[152:155], a[244:247], a[84:87], v[152:155]
  ds_read_b128 a[148:151], v50 offset:13312
  v_mfma_f32_16x16x32_bf16 v[152:155], a[248:251], a[88:91], v[152:155]
  buffer_load_dwordx4 v18, s[40:43], s60 offen offset:0 nt lds
  v_mfma_f32_16x16x32_bf16 v[152:155], a[252:255], a[92:95], v[152:155]
  s_waitcnt lgkmcnt(9)
  ds_read_b128 a[152:155], v50 offset:18432
  ds_read_b128 a[156:159], v50 offset:19456
  ds_read_b128 a[160:163], v50 offset:2048
  v_mfma_f32_16x16x32_bf16 v[156:159], a[224:227], a[96:99], 0
  v_mfma_f32_16x16x32_bf16 v[156:159], a[228:231], a[100:103], v[156:159]
  ds_read_b128 a[164:167], v50 offset:3072
  v_mfma_f32_16x16x32_bf16 v[156:159], a[232:235], a[104:107], v[156:159]
  v_mfma_f32_16x16x32_bf16 v[156:159], a[236:239], a[108:111], v[156:159]
  s_waitcnt lgkmcnt(9)
  ds_read_b128 a[168:171], v50 offset:8192
  ds_read_b128 a[172:175], v50 offset:9216
  ds_read_b128 a[176:179], v50 offset:14336
  buffer_load_dwordx4 v19, s[40:43], s60 offen offset:1024 nt lds
  v_mfma_f32_16x16x32_bf16 v[156:159], a[240:243], a[112:115], v[156:159]
  v_mfma_f32_16x16x32_bf16 v[156:159], a[244:247], a[116:119], v[156:159]
  ds_read_b128 a[180:183], v50 offset:15360
  v_mfma_f32_16x16x32_bf16 v[156:159], a[248:251], a[120:123], v[156:159]
  v_mfma_f32_16x16x32_bf16 v[156:159], a[252:255], a[124:127], v[156:159]
  s_waitcnt lgkmcnt(9)
  v_max3_f32 v40, v40, v144, v145
  v_max3_f32 v40, v40, v146, v147
  v_max3_f32 v41, v41, v148, v149
  v_max3_f32 v41, v41, v150, v151
  v_mfma_f32_16x16x32_bf16 v[160:163], a[224:227], a[128:131], 0
  ds_read_b128 a[184:187], v50 offset:20480
  v_max3_f32 v42, v42, v152, v153
  v_max3_f32 v42, v42, v154, v155
  v_mfma_f32_16x16x32_bf16 v[160:163], a[228:231], a[132:135], v[160:163]
  ds_read_b128 a[188:191], v50 offset:21504
  v_mov_b32 v88, v40
  v_mov_b32 v89, v41
  v_mfma_f32_16x16x32_bf16 v[160:163], a[232:235], a[136:139], v[160:163]
  ds_read_b128 a[192:195], v50 offset:4096
  v_mov_b32 v90, v42
  v_mfma_f32_16x16x32_bf16 v[160:163], a[236:239], a[140:143], v[160:163]
  ds_read_b128 a[196:199], v50 offset:5120
  s_waitcnt lgkmcnt(9)
  v_permlane32_swap_b32 v40, v88
  v_mfma_f32_16x16x32_bf16 v[160:163], a[240:243], a[144:147], v[160:163]
  ds_read_b128 a[200:203], v50 offset:10240
  v_permlane32_swap_b32 v41, v89
  v_permlane32_swap_b32 v42, v90
  v_mfma_f32_16x16x32_bf16 v[160:163], a[244:247], a[148:151], v[160:163]
  ds_read_b128 a[204:207], v50 offset:11264
  buffer_load_dwordx4 v20, s[40:43], s60 offen offset:2048 nt lds
  v_max_f32 v40, v40, v88
  v_mfma_f32_16x16x32_bf16 v[160:163], a[248:251], a[152:155], v[160:163]
  ds_read_b128 a[208:211], v50 offset:16384
  v_max_f32 v41, v41, v89
  v_max_f32 v42, v42, v90
  v_mfma_f32_16x16x32_bf16 v[160:163], a[252:255], a[156:159], v[160:163]
  ds_read_b128 a[212:215], v50 offset:17408
  s_waitcnt lgkmcnt(9)
  v_mov_b32 v88, v40
  v_mfma_f32_16x16x32_bf16 v[164:167], a[224:227], a[160:163], 0
  ds_read_b128 a[216:219], v50 offset:22528
  v_mov_b32 v89, v41
  v_mfma_f32_16x16x32_bf16 v[164:167], a[228:231], a[164:167], v[164:167]
  ds_read_b128 a[220:223], v50 offset:23552
  v_mov_b32 v90, v42
  v_permlane16_swap_b32 v40, v88
  v_mfma_f32_16x16x32_bf16 v[164:167], a[232:235], a[168:171], v[164:167]
  v_permlane16_swap_b32 v41, v89
  v_permlane16_swap_b32 v42, v90
  v_max_f32 v40, v40, v88
  v_mfma_f32_16x16x32_bf16 v[164:167], a[236:239], a[172:175], v[164:167]
  buffer_load_dwordx4 v21, s[40:43], s60 offen offset:3072 nt lds
  v_max_f32 v41, v41, v89
  v_max_f32 v42, v42, v90
  v_mfma_f32_16x16x32_bf16 v[164:167], a[240:243], a[176:179], v[164:167]
  ds_write_b32 v3, v40 offset:0
  ds_write_b32 v3, v41 offset:256
  ds_write_b32 v3, v42 offset:512
  s_waitcnt lgkmcnt(13)
  v_mfma_f32_16x16x32_bf16 v[164:167], a[244:247], a[180:183], v[164:167]
  s_waitcnt lgkmcnt(12)
  v_mfma_f32_16x16x32_bf16 v[164:167], a[248:251], a[184:187], v[164:167]
  s_waitcnt lgkmcnt(11)
  v_mfma_f32_16x16x32_bf16 v[164:167], a[252:255], a[188:191], v[164:167]
  v_max3_f32 v43, v43, v156, v157
  v_max3_f32 v43, v43, v158, v159
  v_max3_f32 v44, v44, v160, v161
  v_max3_f32 v44, v44, v162, v163
  v_mov_b32 v91, v43
  s_waitcnt lgkmcnt(10)
  v_mfma_f32_16x16x32_bf16 v[168:171], a[224:227], a[192:195], 0
  s_waitcnt vmcnt(16)
  ds_read_b128 a[224:227], v4 offset:8192
  s_waitcnt lgkmcnt(10)
  v_mfma_f32_16x16x32_bf16 v[168:171], a[228:231], a[196:199], v[168:171]
  ds_read_b128 a[228:231], v5 offset:8192
  v_mov_b32 v92, v44
  s_nop 1
  v_permlane32_swap_b32 v43, v91
  s_waitcnt lgkmcnt(10)
  v_mfma_f32_16x16x32_bf16 v[168:171], a[232:235], a[200:203], v[168:171]
  v_permlane32_swap_b32 v44, v92
  v_max_f32 v43, v43, v91
  v_max_f32 v44, v44, v92
  s_waitcnt lgkmcnt(9)
  v_mfma_f32_16x16x32_bf16 v[168:171], a[236:239], a[204:207], v[168:171]
  ds_read_b128 a[232:235], v6 offset:8192
  ds_read_b128 a[236:239], v7 offset:8192
  v_mov_b32 v91, v43
  s_waitcnt lgkmcnt(10)
  v_mfma_f32_16x16x32_bf16 v[168:171], a[240:243], a[208:211], v[168:171]
  ds_read_b128 a[240:243], v4 offset:8448
  v_mov_b32 v92, v44
  s_nop 1
  s_waitcnt lgkmcnt(10)
  v_mfma_f32_16x16x32_bf16 v[168:171], a[244:247], a[212:215], v[168:171]
  v_permlane16_swap_b32 v43, v91
  v_permlane16_swap_b32 v44, v92
  v_max_f32 v43, v43, v91
  s_waitcnt lgkmcnt(9)
  v_mfma_f32_16x16x32_bf16 v[168:171], a[248:251], a[216:219], v[168:171]
  ds_read_b128 a[244:247], v5 offset:8448
  ds_read_b128 a[248:251], v6 offset:8448
  v_max_f32 v44, v44, v92
  s_waitcnt lgkmcnt(10)
  v_mfma_f32_16x16x32_bf16 v[168:171], a[252:255], a[220:223], v[168:171]
  ds_write_b32 v3, v43 offset:768
  ds_read_b128 a[252:255], v7 offset:8448
  ds_write_b32 v3, v44 offset:1024
  s_nop 3
  v_max3_f32 v45, v45, v164, v165
  v_max3_f32 v45, v45, v166, v167
  v_max3_f32 v46, v46, v168, v169
  v_max3_f32 v46, v46, v170, v171
  v_mov_b32 v93, v45
  v_mov_b32 v94, v46
  s_nop 1
  v_permlane32_swap_b32 v45, v93
  v_permlane32_swap_b32 v46, v94
  v_max_f32 v45, v45, v93
  v_max_f32 v46, v46, v94
  v_mov_b32 v93, v45
  v_mov_b32 v94, v46
  s_nop 1
  v_permlane16_swap_b32 v45, v93
  v_permlane16_swap_b32 v46, v94
  v_max_f32 v45, v45, v93
  v_max_f32 v46, v46, v94
  ds_write_b32 v3, v45 offset:1280
  ds_write_b32 v3, v46 offset:1536
  s_waitcnt lgkmcnt(0)
  s_barrier
  ds_read_b128 v[88:91], v2 offset:0
  ds_read_b128 v[92:95], v2 offset:256
  ds_read_b128 v[96:99], v2 offset:512
  ds_read_b128 v[100:103], v2 offset:768
  ds_read_b128 v[104:107], v2 offset:1024
  ds_read_b128 v[108:111], v2 offset:1280
  ds_read_b128 v[112:115], v2 offset:1536
  s_waitcnt lgkmcnt(6)
  v_max3_f32 v88, v88, v89, v90
  v_max_f32 v88, v88, v91
  v_sub_f32 v88, 0, v88
  v_mov_b32 v89, v88
  v_mov_b32 v90, v88
  v_mov_b32 v91, v88
  s_waitcnt lgkmcnt(5)
  v_max3_f32 v92, v92, v93, v94
  v_max_f32 v92, v92, v95
  v_sub_f32 v92, 0, v92
  v_mov_b32 v93, v92
  v_mov_b32 v94, v92
  v_mov_b32 v95, v92
  s_nop 0
  v_mfma_f32_16x16x32_bf16 v[116:119], a[224:227], a[0:3], v[88:91]
  v_add_f32 v144, v144, v88
  v_add_f32 v145, v145, v88
  v_add_f32 v146, v146, v88
  v_add_f32 v147, v147, v88
  v_mfma_f32_16x16x32_bf16 v[116:119], a[228:231], a[4:7], v[116:119]
  s_add_u32 m0, s62, 24576
  v_exp_f32 v144, v144
  v_mfma_f32_16x16x32_bf16 v[116:119], a[232:235], a[8:11], v[116:119]
  s_mov_b32 s61, 32768
  buffer_load_dwordx4 v22, s[44:47], s61 offen offset:0 nt lds
  v_exp_f32 v145, v145
  v_mfma_f32_16x16x32_bf16 v[116:119], a[236:239], a[12:15], v[116:119]
  v_exp_f32 v146, v146
  v_cvt_pk_bf16_f32 v26, v144, v145
  s_waitcnt lgkmcnt(4)
  v_max3_f32 v96, v96, v97, v98
  v_mfma_f32_16x16x32_bf16 v[116:119], a[240:243], a[16:19], v[116:119]
  v_exp_f32 v147, v147
  v_add_f32 v33, v33, v144
  v_mfma_f32_16x16x32_bf16 v[116:119], a[244:247], a[20:23], v[116:119]
  v_cvt_pk_bf16_f32 v27, v146, v147
  v_add_f32 v33, v33, v145
  v_max_f32 v96, v96, v99
  v_sub_f32 v96, 0, v96
  v_mfma_f32_16x16x32_bf16 v[116:119], a[248:251], a[24:27], v[116:119]
  buffer_load_dwordx4 v23, s[44:47], s61 offen offset:1024 nt lds
  ds_write_b64 v12, v[26:27] offset:0
  v_add_f32 v33, v33, v146
  v_mfma_f32_16x16x32_bf16 v[116:119], a[252:255], a[28:31], v[116:119]
  v_add_f32 v33, v33, v147
  v_add_f32 v148, v148, v92
  v_add_f32 v149, v149, v92
  v_add_f32 v150, v150, v92
  v_mfma_f32_16x16x32_bf16 v[120:123], a[224:227], a[32:35], v[92:95]
  v_add_f32 v151, v151, v92
  v_mov_b32 v97, v96
  v_exp_f32 v148, v148
  v_mfma_f32_16x16x32_bf16 v[120:123], a[228:231], a[36:39], v[120:123]
  buffer_load_dwordx4 v24, s[44:47], s61 offen offset:2048 nt lds
  v_mov_b32 v98, v96
  v_mov_b32 v99, v96
  v_mfma_f32_16x16x32_bf16 v[120:123], a[232:235], a[40:43], v[120:123]
  v_exp_f32 v149, v149
  v_exp_f32 v150, v150
  v_mfma_f32_16x16x32_bf16 v[120:123], a[236:239], a[44:47], v[120:123]
  v_cvt_pk_bf16_f32 v28, v148, v149
  s_waitcnt lgkmcnt(4)
  v_max3_f32 v100, v100, v101, v102
  v_exp_f32 v151, v151
  v_mfma_f32_16x16x32_bf16 v[120:123], a[240:243], a[48:51], v[120:123]
  v_add_f32 v34, v34, v148
  v_cvt_pk_bf16_f32 v29, v150, v151
  v_add_f32 v34, v34, v149
  v_mfma_f32_16x16x32_bf16 v[120:123], a[244:247], a[52:55], v[120:123]
  buffer_load_dwordx4 v25, s[44:47], s61 offen offset:3072 nt lds
  ds_write_b64 v12, v[28:29] offset:2048
  v_add_f32 v34, v34, v150
  v_add_f32 v34, v34, v151
  v_mfma_f32_16x16x32_bf16 v[120:123], a[248:251], a[56:59], v[120:123]
  v_add_f32 v152, v152, v96
  v_add_f32 v153, v153, v96
  v_add_f32 v154, v154, v96
  v_add_f32 v155, v155, v96
  v_mfma_f32_16x16x32_bf16 v[120:123], a[252:255], a[60:63], v[120:123]
  s_add_u32 m0, s62, 28672
  v_exp_f32 v152, v152
  v_mfma_f32_16x16x32_bf16 v[124:127], a[224:227], a[64:67], v[96:99]
  s_add_u32 s66, s61, 16384
  buffer_load_dwordx4 v22, s[44:47], s66 offen offset:0 nt lds
  v_exp_f32 v153, v153
  v_mfma_f32_16x16x32_bf16 v[124:127], a[228:231], a[68:71], v[124:127]
  v_exp_f32 v154, v154
  v_cvt_pk_bf16_f32 v30, v152, v153
  v_max_f32 v100, v100, v103
  v_mfma_f32_16x16x32_bf16 v[124:127], a[232:235], a[72:75], v[124:127]
  v_exp_f32 v155, v155
  v_add_f32 v35, v35, v152
  v_mfma_f32_16x16x32_bf16 v[124:127], a[236:239], a[76:79], v[124:127]
  v_cvt_pk_bf16_f32 v31, v154, v155
  v_add_f32 v35, v35, v153
  v_sub_f32 v100, 0, v100
  v_mov_b32 v101, v100
  v_mfma_f32_16x16x32_bf16 v[124:127], a[240:243], a[80:83], v[124:127]
  buffer_load_dwordx4 v23, s[44:47], s66 offen offset:1024 nt lds
  ds_write_b64 v12, v[30:31] offset:4096
  v_add_f32 v35, v35, v154
  v_mfma_f32_16x16x32_bf16 v[124:127], a[244:247], a[84:87], v[124:127]
  v_mov_b32 v102, v100
  v_mov_b32 v103, v100
  v_add_f32 v35, v35, v155
  s_waitcnt lgkmcnt(5)
  v_max3_f32 v104, v104, v105, v106
  v_mfma_f32_16x16x32_bf16 v[124:127], a[248:251], a[88:91], v[124:127]
  v_add_f32 v156, v156, v100
  v_add_f32 v157, v157, v100
  v_add_f32 v158, v158, v100
  v_add_f32 v159, v159, v100
  v_mfma_f32_16x16x32_bf16 v[124:127], a[252:255], a[92:95], v[124:127]
  buffer_load_dwordx4 v24, s[44:47], s66 offen offset:2048 nt lds
  v_max_f32 v104, v104, v107
  v_sub_f32 v104, 0, v104
  v_mfma_f32_16x16x32_bf16 v[128:131], a[224:227], a[96:99], v[100:103]
  v_exp_f32 v156, v156
  v_exp_f32 v157, v157
  v_mfma_f32_16x16x32_bf16 v[128:131], a[228:231], a[100:103], v[128:131]
  v_exp_f32 v158, v158
  v_cvt_pk_bf16_f32 v26, v156, v157
  v_mov_b32 v105, v104
  v_mfma_f32_16x16x32_bf16 v[128:131], a[232:235], a[104:107], v[128:131]
  v_exp_f32 v159, v159
  v_add_f32 v36, v36, v156
  v_mfma_f32_16x16x32_bf16 v[128:131], a[236:239], a[108:111], v[128:131]
  buffer_load_dwordx4 v25, s[44:47], s66 offen offset:3072 nt lds
  s_add_u32 m0, s62, 8192
  v_cvt_pk_bf16_f32 v27, v158, v159
  v_add_f32 v36, v36, v157
  v_mfma_f32_16x16x32_bf16 v[128:131], a[240:243], a[112:115], v[128:131]
  ds_write_b64 v12, v[26:27] offset:6144
  v_add_f32 v36, v36, v158
  v_add_f32 v36, v36, v159
  v_mov_b32 v106, v104
  v_mfma_f32_16x16x32_bf16 v[128:131], a[244:247], a[116:119], v[128:131]
  s_mov_b32 s60, 98304
  v_mov_b32 v107, v104
  s_waitcnt lgkmcnt(5)
  v_max3_f32 v108, v108, v109, v110
  v_mfma_f32_16x16x32_bf16 v[128:131], a[248:251], a[120:123], v[128:131]
  buffer_load_dwordx4 v14, s[40:43], s60 offen offset:0 nt lds
  v_add_f32 v160, v160, v104
  v_add_f32 v161, v161, v104
  v_add_f32 v162, v162, v104
  v_mfma_f32_16x16x32_bf16 v[128:131], a[252:255], a[124:127], v[128:131]
  v_add_f32 v163, v163, v104
  v_max_f32 v108, v108, v111
  v_exp_f32 v160, v160
  v_mfma_f32_16x16x32_bf16 v[132:135], a[224:227], a[128:131], v[104:107]
  v_exp_f32 v161, v161
  v_sub_f32 v108, 0, v108
  v_mfma_f32_16x16x32_bf16 v[132:135], a[228:231], a[132:135], v[132:135]
  v_exp_f32 v162, v162
  v_cvt_pk_bf16_f32 v28, v160, v161
  s_waitcnt vmcnt(17)
  v_mfma_f32_16x16x32_bf16 v[132:135], a[232:235], a[136:139], v[132:135]
  buffer_load_dwordx4 v15, s[40:43], s60 offen offset:1024 nt lds
  v_mov_b32 v109, v108
  v_exp_f32 v163, v163
  v_mfma_f32_16x16x32_bf16 v[132:135], a[236:239], a[140:143], v[132:135]
  v_add_f32 v37, v37, v160
  v_cvt_pk_bf16_f32 v29, v162, v163
  v_add_f32 v37, v37, v161
  v_mfma_f32_16x16x32_bf16 v[132:135], a[240:243], a[144:147], v[132:135]
  ds_write_b64 v12, v[28:29] offset:8192
  v_add_f32 v37, v37, v162
  v_add_f32 v37, v37, v163
  v_mov_b32 v110, v108
  v_mfma_f32_16x16x32_bf16 v[132:135], a[244:247], a[148:151], v[132:135]
  buffer_load_dwordx4 v16, s[40:43], s60 offen offset:2048 nt lds
  ds_read_b64_tr_b16 v[56:57], v8 offset:0
  v_mov_b32 v111, v108
  v_mfma_f32_16x16x32_bf16 v[132:135], a[248:251], a[152:155], v[132:135]
  v_add_f32 v164, v164, v108
  v_add_f32 v165, v165, v108
  v_add_f32 v166, v166, v108
  v_add_f32 v167, v167, v108
  v_mfma_f32_16x16x32_bf16 v[132:135], a[252:255], a[156:159], v[132:135]
  v_exp_f32 v164, v164
  v_exp_f32 v165, v165
  v_mfma_f32_16x16x32_bf16 v[136:139], a[224:227], a[160:163], v[108:111]
  v_exp_f32 v166, v166
  v_cvt_pk_bf16_f32 v30, v164, v165
  v_mfma_f32_16x16x32_bf16 v[136:139], a[228:231], a[164:167], v[136:139]
  buffer_load_dwordx4 v17, s[40:43], s60 offen offset:3072 nt lds
  s_waitcnt lgkmcnt(6)
  v_max3_f32 v112, v112, v113, v114
  v_exp_f32 v167, v167
  v_mfma_f32_16x16x32_bf16 v[136:139], a[232:235], a[168:171], v[136:139]
  v_add_f32 v38, v38, v164
  v_cvt_pk_bf16_f32 v31, v166, v167
  v_add_f32 v38, v38, v165
  v_max_f32 v112, v112, v115
  v_mfma_f32_16x16x32_bf16 v[136:139], a[236:239], a[172:175], v[136:139]
  ds_write_b64 v12, v[30:31] offset:10240
  v_add_f32 v38, v38, v166
  v_add_f32 v38, v38, v167
  v_mfma_f32_16x16x32_bf16 v[136:139], a[240:243], a[176:179], v[136:139]
  s_add_u32 m0, s62, 12288
  s_nop 0
  buffer_load_dwordx4 v18, s[40:43], s60 offen offset:0 nt lds
  v_sub_f32 v112, 0, v112
  v_mfma_f32_16x16x32_bf16 v[136:139], a[244:247], a[180:183], v[136:139]
  ds_read_b64_tr_b16 v[58:59], v8 offset:2048
  v_mov_b32 v113, v112
  v_mov_b32 v114, v112
  v_mov_b32 v115, v112
  v_mfma_f32_16x16x32_bf16 v[136:139], a[248:251], a[184:187], v[136:139]
  v_add_f32 v168, v168, v112
  v_add_f32 v169, v169, v112
  v_add_f32 v170, v170, v112
  v_mfma_f32_16x16x32_bf16 v[136:139], a[252:255], a[188:191], v[136:139]
  ds_read_b64_tr_b16 v[60:61], v9 offset:0
  v_add_f32 v171, v171, v112
  v_exp_f32 v168, v168
  v_mfma_f32_16x16x32_bf16 v[140:143], a[224:227], a[192:195], v[112:115]
  buffer_load_dwordx4 v19, s[40:43], s60 offen offset:1024 nt lds
  ds_read_b64_tr_b16 v[62:63], v9 offset:2048
  ds_read_b64_tr_b16 v[64:65], v10 offset:0
  v_mfma_f32_16x16x32_bf16 v[140:143], a[228:231], a[196:199], v[140:143]
  ds_read_b64_tr_b16 v[66:67], v10 offset:2048
  buffer_load_dwordx4 v20, s[40:43], s60 offen offset:2048 nt lds
  v_exp_f32 v169, v169
  v_mfma_f32_16x16x32_bf16 v[140:143], a[232:235], a[200:203], v[140:143]
  ds_read_b64_tr_b16 v[68:69], v11 offset:0
  ds_read_b64_tr_b16 v[70:71], v11 offset:2048
  v_exp_f32 v170, v170
  v_mfma_f32_16x16x32_bf16 v[140:143], a[236:239], a[204:207], v[140:143]
  ds_read_b64_tr_b16 v[72:73], v8 offset:4096
  v_cvt_pk_bf16_f32 v26, v168, v169
  v_mfma_f32_16x16x32_bf16 v[140:143], a[240:243], a[208:211], v[140:143]
  ds_read_b64_tr_b16 v[74:75], v8 offset:6144
  ds_read_b64_tr_b16 v[76:77], v9 offset:4096
  v_exp_f32 v171, v171
  v_add_f32 v39, v39, v168
  v_mfma_f32_16x16x32_bf16 v[140:143], a[244:247], a[212:215], v[140:143]
  ds_read_b64_tr_b16 v[78:79], v9 offset:6144
  buffer_load_dwordx4 v21, s[40:43], s60 offen offset:3072 nt lds
  v_cvt_pk_bf16_f32 v27, v170, v171
  v_add_f32 v39, v39, v169
  v_mfma_f32_16x16x32_bf16 v[140:143], a[248:251], a[216:219], v[140:143]
  ds_read_b64_tr_b16 v[80:81], v10 offset:4096
  ds_read_b64_tr_b16 v[82:83], v10 offset:6144
  v_mfma_f32_16x16x32_bf16 v[140:143], a[252:255], a[220:223], v[140:143]
  ds_write_b64 v12, v[26:27] offset:12288
  ds_read_b64_tr_b16 v[84:85], v11 offset:4096
  ds_read_b64_tr_b16 v[86:87], v11 offset:6144
  v_add_f32 v39, v39, v170
  v_add_f32 v39, v39, v171
  s_waitcnt lgkmcnt(0)
  s_barrier
  ds_read_b128 v[40:43], v13 offset:0
  ds_read_b128 v[44:47], v13 offset:1024
  ds_read_b128 v[48:51], v13 offset:2048
  ds_read_b128 v[52:55], v13 offset:3072
  s_waitcnt lgkmcnt(3)
  v_mfma_f32_16x16x32_bf16 v[144:147], v[56:59], v[40:43], 0
  s_add_u32 m0, s62, 16384
  v_exp_f32 v116, v116
  s_waitcnt lgkmcnt(2)
  v_mfma_f32_16x16x32_bf16 v[144:147], v[72:75], v[44:47], v[144:147]
  v_exp_f32 v117, v117
  v_mfma_f32_16x16x32_bf16 v[148:151], v[76:79], v[44:47], 0
  v_exp_f32 v118, v118
  v_cvt_pk_bf16_f32 v26, v116, v117
  v_mfma_f32_16x16x32_bf16 v[148:151], v[60:63], v[40:43], v[148:151]
  v_exp_f32 v119, v119
  v_add_f32 v33, v33, v116
  v_mfma_f32_16x16x32_bf16 v[152:155], v[64:67], v[40:43], 0
  v_cvt_pk_bf16_f32 v27, v118, v119
  v_add_f32 v33, v33, v117
  v_mfma_f32_16x16x32_bf16 v[152:155], v[80:83], v[44:47], v[152:155]
  ds_write_b64 v12, v[26:27] offset:14336
  v_add_f32 v33, v33, v118
  v_add_f32 v33, v33, v119
  v_mfma_f32_16x16x32_bf16 v[156:159], v[84:87], v[44:47], 0
  s_mov_b32 s61, 65536
  buffer_load_dwordx4 v22, s[44:47], s61 offen offset:0 nt lds
  v_mfma_f32_16x16x32_bf16 v[156:159], v[68:71], v[40:43], v[156:159]
  ds_read_b128 v[40:43], v13 offset:4096
  v_exp_f32 v120, v120
  s_waitcnt lgkmcnt(3)
  v_mfma_f32_16x16x32_bf16 v[160:163], v[56:59], v[48:51], 0
  ds_read_b128 v[44:47], v13 offset:5120
  v_exp_f32 v121, v121
  s_waitcnt lgkmcnt(3)
  v_mfma_f32_16x16x32_bf16 v[160:163], v[72:75], v[52:55], v[160:163]
  v_exp_f32 v122, v122
  v_mfma_f32_16x16x32_bf16 v[164:167], v[76:79], v[52:55], 0
  buffer_load_dwordx4 v23, s[44:47], s61 offen offset:1024 nt lds
  v_cvt_pk_bf16_f32 v28, v120, v121
  v_mfma_f32_16x16x32_bf16 v[164:167], v[60:63], v[48:51], v[164:167]
  v_exp_f32 v123, v123
  v_add_f32 v34, v34, v120
  v_cvt_pk_bf16_f32 v29, v122, v123
  v_mfma_f32_16x16x32_bf16 v[168:171], v[64:67], v[48:51], 0
  v_add_f32 v34, v34, v121
  v_mfma_f32_16x16x32_bf16 v[168:171], v[80:83], v[52:55], v[168:171]
  ds_write_b64 v12, v[28:29] offset:16384
  v_add_f32 v34, v34, v122
  v_add_f32 v34, v34, v123
  v_mfma_f32_16x16x32_bf16 v[172:175], v[84:87], v[52:55], 0
  v_exp_f32 v124, v124
  v_exp_f32 v125, v125
  v_mfma_f32_16x16x32_bf16 v[172:175], v[68:71], v[48:51], v[172:175]
  v_exp_f32 v126, v126
  s_waitcnt lgkmcnt(2)
  v_mfma_f32_16x16x32_bf16 v[176:179], v[56:59], v[40:43], 0
  ds_read_b128 v[48:51], v13 offset:6144
  buffer_load_dwordx4 v24, s[44:47], s61 offen offset:2048 nt lds
  v_cvt_pk_bf16_f32 v30, v124, v125
  s_waitcnt lgkmcnt(2)
  v_mfma_f32_16x16x32_bf16 v[176:179], v[72:75], v[44:47], v[176:179]
  v_exp_f32 v127, v127
  v_add_f32 v35, v35, v124
  v_mfma_f32_16x16x32_bf16 v[180:183], v[76:79], v[44:47], 0
  v_cvt_pk_bf16_f32 v31, v126, v127
  v_add_f32 v35, v35, v125
  v_mfma_f32_16x16x32_bf16 v[180:183], v[60:63], v[40:43], v[180:183]
  ds_read_b128 v[52:55], v13 offset:7168
  ds_write_b64 v12, v[30:31] offset:18432
  v_add_f32 v35, v35, v126
  v_mfma_f32_16x16x32_bf16 v[184:187], v[64:67], v[40:43], 0
  v_add_f32 v35, v35, v127
  s_waitcnt vmcnt(19)
  ds_read_b128 a[224:227], v4 offset:0
  v_mfma_f32_16x16x32_bf16 v[184:187], v[80:83], v[44:47], v[184:187]
  v_exp_f32 v128, v128
  v_mfma_f32_16x16x32_bf16 v[188:191], v[84:87], v[44:47], 0
  buffer_load_dwordx4 v25, s[44:47], s61 offen offset:3072 nt lds
  v_exp_f32 v129, v129
  v_mfma_f32_16x16x32_bf16 v[188:191], v[68:71], v[40:43], v[188:191]
  v_exp_f32 v130, v130
  v_cvt_pk_bf16_f32 v26, v128, v129
  s_waitcnt lgkmcnt(3)
  v_mfma_f32_16x16x32_bf16 v[192:195], v[56:59], v[48:51], 0
  v_exp_f32 v131, v131
  s_waitcnt lgkmcnt(2)
  v_mfma_f32_16x16x32_bf16 v[192:195], v[72:75], v[52:55], v[192:195]
  v_add_f32 v36, v36, v128
  v_cvt_pk_bf16_f32 v27, v130, v131
  v_add_f32 v36, v36, v129
  v_mfma_f32_16x16x32_bf16 v[196:199], v[76:79], v[52:55], 0
  ds_write_b64 v12, v[26:27] offset:20480
  v_add_f32 v36, v36, v130
  v_add_f32 v36, v36, v131
  v_mfma_f32_16x16x32_bf16 v[196:199], v[60:63], v[48:51], v[196:199]
  ds_read_b128 v[40:43], v13 offset:8192
  ds_read_b128 v[44:47], v13 offset:9216
  v_mfma_f32_16x16x32_bf16 v[200:203], v[64:67], v[48:51], 0
  s_add_u32 m0, s62, 20480
  v_exp_f32 v132, v132
  v_mfma_f32_16x16x32_bf16 v[200:203], v[80:83], v[52:55], v[200:203]
  v_exp_f32 v133, v133
  v_mfma_f32_16x16x32_bf16 v[204:207], v[84:87], v[52:55], 0
  v_exp_f32 v134, v134
  v_cvt_pk_bf16_f32 v28, v132, v133
  v_mfma_f32_16x16x32_bf16 v[204:207], v[68:71], v[48:51], v[204:207]
  v_exp_f32 v135, v135
  v_add_f32 v37, v37, v132
  s_waitcnt lgkmcnt(1)
  v_mfma_f32_16x16x32_bf16 v[208:211], v[56:59], v[40:43], 0
  v_cvt_pk_bf16_f32 v29, v134, v135
  v_add_f32 v37, v37, v133
  s_waitcnt lgkmcnt(0)
  v_mfma_f32_16x16x32_bf16 v[208:211], v[72:75], v[44:47], v[208:211]
  ds_write_b64 v12, v[28:29] offset:22528
  v_add_f32 v37, v37, v134
  v_add_f32 v37, v37, v135
  v_mfma_f32_16x16x32_bf16 v[212:215], v[76:79], v[44:47], 0
  s_add_u32 s66, s61, 16384
  buffer_load_dwordx4 v22, s[44:47], s66 offen offset:0 nt lds
  ds_read_b128 v[48:51], v13 offset:10240
  v_mfma_f32_16x16x32_bf16 v[212:215], v[60:63], v[40:43], v[212:215]
  ds_read_b128 v[52:55], v13 offset:11264
  ds_read_b128 a[228:231], v5 offset:0
  v_mfma_f32_16x16x32_bf16 v[216:219], v[64:67], v[40:43], 0
  ds_read_b128 a[232:235], v6 offset:0
  v_exp_f32 v136, v136
  v_mfma_f32_16x16x32_bf16 v[216:219], v[80:83], v[44:47], v[216:219]
  ds_read_b128 a[236:239], v7 offset:0
  v_exp_f32 v137, v137
  v_mfma_f32_16x16x32_bf16 v[220:223], v[84:87], v[44:47], 0
  v_exp_f32 v138, v138
  v_mfma_f32_16x16x32_bf16 v[220:223], v[68:71], v[40:43], v[220:223]
  ds_read_b128 v[40:43], v13 offset:12288
  buffer_load_dwordx4 v23, s[44:47], s66 offen offset:1024 nt lds
  v_cvt_pk_bf16_f32 v30, v136, v137
  s_waitcnt lgkmcnt(5)
  v_mfma_f32_16x16x32_bf16 v[224:227], v[56:59], v[48:51], 0
  v_exp_f32 v139, v139
  v_add_f32 v38, v38, v136
  s_waitcnt lgkmcnt(4)
  v_mfma_f32_16x16x32_bf16 v[224:227], v[72:75], v[52:55], v[224:227]
  v_cvt_pk_bf16_f32 v31, v138, v139
  v_add_f32 v38, v38, v137
  v_mfma_f32_16x16x32_bf16 v[228:231], v[76:79], v[52:55], 0
  ds_write_b64 v12, v[30:31] offset:24576
  v_add_f32 v38, v38, v138
  v_add_f32 v38, v38, v139
  v_mfma_f32_16x16x32_bf16 v[228:231], v[60:63], v[48:51], v[228:231]
  ds_read_b128 v[44:47], v13 offset:13312
  ds_read_b128 a[240:243], v4 offset:256
  v_mfma_f32_16x16x32_bf16 v[232:235], v[64:67], v[48:51], 0
  ds_read_b128 a[244:247], v5 offset:256
  v_exp_f32 v140, v140
  v_mfma_f32_16x16x32_bf16 v[232:235], v[80:83], v[52:55], v[232:235]
  ds_read_b128 a[248:251], v6 offset:256
  v_exp_f32 v141, v141
  v_mfma_f32_16x16x32_bf16 v[236:239], v[84:87], v[52:55], 0
  v_exp_f32 v142, v142
  v_mfma_f32_16x16x32_bf16 v[236:239], v[68:71], v[48:51], v[236:239]
  buffer_load_dwordx4 v24, s[44:47], s66 offen offset:2048 nt lds
  ds_read_b128 a[252:255], v7 offset:256
  v_cvt_pk_bf16_f32 v26, v140, v141
  s_waitcnt lgkmcnt(6)
  v_mfma_f32_16x16x32_bf16 v[240:243], v[56:59], v[40:43], 0
  v_exp_f32 v143, v143
  v_add_f32 v39, v39, v140
  s_waitcnt lgkmcnt(4)
  v_mfma_f32_16x16x32_bf16 v[240:243], v[72:75], v[44:47], v[240:243]
  v_cvt_pk_bf16_f32 v27, v142, v143
  v_add_f32 v39, v39, v141
  v_mfma_f32_16x16x32_bf16 v[244:247], v[76:79], v[44:47], 0
  ds_write_b64 v12, v[26:27] offset:26624
  v_add_f32 v39, v39, v142
  v_add_f32 v39, v39, v143
  v_mfma_f32_16x16x32_bf16 v[244:247], v[60:63], v[40:43], v[244:247]
  buffer_load_dwordx4 v25, s[44:47], s66 offen offset:3072 nt lds
  v_mfma_f32_16x16x32_bf16 v[248:251], v[64:67], v[40:43], 0
  v_mfma_f32_16x16x32_bf16 v[248:251], v[80:83], v[44:47], v[248:251]
  v_mfma_f32_16x16x32_bf16 v[252:255], v[84:87], v[44:47], 0
  v_mfma_f32_16x16x32_bf16 v[252:255], v[68:71], v[40:43], v[252:255]
  s_or_b32 s3, s4, s70
  s_or_b32 s3, s3, s34
  s_cbranch_scc1 L_noset
  s_lshl_b32 s3, s92, 4
  v_mov_b32 v2, s3
  v_mov_b32 v3, 1
  global_store_dword v2, v3, s[30:31] sc1
L_noset:
  s_mov_b32 s63, 13
.p2align 3
L_loop:
  s_waitcnt vmcnt(16) lgkmcnt(0)
  s_barrier
  v_mfma_f32_16x16x32_bf16 v[116:119], a[224:227], a[0:3], v[88:91]
  s_add_u32 m0, s62, 0
  ds_read_b64_tr_b16 v[56:57], v8 offset:8192
  v_mfma_f32_16x16x32_bf16 v[116:119], a[228:231], a[4:7], v[116:119]
  s_add_u32 s60, s60, 32768
  ds_read_b64_tr_b16 v[58:59], v8 offset:10240
  v_mfma_f32_16x16x32_bf16 v[116:119], a[232:235], a[8:11], v[116:119]
  ds_read_b64_tr_b16 v[72:73], v8 offset:12288
  ds_read_b64_tr_b16 v[74:75], v8 offset:14336
  v_mfma_f32_16x16x32_bf16 v[116:119], a[236:239], a[12:15], v[116:119]
  ds_read_b64_tr_b16 v[60:61], v9 offset:8192
  buffer_load_dwordx4 v14, s[40:43], s60 offen offset:0 nt lds
  v_mfma_f32_16x16x32_bf16 v[116:119], a[240:243], a[16:19], v[116:119]
  ds_read_b64_tr_b16 v[62:63], v9 offset:10240
  ds_read_b64_tr_b16 v[76:77], v9 offset:12288
  v_mfma_f32_16x16x32_bf16 v[116:119], a[244:247], a[20:23], v[116:119]
  ds_read_b64_tr_b16 v[78:79], v9 offset:14336
  v_mfma_f32_16x16x32_bf16 v[116:119], a[248:251], a[24:27], v[116:119]
  ds_read_b64_tr_b16 v[64:65], v10 offset:8192
  ds_read_b64_tr_b16 v[66:67], v10 offset:10240
  v_mfma_f32_16x16x32_bf16 v[116:119], a[252:255], a[28:31], v[116:119]
  buffer_load_dwordx4 v15, s[40:43], s60 offen offset:1024 nt lds
  ds_read_b64_tr_b16 v[80:81], v10 offset:12288
  v_mfma_f32_16x16x32_bf16 v[120:123], a[224:227], a[32:35], v[92:95]
  ds_read_b64_tr_b16 v[82:83], v10 offset:14336
  ds_read_b64_tr_b16 v[68:69], v11 offset:8192
  v_mfma_f32_16x16x32_bf16 v[120:123], a[228:231], a[36:39], v[120:123]
  ds_read_b64_tr_b16 v[70:71], v11 offset:10240
  v_mfma_f32_16x16x32_bf16 v[120:123], a[232:235], a[40:43], v[120:123]
  ds_read_b64_tr_b16 v[84:85], v11 offset:12288
  ds_read_b64_tr_b16 v[86:87], v11 offset:14336
  v_mfma_f32_16x16x32_bf16 v[120:123], a[236:239], a[44:47], v[120:123]
  v_mfma_f32_16x16x32_bf16 v[120:123], a[240:243], a[48:51], v[120:123]
  v_mfma_f32_16x16x32_bf16 v[120:123], a[244:247], a[52:55], v[120:123]
  v_mfma_f32_16x16x32_bf16 v[120:123], a[248:251], a[56:59], v[120:123]
  buffer_load_dwordx4 v16, s[40:43], s60 offen offset:2048 nt lds
  v_mfma_f32_16x16x32_bf16 v[120:123], a[252:255], a[60:63], v[120:123]
  v_exp_f32 v116, v116
  v_mfma_f32_16x16x32_bf16 v[124:127], a[224:227], a[64:67], v[96:99]
  v_exp_f32 v117, v117
  v_mfma_f32_16x16x32_bf16 v[124:127], a[228:231], a[68:71], v[124:127]
  v_exp_f32 v118, v118
  v_mfma_f32_16x16x32_bf16 v[124:127], a[232:235], a[72:75], v[124:127]
  v_cvt_pk_bf16_f32 v26, v116, v117
  v_mfma_f32_16x16x32_bf16 v[124:127], a[236:239], a[76:79], v[124:127]
  v_exp_f32 v119, v119
  v_mfma_f32_16x16x32_bf16 v[124:127], a[240:243], a[80:83], v[124:127]
  v_add_f32 v33, v33, v116
  v_cvt_pk_bf16_f32 v27, v118, v119
  v_mfma_f32_16x16x32_bf16 v[124:127], a[244:247], a[84:87], v[124:127]
  buffer_load_dwordx4 v17, s[40:43], s60 offen offset:3072 nt lds
  v_add_f32 v33, v33, v117
  v_mfma_f32_16x16x32_bf16 v[124:127], a[248:251], a[88:91], v[124:127]
  ds_write_b64 v12, v[26:27] offset:0
  v_add_f32 v33, v33, v118
  v_mfma_f32_16x16x32_bf16 v[124:127], a[252:255], a[92:95], v[124:127]
  v_add_f32 v33, v33, v119
  v_mfma_f32_16x16x32_bf16 v[128:131], a[224:227], a[96:99], v[100:103]
  v_exp_f32 v120, v120
  v_mfma_f32_16x16x32_bf16 v[128:131], a[228:231], a[100:103], v[128:131]
  v_exp_f32 v121, v121
  v_mfma_f32_16x16x32_bf16 v[128:131], a[232:235], a[104:107], v[128:131]
  v_exp_f32 v122, v122
  v_mfma_f32_16x16x32_bf16 v[128:131], a[236:239], a[108:111], v[128:131]
  ds_read_b128 v[40:43], v13 offset:14336
  v_cvt_pk_bf16_f32 v28, v120, v121
  v_mfma_f32_16x16x32_bf16 v[128:131], a[240:243], a[112:115], v[128:131]
  v_exp_f32 v123, v123
  v_mfma_f32_16x16x32_bf16 v[128:131], a[244:247], a[116:119], v[128:131]
  v_add_f32 v34, v34, v120
  v_cvt_pk_bf16_f32 v29, v122, v123
  v_mfma_f32_16x16x32_bf16 v[128:131], a[248:251], a[120:123], v[128:131]
  ds_read_b128 v[44:47], v13 offset:15360
  v_add_f32 v34, v34, v121
  v_mfma_f32_16x16x32_bf16 v[128:131], a[252:255], a[124:127], v[128:131]
  ds_write_b64 v12, v[28:29] offset:2048
  v_add_f32 v34, v34, v122
  v_mfma_f32_16x16x32_bf16 v[132:135], a[224:227], a[128:131], v[104:107]
  ds_read_b128 v[48:51], v13 offset:16384
  v_add_f32 v34, v34, v123
  v_mfma_f32_16x16x32_bf16 v[132:135], a[228:231], a[132:135], v[132:135]
  s_add_u32 m0, s62, 4096
  s_nop 0
  v_mfma_f32_16x16x32_bf16 v[132:135], a[232:235], a[136:139], v[132:135]
  buffer_load_dwordx4 v18, s[40:43], s60 offen offset:0 nt lds
  ds_read_b128 v[52:55], v13 offset:17408
  v_mfma_f32_16x16x32_bf16 v[132:135], a[236:239], a[140:143], v[132:135]
  v_exp_f32 v124, v124
  v_mfma_f32_16x16x32_bf16 v[132:135], a[240:243], a[144:147], v[132:135]
  v_exp_f32 v125, v125
  v_mfma_f32_16x16x32_bf16 v[132:135], a[244:247], a[148:151], v[132:135]
  v_exp_f32 v126, v126
  v_mfma_f32_16x16x32_bf16 v[132:135], a[248:251], a[152:155], v[132:135]
  buffer_load_dwordx4 v19, s[40:43], s60 offen offset:1024 nt lds
  v_cvt_pk_bf16_f32 v30, v124, v125
  v_mfma_f32_16x16x32_bf16 v[132:135], a[252:255], a[156:159], v[132:135]
  v_exp_f32 v127, v127
  v_mfma_f32_16x16x32_bf16 v[136:139], a[224:227], a[160:163], v[108:111]
  v_add_f32 v35, v35, v124
  v_cvt_pk_bf16_f32 v31, v126, v127
  v_mfma_f32_16x16x32_bf16 v[136:139], a[228:231], a[164:167], v[136:139]
  v_add_f32 v35, v35, v125
  v_mfma_f32_16x16x32_bf16 v[136:139], a[232:235], a[168:171], v[136:139]
  ds_write_b64 v12, v[30:31] offset:4096
  v_add_f32 v35, v35, v126
  v_mfma_f32_16x16x32_bf16 v[136:139], a[236:239], a[172:175], v[136:139]
  buffer_load_dwordx4 v20, s[40:43], s60 offen offset:2048 nt lds
  v_add_f32 v35, v35, v127
  v_mfma_f32_16x16x32_bf16 v[136:139], a[240:243], a[176:179], v[136:139]
  v_exp_f32 v128, v128
  v_mfma_f32_16x16x32_bf16 v[136:139], a[244:247], a[180:183], v[136:139]
  v_exp_f32 v129, v129
  v_mfma_f32_16x16x32_bf16 v[136:139], a[248:251], a[184:187], v[136:139]
  v_exp_f32 v130, v130
  v_mfma_f32_16x16x32_bf16 v[136:139], a[252:255], a[188:191], v[136:139]
  v_cvt_pk_bf16_f32 v26, v128, v129
  v_mfma_f32_16x16x32_bf16 v[140:143], a[224:227], a[192:195], v[112:115]
  v_exp_f32 v131, v131
  v_mfma_f32_16x16x32_bf16 v[140:143], a[228:231], a[196:199], v[140:143]
  v_add_f32 v36, v36, v128
  v_cvt_pk_bf16_f32 v27, v130, v131
  v_mfma_f32_16x16x32_bf16 v[140:143], a[232:235], a[200:203], v[140:143]
  buffer_load_dwordx4 v21, s[40:43], s60 offen offset:3072 nt lds
  v_add_f32 v36, v36, v129
  v_mfma_f32_16x16x32_bf16 v[140:143], a[236:239], a[204:207], v[140:143]
  ds_write_b64 v12, v[26:27] offset:6144
  v_add_f32 v36, v36, v130
  v_mfma_f32_16x16x32_bf16 v[140:143], a[240:243], a[208:211], v[140:143]
  v_add_f32 v36, v36, v131
  v_mfma_f32_16x16x32_bf16 v[140:143], a[244:247], a[212:215], v[140:143]
  v_exp_f32 v132, v132
  v_mfma_f32_16x16x32_bf16 v[140:143], a[248:251], a[216:219], v[140:143]
  v_exp_f32 v133, v133
  v_mfma_f32_16x16x32_bf16 v[140:143], a[252:255], a[220:223], v[140:143]
  v_exp_f32 v134, v134
  s_waitcnt lgkmcnt(6)
  v_mfma_f32_16x16x32_bf16 v[144:147], v[56:59], v[40:43], v[144:147]
  v_cvt_pk_bf16_f32 v28, v132, v133
  s_waitcnt vmcnt(16)
  s_waitcnt lgkmcnt(5)
  v_mfma_f32_16x16x32_bf16 v[144:147], v[72:75], v[44:47], v[144:147]
  v_exp_f32 v135, v135
  v_mfma_f32_16x16x32_bf16 v[148:151], v[76:79], v[44:47], v[148:151]
  v_add_f32 v37, v37, v132
  v_cvt_pk_bf16_f32 v29, v134, v135
  v_mfma_f32_16x16x32_bf16 v[148:151], v[60:63], v[40:43], v[148:151]
  ds_read_b128 a[224:227], v4 offset:8192
  v_add_f32 v37, v37, v133
  v_mfma_f32_16x16x32_bf16 v[152:155], v[64:67], v[40:43], v[152:155]
  ds_write_b64 v12, v[28:29] offset:8192
  v_add_f32 v37, v37, v134
  v_mfma_f32_16x16x32_bf16 v[152:155], v[80:83], v[44:47], v[152:155]
  ds_read_b128 a[228:231], v5 offset:8192
  v_add_f32 v37, v37, v135
  v_mfma_f32_16x16x32_bf16 v[156:159], v[84:87], v[44:47], v[156:159]
  v_exp_f32 v136, v136
  v_mfma_f32_16x16x32_bf16 v[156:159], v[68:71], v[40:43], v[156:159]
  v_exp_f32 v137, v137
  s_waitcnt lgkmcnt(6)
  v_mfma_f32_16x16x32_bf16 v[160:163], v[56:59], v[48:51], v[160:163]
  ds_read_b128 v[40:43], v13 offset:18432
  ds_read_b128 v[44:47], v13 offset:19456
  s_waitcnt lgkmcnt(7)
  v_mfma_f32_16x16x32_bf16 v[160:163], v[72:75], v[52:55], v[160:163]
  v_exp_f32 v138, v138
  v_mfma_f32_16x16x32_bf16 v[164:167], v[76:79], v[52:55], v[164:167]
  s_add_u32 m0, s62, 24576
  v_cvt_pk_bf16_f32 v30, v136, v137
  v_mfma_f32_16x16x32_bf16 v[164:167], v[60:63], v[48:51], v[164:167]
  v_exp_f32 v139, v139
  v_mfma_f32_16x16x32_bf16 v[168:171], v[64:67], v[48:51], v[168:171]
  s_add_u32 s61, s61, 32768
  v_add_f32 v38, v38, v136
  v_mfma_f32_16x16x32_bf16 v[168:171], v[80:83], v[52:55], v[168:171]
  v_cvt_pk_bf16_f32 v31, v138, v139
  v_add_f32 v38, v38, v137
  v_mfma_f32_16x16x32_bf16 v[172:175], v[84:87], v[52:55], v[172:175]
  buffer_load_dwordx4 v22, s[44:47], s61 offen offset:0 nt lds
  ds_write_b64 v12, v[30:31] offset:10240
  v_mfma_f32_16x16x32_bf16 v[172:175], v[68:71], v[48:51], v[172:175]
  ds_read_b128 v[48:51], v13 offset:20480
  v_add_f32 v38, v38, v138
  s_waitcnt lgkmcnt(3)
  v_mfma_f32_16x16x32_bf16 v[176:179], v[56:59], v[40:43], v[176:179]
  ds_read_b128 v[52:55], v13 offset:21504
  v_add_f32 v38, v38, v139
  s_waitcnt lgkmcnt(3)
  v_mfma_f32_16x16x32_bf16 v[176:179], v[72:75], v[44:47], v[176:179]
  v_exp_f32 v140, v140
  v_mfma_f32_16x16x32_bf16 v[180:183], v[76:79], v[44:47], v[180:183]
  v_exp_f32 v141, v141
  v_mfma_f32_16x16x32_bf16 v[180:183], v[60:63], v[40:43], v[180:183]
  buffer_load_dwordx4 v23, s[44:47], s61 offen offset:1024 nt lds
  ds_read_b128 a[232:235], v6 offset:8192
  v_mfma_f32_16x16x32_bf16 v[184:187], v[64:67], v[40:43], v[184:187]
  v_exp_f32 v142, v142
  v_mfma_f32_16x16x32_bf16 v[184:187], v[80:83], v[44:47], v[184:187]
  buffer_load_dwordx4 v24, s[44:47], s61 offen offset:2048 nt lds
  v_cvt_pk_bf16_f32 v26, v140, v141
  v_mfma_f32_16x16x32_bf16 v[188:191], v[84:87], v[44:47], v[188:191]
  v_exp_f32 v143, v143
  v_mfma_f32_16x16x32_bf16 v[188:191], v[68:71], v[40:43], v[188:191]
  ds_read_b128 v[40:43], v13 offset:22528
  ds_read_b128 v[44:47], v13 offset:23552
  s_waitcnt lgkmcnt(4)
  v_mfma_f32_16x16x32_bf16 v[192:195], v[56:59], v[48:51], v[192:195]
  v_add_f32 v39, v39, v140
  v_cvt_pk_bf16_f32 v27, v142, v143
  s_waitcnt lgkmcnt(3)
  v_mfma_f32_16x16x32_bf16 v[192:195], v[72:75], v[52:55], v[192:195]
  ds_read_b128 a[236:239], v7 offset:8192
  v_add_f32 v39, v39, v141
  v_mfma_f32_16x16x32_bf16 v[196:199], v[76:79], v[52:55], v[196:199]
  ds_read_b128 a[240:243], v4 offset:8448
  ds_write_b64 v12, v[26:27] offset:12288
  v_mfma_f32_16x16x32_bf16 v[196:199], v[60:63], v[48:51], v[196:199]
  buffer_load_dwordx4 v25, s[44:47], s61 offen offset:3072 nt lds
  ds_read_b128 a[244:247], v5 offset:8448
  v_mfma_f32_16x16x32_bf16 v[200:203], v[64:67], v[48:51], v[200:203]
  ds_read_b128 a[248:251], v6 offset:8448
  v_add_f32 v39, v39, v142
  v_mfma_f32_16x16x32_bf16 v[200:203], v[80:83], v[52:55], v[200:203]
  ds_read_b128 a[252:255], v7 offset:8448
  v_add_f32 v39, v39, v143
  v_mfma_f32_16x16x32_bf16 v[204:207], v[84:87], v[52:55], v[204:207]
  v_mfma_f32_16x16x32_bf16 v[204:207], v[68:71], v[48:51], v[204:207]
  ds_read_b128 v[48:51], v13 offset:24576
  s_add_u32 m0, s62, 28672
  s_waitcnt lgkmcnt(8)
  v_mfma_f32_16x16x32_bf16 v[208:211], v[56:59], v[40:43], v[208:211]
  ds_read_b128 v[52:55], v13 offset:25600
  s_add_u32 s66, s61, 16384
  s_waitcnt lgkmcnt(8)
  v_mfma_f32_16x16x32_bf16 v[208:211], v[72:75], v[44:47], v[208:211]
  buffer_load_dwordx4 v22, s[44:47], s66 offen offset:0 nt lds
  v_mfma_f32_16x16x32_bf16 v[212:215], v[76:79], v[44:47], v[212:215]
  v_mfma_f32_16x16x32_bf16 v[212:215], v[60:63], v[40:43], v[212:215]
  v_mfma_f32_16x16x32_bf16 v[216:219], v[64:67], v[40:43], v[216:219]
  v_mfma_f32_16x16x32_bf16 v[216:219], v[80:83], v[44:47], v[216:219]
  v_mfma_f32_16x16x32_bf16 v[220:223], v[84:87], v[44:47], v[220:223]
  buffer_load_dwordx4 v23, s[44:47], s66 offen offset:1024 nt lds
  v_mfma_f32_16x16x32_bf16 v[220:223], v[68:71], v[40:43], v[220:223]
  ds_read_b128 v[40:43], v13 offset:26624
  ds_read_b128 v[44:47], v13 offset:27648
  s_waitcnt lgkmcnt(3)
  v_mfma_f32_16x16x32_bf16 v[224:227], v[56:59], v[48:51], v[224:227]
  s_waitcnt lgkmcnt(2)
  v_mfma_f32_16x16x32_bf16 v[224:227], v[72:75], v[52:55], v[224:227]
  v_mfma_f32_16x16x32_bf16 v[228:231], v[76:79], v[52:55], v[228:231]
  v_mfma_f32_16x16x32_bf16 v[228:231], v[60:63], v[48:51], v[228:231]
  v_mfma_f32_16x16x32_bf16 v[232:235], v[64:67], v[48:51], v[232:235]
  buffer_load_dwordx4 v24, s[44:47], s66 offen offset:2048 nt lds
  v_mfma_f32_16x16x32_bf16 v[232:235], v[80:83], v[52:55], v[232:235]
  v_mfma_f32_16x16x32_bf16 v[236:239], v[84:87], v[52:55], v[236:239]
  v_mfma_f32_16x16x32_bf16 v[236:239], v[68:71], v[48:51], v[236:239]
  s_waitcnt lgkmcnt(1)
  v_mfma_f32_16x16x32_bf16 v[240:243], v[56:59], v[40:43], v[240:243]
  s_waitcnt lgkmcnt(0)
  v_mfma_f32_16x16x32_bf16 v[240:243], v[72:75], v[44:47], v[240:243]
  v_mfma_f32_16x16x32_bf16 v[244:247], v[76:79], v[44:47], v[244:247]
  buffer_load_dwordx4 v25, s[44:47], s66 offen offset:3072 nt lds
  v_mfma_f32_16x16x32_bf16 v[244:247], v[60:63], v[40:43], v[244:247]
  v_mfma_f32_16x16x32_bf16 v[248:251], v[64:67], v[40:43], v[248:251]
  v_mfma_f32_16x16x32_bf16 v[248:251], v[80:83], v[44:47], v[248:251]
  v_mfma_f32_16x16x32_bf16 v[252:255], v[84:87], v[44:47], v[252:255]
  v_mfma_f32_16x16x32_bf16 v[252:255], v[68:71], v[40:43], v[252:255]
  s_waitcnt vmcnt(16)
  s_barrier
  v_mfma_f32_16x16x32_bf16 v[116:119], a[224:227], a[0:3], v[88:91]
  s_add_u32 m0, s62, 8192
  ds_read_b64_tr_b16 v[56:57], v8 offset:0
  v_mfma_f32_16x16x32_bf16 v[116:119], a[228:231], a[4:7], v[116:119]
  s_add_u32 s60, s60, 32768
  ds_read_b64_tr_b16 v[58:59], v8 offset:2048
  v_mfma_f32_16x16x32_bf16 v[116:119], a[232:235], a[8:11], v[116:119]
  ds_read_b64_tr_b16 v[72:73], v8 offset:4096
  ds_read_b64_tr_b16 v[74:75], v8 offset:6144
  v_mfma_f32_16x16x32_bf16 v[116:119], a[236:239], a[12:15], v[116:119]
  ds_read_b64_tr_b16 v[60:61], v9 offset:0
  buffer_load_dwordx4 v14, s[40:43], s60 offen offset:0 nt lds
  v_mfma_f32_16x16x32_bf16 v[116:119], a[240:243], a[16:19], v[116:119]
  ds_read_b64_tr_b16 v[62:63], v9 offset:2048
  ds_read_b64_tr_b16 v[76:77], v9 offset:4096
  v_mfma_f32_16x16x32_bf16 v[116:119], a[244:247], a[20:23], v[116:119]
  ds_read_b64_tr_b16 v[78:79], v9 offset:6144
  v_mfma_f32_16x16x32_bf16 v[116:119], a[248:251], a[24:27], v[116:119]
  ds_read_b64_tr_b16 v[64:65], v10 offset:0
  ds_read_b64_tr_b16 v[66:67], v10 offset:2048
  v_mfma_f32_16x16x32_bf16 v[116:119], a[252:255], a[28:31], v[116:119]
  buffer_load_dwordx4 v15, s[40:43], s60 offen offset:1024 nt lds
  ds_read_b64_tr_b16 v[80:81], v10 offset:4096
  v_mfma_f32_16x16x32_bf16 v[120:123], a[224:227], a[32:35], v[92:95]
  ds_read_b64_tr_b16 v[82:83], v10 offset:6144
  ds_read_b64_tr_b16 v[68:69], v11 offset:0
  v_mfma_f32_16x16x32_bf16 v[120:123], a[228:231], a[36:39], v[120:123]
  ds_read_b64_tr_b16 v[70:71], v11 offset:2048
  v_mfma_f32_16x16x32_bf16 v[120:123], a[232:235], a[40:43], v[120:123]
  ds_read_b64_tr_b16 v[84:85], v11 offset:4096
  ds_read_b64_tr_b16 v[86:87], v11 offset:6144
  v_mfma_f32_16x16x32_bf16 v[120:123], a[236:239], a[44:47], v[120:123]
  v_mfma_f32_16x16x32_bf16 v[120:123], a[240:243], a[48:51], v[120:123]
  v_mfma_f32_16x16x32_bf16 v[120:123], a[244:247], a[52:55], v[120:123]
  v_mfma_f32_16x16x32_bf16 v[120:123], a[248:251], a[56:59], v[120:123]
  buffer_load_dwordx4 v16, s[40:43], s60 offen offset:2048 nt lds
  v_mfma_f32_16x16x32_bf16 v[120:123], a[252:255], a[60:63], v[120:123]
  v_exp_f32 v116, v116
  v_mfma_f32_16x16x32_bf16 v[124:127], a[224:227], a[64:67], v[96:99]
  v_exp_f32 v117, v117
  v_mfma_f32_16x16x32_bf16 v[124:127], a[228:231], a[68:71], v[124:127]
  v_exp_f32 v118, v118
  v_mfma_f32_16x16x32_bf16 v[124:127], a[232:235], a[72:75], v[124:127]
  v_cvt_pk_bf16_f32 v26, v116, v117
  v_mfma_f32_16x16x32_bf16 v[124:127], a[236:239], a[76:79], v[124:127]
  v_exp_f32 v119, v119
  v_mfma_f32_16x16x32_bf16 v[124:127], a[240:243], a[80:83], v[124:127]
  v_add_f32 v33, v33, v116
  v_cvt_pk_bf16_f32 v27, v118, v119
  v_mfma_f32_16x16x32_bf16 v[124:127], a[244:247], a[84:87], v[124:127]
  buffer_load_dwordx4 v17, s[40:43], s60 offen offset:3072 nt lds
  v_add_f32 v33, v33, v117
  v_mfma_f32_16x16x32_bf16 v[124:127], a[248:251], a[88:91], v[124:127]
  ds_write_b64 v12, v[26:27] offset:14336
  v_add_f32 v33, v33, v118
  v_mfma_f32_16x16x32_bf16 v[124:127], a[252:255], a[92:95], v[124:127]
  v_add_f32 v33, v33, v119
  v_mfma_f32_16x16x32_bf16 v[128:131], a[224:227], a[96:99], v[100:103]
  v_exp_f32 v120, v120
  v_mfma_f32_16x16x32_bf16 v[128:131], a[228:231], a[100:103], v[128:131]
  v_exp_f32 v121, v121
  v_mfma_f32_16x16x32_bf16 v[128:131], a[232:235], a[104:107], v[128:131]
  v_exp_f32 v122, v122
  v_mfma_f32_16x16x32_bf16 v[128:131], a[236:239], a[108:111], v[128:131]
  ds_read_b128 v[40:43], v13 offset:0
  v_cvt_pk_bf16_f32 v28, v120, v121
  v_mfma_f32_16x16x32_bf16 v[128:131], a[240:243], a[112:115], v[128:131]
  v_exp_f32 v123, v123
  v_mfma_f32_16x16x32_bf16 v[128:131], a[244:247], a[116:119], v[128:131]
  v_add_f32 v34, v34, v120
  v_cvt_pk_bf16_f32 v29, v122, v123
  v_mfma_f32_16x16x32_bf16 v[128:131], a[248:251], a[120:123], v[128:131]
  ds_read_b128 v[44:47], v13 offset:1024
  v_add_f32 v34, v34, v121
  v_mfma_f32_16x16x32_bf16 v[128:131], a[252:255], a[124:127], v[128:131]
  ds_write_b64 v12, v[28:29] offset:16384
  v_add_f32 v34, v34, v122
  v_mfma_f32_16x16x32_bf16 v[132:135], a[224:227], a[128:131], v[104:107]
  ds_read_b128 v[48:51], v13 offset:2048
  v_add_f32 v34, v34, v123
  v_mfma_f32_16x16x32_bf16 v[132:135], a[228:231], a[132:135], v[132:135]
  s_add_u32 m0, s62, 12288
  s_nop 0
  v_mfma_f32_16x16x32_bf16 v[132:135], a[232:235], a[136:139], v[132:135]
  buffer_load_dwordx4 v18, s[40:43], s60 offen offset:0 nt lds
  ds_read_b128 v[52:55], v13 offset:3072
  v_mfma_f32_16x16x32_bf16 v[132:135], a[236:239], a[140:143], v[132:135]
  v_exp_f32 v124, v124
  v_mfma_f32_16x16x32_bf16 v[132:135], a[240:243], a[144:147], v[132:135]
  v_exp_f32 v125, v125
  v_mfma_f32_16x16x32_bf16 v[132:135], a[244:247], a[148:151], v[132:135]
  v_exp_f32 v126, v126
  v_mfma_f32_16x16x32_bf16 v[132:135], a[248:251], a[152:155], v[132:135]
  buffer_load_dwordx4 v19, s[40:43], s60 offen offset:1024 nt lds
  v_cvt_pk_bf16_f32 v30, v124, v125
  v_mfma_f32_16x16x32_bf16 v[132:135], a[252:255], a[156:159], v[132:135]
  v_exp_f32 v127, v127
  v_mfma_f32_16x16x32_bf16 v[136:139], a[224:227], a[160:163], v[108:111]
  v_add_f32 v35, v35, v124
  v_cvt_pk_bf16_f32 v31, v126, v127
  v_mfma_f32_16x16x32_bf16 v[136:139], a[228:231], a[164:167], v[136:139]
  v_add_f32 v35, v35, v125
  v_mfma_f32_16x16x32_bf16 v[136:139], a[232:235], a[168:171], v[136:139]
  ds_write_b64 v12, v[30:31] offset:18432
  v_add_f32 v35, v35, v126
  v_mfma_f32_16x16x32_bf16 v[136:139], a[236:239], a[172:175], v[136:139]
  buffer_load_dwordx4 v20, s[40:43], s60 offen offset:2048 nt lds
  v_add_f32 v35, v35, v127
  v_mfma_f32_16x16x32_bf16 v[136:139], a[240:243], a[176:179], v[136:139]
  v_exp_f32 v128, v128
  v_mfma_f32_16x16x32_bf16 v[136:139], a[244:247], a[180:183], v[136:139]
  v_exp_f32 v129, v129
  v_mfma_f32_16x16x32_bf16 v[136:139], a[248:251], a[184:187], v[136:139]
  v_exp_f32 v130, v130
  v_mfma_f32_16x16x32_bf16 v[136:139], a[252:255], a[188:191], v[136:139]
  v_cvt_pk_bf16_f32 v26, v128, v129
  v_mfma_f32_16x16x32_bf16 v[140:143], a[224:227], a[192:195], v[112:115]
  v_exp_f32 v131, v131
  v_mfma_f32_16x16x32_bf16 v[140:143], a[228:231], a[196:199], v[140:143]
  v_add_f32 v36, v36, v128
  v_cvt_pk_bf16_f32 v27, v130, v131
  v_mfma_f32_16x16x32_bf16 v[140:143], a[232:235], a[200:203], v[140:143]
  buffer_load_dwordx4 v21, s[40:43], s60 offen offset:3072 nt lds
  v_add_f32 v36, v36, v129
  v_mfma_f32_16x16x32_bf16 v[140:143], a[236:239], a[204:207], v[140:143]
  ds_write_b64 v12, v[26:27] offset:20480
  v_add_f32 v36, v36, v130
  v_mfma_f32_16x16x32_bf16 v[140:143], a[240:243], a[208:211], v[140:143]
  v_add_f32 v36, v36, v131
  v_mfma_f32_16x16x32_bf16 v[140:143], a[244:247], a[212:215], v[140:143]
  v_exp_f32 v132, v132
  v_mfma_f32_16x16x32_bf16 v[140:143], a[248:251], a[216:219], v[140:143]
  v_exp_f32 v133, v133
  v_mfma_f32_16x16x32_bf16 v[140:143], a[252:255], a[220:223], v[140:143]
  v_exp_f32 v134, v134
  s_waitcnt lgkmcnt(6)
  v_mfma_f32_16x16x32_bf16 v[144:147], v[56:59], v[40:43], v[144:147]
  v_cvt_pk_bf16_f32 v28, v132, v133
  s_waitcnt vmcnt(16)
  s_waitcnt lgkmcnt(5)
  v_mfma_f32_16x16x32_bf16 v[144:147], v[72:75], v[44:47], v[144:147]
  v_exp_f32 v135, v135
  v_mfma_f32_16x16x32_bf16 v[148:151], v[76:79], v[44:47], v[148:151]
  v_add_f32 v37, v37, v132
  v_cvt_pk_bf16_f32 v29, v134, v135
  v_mfma_f32_16x16x32_bf16 v[148:151], v[60:63], v[40:43], v[148:151]
  ds_read_b128 a[224:227], v4 offset:0
  v_add_f32 v37, v37, v133
  v_mfma_f32_16x16x32_bf16 v[152:155], v[64:67], v[40:43], v[152:155]
  ds_write_b64 v12, v[28:29] offset:22528
  v_add_f32 v37, v37, v134
  v_mfma_f32_16x16x32_bf16 v[152:155], v[80:83], v[44:47], v[152:155]
  ds_read_b128 a[228:231], v5 offset:0
  v_add_f32 v37, v37, v135
  v_mfma_f32_16x16x32_bf16 v[156:159], v[84:87], v[44:47], v[156:159]
  v_exp_f32 v136, v136
  v_mfma_f32_16x16x32_bf16 v[156:159], v[68:71], v[40:43], v[156:159]
  v_exp_f32 v137, v137
  s_waitcnt lgkmcnt(6)
  v_mfma_f32_16x16x32_bf16 v[160:163], v[56:59], v[48:51], v[160:163]
  ds_read_b128 v[40:43], v13 offset:4096
  ds_read_b128 v[44:47], v13 offset:5120
  s_waitcnt lgkmcnt(7)
  v_mfma_f32_16x16x32_bf16 v[160:163], v[72:75], v[52:55], v[160:163]
  v_exp_f32 v138, v138
  v_mfma_f32_16x16x32_bf16 v[164:167], v[76:79], v[52:55], v[164:167]
  s_add_u32 m0, s62, 16384
  v_cvt_pk_bf16_f32 v30, v136, v137
  v_mfma_f32_16x16x32_bf16 v[164:167], v[60:63], v[48:51], v[164:167]
  v_exp_f32 v139, v139
  v_mfma_f32_16x16x32_bf16 v[168:171], v[64:67], v[48:51], v[168:171]
  s_add_u32 s61, s61, 32768
  v_add_f32 v38, v38, v136
  v_mfma_f32_16x16x32_bf16 v[168:171], v[80:83], v[52:55], v[168:171]
  v_cvt_pk_bf16_f32 v31, v138, v139
  v_add_f32 v38, v38, v137
  v_mfma_f32_16x16x32_bf16 v[172:175], v[84:87], v[52:55], v[172:175]
  buffer_load_dwordx4 v22, s[44:47], s61 offen offset:0 nt lds
  ds_write_b64 v12, v[30:31] offset:24576
  v_mfma_f32_16x16x32_bf16 v[172:175], v[68:71], v[48:51], v[172:175]
  ds_read_b128 v[48:51], v13 offset:6144
  v_add_f32 v38, v38, v138
  s_waitcnt lgkmcnt(3)
  v_mfma_f32_16x16x32_bf16 v[176:179], v[56:59], v[40:43], v[176:179]
  ds_read_b128 v[52:55], v13 offset:7168
  v_add_f32 v38, v38, v139
  s_waitcnt lgkmcnt(3)
  v_mfma_f32_16x16x32_bf16 v[176:179], v[72:75], v[44:47], v[176:179]
  v_exp_f32 v140, v140
  v_mfma_f32_16x16x32_bf16 v[180:183], v[76:79], v[44:47], v[180:183]
  v_exp_f32 v141, v141
  v_mfma_f32_16x16x32_bf16 v[180:183], v[60:63], v[40:43], v[180:183]
  buffer_load_dwordx4 v23, s[44:47], s61 offen offset:1024 nt lds
  ds_read_b128 a[232:235], v6 offset:0
  v_mfma_f32_16x16x32_bf16 v[184:187], v[64:67], v[40:43], v[184:187]
  v_exp_f32 v142, v142
  v_mfma_f32_16x16x32_bf16 v[184:187], v[80:83], v[44:47], v[184:187]
  buffer_load_dwordx4 v24, s[44:47], s61 offen offset:2048 nt lds
  v_cvt_pk_bf16_f32 v26, v140, v141
  v_mfma_f32_16x16x32_bf16 v[188:191], v[84:87], v[44:47], v[188:191]
  v_exp_f32 v143, v143
  v_mfma_f32_16x16x32_bf16 v[188:191], v[68:71], v[40:43], v[188:191]
  ds_read_b128 v[40:43], v13 offset:8192
  ds_read_b128 v[44:47], v13 offset:9216
  s_waitcnt lgkmcnt(4)
  v_mfma_f32_16x16x32_bf16 v[192:195], v[56:59], v[48:51], v[192:195]
  v_add_f32 v39, v39, v140
  v_cvt_pk_bf16_f32 v27, v142, v143
  s_waitcnt lgkmcnt(3)
  v_mfma_f32_16x16x32_bf16 v[192:195], v[72:75], v[52:55], v[192:195]
  ds_read_b128 a[236:239], v7 offset:0
  v_add_f32 v39, v39, v141
  v_mfma_f32_16x16x32_bf16 v[196:199], v[76:79], v[52:55], v[196:199]
  ds_read_b128 a[240:243], v4 offset:256
  ds_write_b64 v12, v[26:27] offset:26624
  v_mfma_f32_16x16x32_bf16 v[196:199], v[60:63], v[48:51], v[196:199]
  buffer_load_dwordx4 v25, s[44:47], s61 offen offset:3072 nt lds
  ds_read_b128 a[244:247], v5 offset:256
  v_mfma_f32_16x16x32_bf16 v[200:203], v[64:67], v[48:51], v[200:203]
  ds_read_b128 a[248:251], v6 offset:256
  v_add_f32 v39, v39, v142
  v_mfma_f32_16x16x32_bf16 v[200:203], v[80:83], v[52:55], v[200:203]
  ds_read_b128 a[252:255], v7 offset:256
  v_add_f32 v39, v39, v143
  v_mfma_f32_16x16x32_bf16 v[204:207], v[84:87], v[52:55], v[204:207]
  v_mfma_f32_16x16x32_bf16 v[204:207], v[68:71], v[48:51], v[204:207]
  ds_read_b128 v[48:51], v13 offset:10240
  s_add_u32 m0, s62, 20480
  s_waitcnt lgkmcnt(8)
  v_mfma_f32_16x16x32_bf16 v[208:211], v[56:59], v[40:43], v[208:211]
  ds_read_b128 v[52:55], v13 offset:11264
  s_add_u32 s66, s61, 16384
  s_waitcnt lgkmcnt(8)
  v_mfma_f32_16x16x32_bf16 v[208:211], v[72:75], v[44:47], v[208:211]
  buffer_load_dwordx4 v22, s[44:47], s66 offen offset:0 nt lds
  v_mfma_f32_16x16x32_bf16 v[212:215], v[76:79], v[44:47], v[212:215]
  v_mfma_f32_16x16x32_bf16 v[212:215], v[60:63], v[40:43], v[212:215]
  v_mfma_f32_16x16x32_bf16 v[216:219], v[64:67], v[40:43], v[216:219]
  v_mfma_f32_16x16x32_bf16 v[216:219], v[80:83], v[44:47], v[216:219]
  v_mfma_f32_16x16x32_bf16 v[220:223], v[84:87], v[44:47], v[220:223]
  buffer_load_dwordx4 v23, s[44:47], s66 offen offset:1024 nt lds
  v_mfma_f32_16x16x32_bf16 v[220:223], v[68:71], v[40:43], v[220:223]
  ds_read_b128 v[40:43], v13 offset:12288
  ds_read_b128 v[44:47], v13 offset:13312
  s_waitcnt lgkmcnt(3)
  v_mfma_f32_16x16x32_bf16 v[224:227], v[56:59], v[48:51], v[224:227]
  s_waitcnt lgkmcnt(2)
  v_mfma_f32_16x16x32_bf16 v[224:227], v[72:75], v[52:55], v[224:227]
  v_mfma_f32_16x16x32_bf16 v[228:231], v[76:79], v[52:55], v[228:231]
  v_mfma_f32_16x16x32_bf16 v[228:231], v[60:63], v[48:51], v[228:231]
  v_mfma_f32_16x16x32_bf16 v[232:235], v[64:67], v[48:51], v[232:235]
  buffer_load_dwordx4 v24, s[44:47], s66 offen offset:2048 nt lds
  v_mfma_f32_16x16x32_bf16 v[232:235], v[80:83], v[52:55], v[232:235]
  v_mfma_f32_16x16x32_bf16 v[236:239], v[84:87], v[52:55], v[236:239]
  v_mfma_f32_16x16x32_bf16 v[236:239], v[68:71], v[48:51], v[236:239]
  s_waitcnt lgkmcnt(1)
  v_mfma_f32_16x16x32_bf16 v[240:243], v[56:59], v[40:43], v[240:243]
  s_waitcnt lgkmcnt(0)
  v_mfma_f32_16x16x32_bf16 v[240:243], v[72:75], v[44:47], v[240:243]
  v_mfma_f32_16x16x32_bf16 v[244:247], v[76:79], v[44:47], v[244:247]
  buffer_load_dwordx4 v25, s[44:47], s66 offen offset:3072 nt lds
  v_mfma_f32_16x16x32_bf16 v[244:247], v[60:63], v[40:43], v[244:247]
  v_mfma_f32_16x16x32_bf16 v[248:251], v[64:67], v[40:43], v[248:251]
  v_mfma_f32_16x16x32_bf16 v[248:251], v[80:83], v[44:47], v[248:251]
  v_mfma_f32_16x16x32_bf16 v[252:255], v[84:87], v[44:47], v[252:255]
  v_mfma_f32_16x16x32_bf16 v[252:255], v[68:71], v[40:43], v[252:255]
  s_sub_u32 s63, s63, 1
  s_cmp_lg_u32 s63, 0
  s_cbranch_scc1 L_loop
  s_waitcnt vmcnt(16)
  s_barrier
  v_mfma_f32_16x16x32_bf16 v[116:119], a[224:227], a[0:3], v[88:91]
  s_add_u32 m0, s62, 0
  ds_read_b64_tr_b16 v[56:57], v8 offset:8192
  v_mfma_f32_16x16x32_bf16 v[116:119], a[228:231], a[4:7], v[116:119]
  s_add_u32 s60, s60, 32768
  ds_read_b64_tr_b16 v[58:59], v8 offset:10240
  v_mfma_f32_16x16x32_bf16 v[116:119], a[232:235], a[8:11], v[116:119]
  ds_read_b64_tr_b16 v[72:73], v8 offset:12288
  ds_read_b64_tr_b16 v[74:75], v8 offset:14336
  v_mfma_f32_16x16x32_bf16 v[116:119], a[236:239], a[12:15], v[116:119]
  ds_read_b64_tr_b16 v[60:61], v9 offset:8192
  buffer_load_dwordx4 v14, s[40:43], s60 offen offset:0 nt lds
  v_mfma_f32_16x16x32_bf16 v[116:119], a[240:243], a[16:19], v[116:119]
  ds_read_b64_tr_b16 v[62:63], v9 offset:10240
  ds_read_b64_tr_b16 v[76:77], v9 offset:12288
  v_mfma_f32_16x16x32_bf16 v[116:119], a[244:247], a[20:23], v[116:119]
  ds_read_b64_tr_b16 v[78:79], v9 offset:14336
  v_mfma_f32_16x16x32_bf16 v[116:119], a[248:251], a[24:27], v[116:119]
  ds_read_b64_tr_b16 v[64:65], v10 offset:8192
  ds_read_b64_tr_b16 v[66:67], v10 offset:10240
  v_mfma_f32_16x16x32_bf16 v[116:119], a[252:255], a[28:31], v[116:119]
  buffer_load_dwordx4 v15, s[40:43], s60 offen offset:1024 nt lds
  ds_read_b64_tr_b16 v[80:81], v10 offset:12288
  v_mfma_f32_16x16x32_bf16 v[120:123], a[224:227], a[32:35], v[92:95]
  ds_read_b64_tr_b16 v[82:83], v10 offset:14336
  ds_read_b64_tr_b16 v[68:69], v11 offset:8192
  v_mfma_f32_16x16x32_bf16 v[120:123], a[228:231], a[36:39], v[120:123]
  ds_read_b64_tr_b16 v[70:71], v11 offset:10240
  v_mfma_f32_16x16x32_bf16 v[120:123], a[232:235], a[40:43], v[120:123]
  ds_read_b64_tr_b16 v[84:85], v11 offset:12288
  ds_read_b64_tr_b16 v[86:87], v11 offset:14336
  v_mfma_f32_16x16x32_bf16 v[120:123], a[236:239], a[44:47], v[120:123]
  v_mfma_f32_16x16x32_bf16 v[120:123], a[240:243], a[48:51], v[120:123]
  v_mfma_f32_16x16x32_bf16 v[120:123], a[244:247], a[52:55], v[120:123]
  v_mfma_f32_16x16x32_bf16 v[120:123], a[248:251], a[56:59], v[120:123]
  buffer_load_dwordx4 v16, s[40:43], s60 offen offset:2048 nt lds
  v_mfma_f32_16x16x32_bf16 v[120:123], a[252:255], a[60:63], v[120:123]
  v_exp_f32 v116, v116
  v_mfma_f32_16x16x32_bf16 v[124:127], a[224:227], a[64:67], v[96:99]
  v_exp_f32 v117, v117
  v_mfma_f32_16x16x32_bf16 v[124:127], a[228:231], a[68:71], v[124:127]
  v_exp_f32 v118, v118
  v_mfma_f32_16x16x32_bf16 v[124:127], a[232:235], a[72:75], v[124:127]
  v_cvt_pk_bf16_f32 v26, v116, v117
  v_mfma_f32_16x16x32_bf16 v[124:127], a[236:239], a[76:79], v[124:127]
  v_exp_f32 v119, v119
  v_mfma_f32_16x16x32_bf16 v[124:127], a[240:243], a[80:83], v[124:127]
  v_add_f32 v33, v33, v116
  v_cvt_pk_bf16_f32 v27, v118, v119
  v_mfma_f32_16x16x32_bf16 v[124:127], a[244:247], a[84:87], v[124:127]
  buffer_load_dwordx4 v17, s[40:43], s60 offen offset:3072 nt lds
  v_add_f32 v33, v33, v117
  v_mfma_f32_16x16x32_bf16 v[124:127], a[248:251], a[88:91], v[124:127]
  ds_write_b64 v12, v[26:27] offset:0
  v_add_f32 v33, v33, v118
  v_mfma_f32_16x16x32_bf16 v[124:127], a[252:255], a[92:95], v[124:127]
  v_add_f32 v33, v33, v119
  v_mfma_f32_16x16x32_bf16 v[128:131], a[224:227], a[96:99], v[100:103]
  v_exp_f32 v120, v120
  v_mfma_f32_16x16x32_bf16 v[128:131], a[228:231], a[100:103], v[128:131]
  v_exp_f32 v121, v121
  v_mfma_f32_16x16x32_bf16 v[128:131], a[232:235], a[104:107], v[128:131]
  v_exp_f32 v122, v122
  v_mfma_f32_16x16x32_bf16 v[128:131], a[236:239], a[108:111], v[128:131]
  ds_read_b128 v[40:43], v13 offset:14336
  v_cvt_pk_bf16_f32 v28, v120, v121
  v_mfma_f32_16x16x32_bf16 v[128:131], a[240:243], a[112:115], v[128:131]
  v_exp_f32 v123, v123
  v_mfma_f32_16x16x32_bf16 v[128:131], a[244:247], a[116:119], v[128:131]
  v_add_f32 v34, v34, v120
  v_cvt_pk_bf16_f32 v29, v122, v123
  v_mfma_f32_16x16x32_bf16 v[128:131], a[248:251], a[120:123], v[128:131]
  ds_read_b128 v[44:47], v13 offset:15360
  v_add_f32 v34, v34, v121
  v_mfma_f32_16x16x32_bf16 v[128:131], a[252:255], a[124:127], v[128:131]
  ds_write_b64 v12, v[28:29] offset:2048
  v_add_f32 v34, v34, v122
  v_mfma_f32_16x16x32_bf16 v[132:135], a[224:227], a[128:131], v[104:107]
  ds_read_b128 v[48:51], v13 offset:16384
  v_add_f32 v34, v34, v123
  v_mfma_f32_16x16x32_bf16 v[132:135], a[228:231], a[132:135], v[132:135]
  s_add_u32 m0, s62, 4096
  s_nop 0
  v_mfma_f32_16x16x32_bf16 v[132:135], a[232:235], a[136:139], v[132:135]
  buffer_load_dwordx4 v18, s[40:43], s60 offen offset:0 nt lds
  ds_read_b128 v[52:55], v13 offset:17408
  v_mfma_f32_16x16x32_bf16 v[132:135], a[236:239], a[140:143], v[132:135]
  v_exp_f32 v124, v124
  v_mfma_f32_16x16x32_bf16 v[132:135], a[240:243], a[144:147], v[132:135]
  v_exp_f32 v125, v125
  v_mfma_f32_16x16x32_bf16 v[132:135], a[244:247], a[148:151], v[132:135]
  v_exp_f32 v126, v126
  v_mfma_f32_16x16x32_bf16 v[132:135], a[248:251], a[152:155], v[132:135]
  buffer_load_dwordx4 v19, s[40:43], s60 offen offset:1024 nt lds
  v_cvt_pk_bf16_f32 v30, v124, v125
  v_mfma_f32_16x16x32_bf16 v[132:135], a[252:255], a[156:159], v[132:135]
  v_exp_f32 v127, v127
  v_mfma_f32_16x16x32_bf16 v[136:139], a[224:227], a[160:163], v[108:111]
  v_add_f32 v35, v35, v124
  v_cvt_pk_bf16_f32 v31, v126, v127
  v_mfma_f32_16x16x32_bf16 v[136:139], a[228:231], a[164:167], v[136:139]
  v_add_f32 v35, v35, v125
  v_mfma_f32_16x16x32_bf16 v[136:139], a[232:235], a[168:171], v[136:139]
  ds_write_b64 v12, v[30:31] offset:4096
  v_add_f32 v35, v35, v126
  v_mfma_f32_16x16x32_bf16 v[136:139], a[236:239], a[172:175], v[136:139]
  buffer_load_dwordx4 v20, s[40:43], s60 offen offset:2048 nt lds
  v_add_f32 v35, v35, v127
  v_mfma_f32_16x16x32_bf16 v[136:139], a[240:243], a[176:179], v[136:139]
  v_exp_f32 v128, v128
  v_mfma_f32_16x16x32_bf16 v[136:139], a[244:247], a[180:183], v[136:139]
  v_exp_f32 v129, v129
  v_mfma_f32_16x16x32_bf16 v[136:139], a[248:251], a[184:187], v[136:139]
  v_exp_f32 v130, v130
  v_mfma_f32_16x16x32_bf16 v[136:139], a[252:255], a[188:191], v[136:139]
  v_cvt_pk_bf16_f32 v26, v128, v129
  v_mfma_f32_16x16x32_bf16 v[140:143], a[224:227], a[192:195], v[112:115]
  v_exp_f32 v131, v131
  v_mfma_f32_16x16x32_bf16 v[140:143], a[228:231], a[196:199], v[140:143]
  v_add_f32 v36, v36, v128
  v_cvt_pk_bf16_f32 v27, v130, v131
  v_mfma_f32_16x16x32_bf16 v[140:143], a[232:235], a[200:203], v[140:143]
  buffer_load_dwordx4 v21, s[40:43], s60 offen offset:3072 nt lds
  v_add_f32 v36, v36, v129
  v_mfma_f32_16x16x32_bf16 v[140:143], a[236:239], a[204:207], v[140:143]
  ds_write_b64 v12, v[26:27] offset:6144
  v_add_f32 v36, v36, v130
  v_mfma_f32_16x16x32_bf16 v[140:143], a[240:243], a[208:211], v[140:143]
  v_add_f32 v36, v36, v131
  v_mfma_f32_16x16x32_bf16 v[140:143], a[244:247], a[212:215], v[140:143]
  v_exp_f32 v132, v132
  v_mfma_f32_16x16x32_bf16 v[140:143], a[248:251], a[216:219], v[140:143]
  v_exp_f32 v133, v133
  v_mfma_f32_16x16x32_bf16 v[140:143], a[252:255], a[220:223], v[140:143]
  v_exp_f32 v134, v134
  s_waitcnt lgkmcnt(6)
  v_mfma_f32_16x16x32_bf16 v[144:147], v[56:59], v[40:43], v[144:147]
  v_cvt_pk_bf16_f32 v28, v132, v133
  s_waitcnt vmcnt(16)
  s_waitcnt lgkmcnt(5)
  v_mfma_f32_16x16x32_bf16 v[144:147], v[72:75], v[44:47], v[144:147]
  v_exp_f32 v135, v135
  v_mfma_f32_16x16x32_bf16 v[148:151], v[76:79], v[44:47], v[148:151]
  v_add_f32 v37, v37, v132
  v_cvt_pk_bf16_f32 v29, v134, v135
  v_mfma_f32_16x16x32_bf16 v[148:151], v[60:63], v[40:43], v[148:151]
  ds_read_b128 a[224:227], v4 offset:8192
  v_add_f32 v37, v37, v133
  v_mfma_f32_16x16x32_bf16 v[152:155], v[64:67], v[40:43], v[152:155]
  ds_write_b64 v12, v[28:29] offset:8192
  v_add_f32 v37, v37, v134
  v_mfma_f32_16x16x32_bf16 v[152:155], v[80:83], v[44:47], v[152:155]
  ds_read_b128 a[228:231], v5 offset:8192
  v_add_f32 v37, v37, v135
  v_mfma_f32_16x16x32_bf16 v[156:159], v[84:87], v[44:47], v[156:159]
  v_exp_f32 v136, v136
  v_mfma_f32_16x16x32_bf16 v[156:159], v[68:71], v[40:43], v[156:159]
  v_exp_f32 v137, v137
  s_waitcnt lgkmcnt(6)
  v_mfma_f32_16x16x32_bf16 v[160:163], v[56:59], v[48:51], v[160:163]
  ds_read_b128 v[40:43], v13 offset:18432
  ds_read_b128 v[44:47], v13 offset:19456
  s_waitcnt lgkmcnt(7)
  v_mfma_f32_16x16x32_bf16 v[160:163], v[72:75], v[52:55], v[160:163]
  v_exp_f32 v138, v138
  v_mfma_f32_16x16x32_bf16 v[164:167], v[76:79], v[52:55], v[164:167]
  s_add_u32 m0, s62, 24576
  v_cvt_pk_bf16_f32 v30, v136, v137
  v_mfma_f32_16x16x32_bf16 v[164:167], v[60:63], v[48:51], v[164:167]
  v_exp_f32 v139, v139
  v_mfma_f32_16x16x32_bf16 v[168:171], v[64:67], v[48:51], v[168:171]
  s_add_u32 s61, s61, 32768
  v_add_f32 v38, v38, v136
  v_mfma_f32_16x16x32_bf16 v[168:171], v[80:83], v[52:55], v[168:171]
  v_cvt_pk_bf16_f32 v31, v138, v139
  v_add_f32 v38, v38, v137
  v_mfma_f32_16x16x32_bf16 v[172:175], v[84:87], v[52:55], v[172:175]
  buffer_load_dwordx4 v22, s[44:47], s61 offen offset:0 nt lds
  ds_write_b64 v12, v[30:31] offset:10240
  v_mfma_f32_16x16x32_bf16 v[172:175], v[68:71], v[48:51], v[172:175]
  ds_read_b128 v[48:51], v13 offset:20480
  v_add_f32 v38, v38, v138
  s_waitcnt lgkmcnt(3)
  v_mfma_f32_16x16x32_bf16 v[176:179], v[56:59], v[40:43], v[176:179]
  ds_read_b128 v[52:55], v13 offset:21504
  v_add_f32 v38, v38, v139
  s_waitcnt lgkmcnt(3)
  v_mfma_f32_16x16x32_bf16 v[176:179], v[72:75], v[44:47], v[176:179]
  v_exp_f32 v140, v140
  v_mfma_f32_16x16x32_bf16 v[180:183], v[76:79], v[44:47], v[180:183]
  v_exp_f32 v141, v141
  v_mfma_f32_16x16x32_bf16 v[180:183], v[60:63], v[40:43], v[180:183]
  buffer_load_dwordx4 v23, s[44:47], s61 offen offset:1024 nt lds
  ds_read_b128 a[232:235], v6 offset:8192
  v_mfma_f32_16x16x32_bf16 v[184:187], v[64:67], v[40:43], v[184:187]
  v_exp_f32 v142, v142
  v_mfma_f32_16x16x32_bf16 v[184:187], v[80:83], v[44:47], v[184:187]
  buffer_load_dwordx4 v24, s[44:47], s61 offen offset:2048 nt lds
  v_cvt_pk_bf16_f32 v26, v140, v141
  v_mfma_f32_16x16x32_bf16 v[188:191], v[84:87], v[44:47], v[188:191]
  v_exp_f32 v143, v143
  v_mfma_f32_16x16x32_bf16 v[188:191], v[68:71], v[40:43], v[188:191]
  ds_read_b128 v[40:43], v13 offset:22528
  ds_read_b128 v[44:47], v13 offset:23552
  s_waitcnt lgkmcnt(4)
  v_mfma_f32_16x16x32_bf16 v[192:195], v[56:59], v[48:51], v[192:195]
  v_add_f32 v39, v39, v140
  v_cvt_pk_bf16_f32 v27, v142, v143
  s_waitcnt lgkmcnt(3)
  v_mfma_f32_16x16x32_bf16 v[192:195], v[72:75], v[52:55], v[192:195]
  ds_read_b128 a[236:239], v7 offset:8192
  v_add_f32 v39, v39, v141
  v_mfma_f32_16x16x32_bf16 v[196:199], v[76:79], v[52:55], v[196:199]
  ds_read_b128 a[240:243], v4 offset:8448
  ds_write_b64 v12, v[26:27] offset:12288
  v_mfma_f32_16x16x32_bf16 v[196:199], v[60:63], v[48:51], v[196:199]
  buffer_load_dwordx4 v25, s[44:47], s61 offen offset:3072 nt lds
  ds_read_b128 a[244:247], v5 offset:8448
  v_mfma_f32_16x16x32_bf16 v[200:203], v[64:67], v[48:51], v[200:203]
  ds_read_b128 a[248:251], v6 offset:8448
  v_add_f32 v39, v39, v142
  v_mfma_f32_16x16x32_bf16 v[200:203], v[80:83], v[52:55], v[200:203]
  ds_read_b128 a[252:255], v7 offset:8448
  v_add_f32 v39, v39, v143
  v_mfma_f32_16x16x32_bf16 v[204:207], v[84:87], v[52:55], v[204:207]
  v_mfma_f32_16x16x32_bf16 v[204:207], v[68:71], v[48:51], v[204:207]
  ds_read_b128 v[48:51], v13 offset:24576
  s_add_u32 m0, s62, 28672
  s_waitcnt lgkmcnt(8)
  v_mfma_f32_16x16x32_bf16 v[208:211], v[56:59], v[40:43], v[208:211]
  ds_read_b128 v[52:55], v13 offset:25600
  s_add_u32 s66, s61, 16384
  s_waitcnt lgkmcnt(8)
  v_mfma_f32_16x16x32_bf16 v[208:211], v[72:75], v[44:47], v[208:211]
  buffer_load_dwordx4 v22, s[44:47], s66 offen offset:0 nt lds
  v_mfma_f32_16x16x32_bf16 v[212:215], v[76:79], v[44:47], v[212:215]
  v_mfma_f32_16x16x32_bf16 v[212:215], v[60:63], v[40:43], v[212:215]
  v_mfma_f32_16x16x32_bf16 v[216:219], v[64:67], v[40:43], v[216:219]
  v_mfma_f32_16x16x32_bf16 v[216:219], v[80:83], v[44:47], v[216:219]
  v_mfma_f32_16x16x32_bf16 v[220:223], v[84:87], v[44:47], v[220:223]
  buffer_load_dwordx4 v23, s[44:47], s66 offen offset:1024 nt lds
  v_mfma_f32_16x16x32_bf16 v[220:223], v[68:71], v[40:43], v[220:223]
  ds_read_b128 v[40:43], v13 offset:26624
  ds_read_b128 v[44:47], v13 offset:27648
  s_waitcnt lgkmcnt(3)
  v_mfma_f32_16x16x32_bf16 v[224:227], v[56:59], v[48:51], v[224:227]
  s_waitcnt lgkmcnt(2)
  v_mfma_f32_16x16x32_bf16 v[224:227], v[72:75], v[52:55], v[224:227]
  v_mfma_f32_16x16x32_bf16 v[228:231], v[76:79], v[52:55], v[228:231]
  v_mfma_f32_16x16x32_bf16 v[228:231], v[60:63], v[48:51], v[228:231]
  v_mfma_f32_16x16x32_bf16 v[232:235], v[64:67], v[48:51], v[232:235]
  buffer_load_dwordx4 v24, s[44:47], s66 offen offset:2048 nt lds
  v_mfma_f32_16x16x32_bf16 v[232:235], v[80:83], v[52:55], v[232:235]
  v_mfma_f32_16x16x32_bf16 v[236:239], v[84:87], v[52:55], v[236:239]
  v_mfma_f32_16x16x32_bf16 v[236:239], v[68:71], v[48:51], v[236:239]
  s_waitcnt lgkmcnt(1)
  v_mfma_f32_16x16x32_bf16 v[240:243], v[56:59], v[40:43], v[240:243]
  s_waitcnt lgkmcnt(0)
  v_mfma_f32_16x16x32_bf16 v[240:243], v[72:75], v[44:47], v[240:243]
  v_mfma_f32_16x16x32_bf16 v[244:247], v[76:79], v[44:47], v[244:247]
  buffer_load_dwordx4 v25, s[44:47], s66 offen offset:3072 nt lds
  v_mfma_f32_16x16x32_bf16 v[244:247], v[60:63], v[40:43], v[244:247]
  v_mfma_f32_16x16x32_bf16 v[248:251], v[64:67], v[40:43], v[248:251]
  v_mfma_f32_16x16x32_bf16 v[248:251], v[80:83], v[44:47], v[248:251]
  v_mfma_f32_16x16x32_bf16 v[252:255], v[84:87], v[44:47], v[252:255]
  v_mfma_f32_16x16x32_bf16 v[252:255], v[68:71], v[40:43], v[252:255]
  s_waitcnt vmcnt(16)
  s_barrier
  v_mfma_f32_16x16x32_bf16 v[116:119], a[224:227], a[0:3], v[88:91]
  s_add_u32 m0, s62, 8192
  ds_read_b64_tr_b16 v[56:57], v8 offset:0
  v_mfma_f32_16x16x32_bf16 v[116:119], a[228:231], a[4:7], v[116:119]
  s_add_u32 s60, s60, 32768
  ds_read_b64_tr_b16 v[58:59], v8 offset:2048
  v_mfma_f32_16x16x32_bf16 v[116:119], a[232:235], a[8:11], v[116:119]
  ds_read_b64_tr_b16 v[72:73], v8 offset:4096
  ds_read_b64_tr_b16 v[74:75], v8 offset:6144
  v_mfma_f32_16x16x32_bf16 v[116:119], a[236:239], a[12:15], v[116:119]
  ds_read_b64_tr_b16 v[60:61], v9 offset:0
  buffer_load_dwordx4 v14, s[40:43], s60 offen offset:0 nt lds
  v_mfma_f32_16x16x32_bf16 v[116:119], a[240:243], a[16:19], v[116:119]
  ds_read_b64_tr_b16 v[62:63], v9 offset:2048
  ds_read_b64_tr_b16 v[76:77], v9 offset:4096
  v_mfma_f32_16x16x32_bf16 v[116:119], a[244:247], a[20:23], v[116:119]
  ds_read_b64_tr_b16 v[78:79], v9 offset:6144
  v_mfma_f32_16x16x32_bf16 v[116:119], a[248:251], a[24:27], v[116:119]
  ds_read_b64_tr_b16 v[64:65], v10 offset:0
  ds_read_b64_tr_b16 v[66:67], v10 offset:2048
  v_mfma_f32_16x16x32_bf16 v[116:119], a[252:255], a[28:31], v[116:119]
  buffer_load_dwordx4 v15, s[40:43], s60 offen offset:1024 nt lds
  ds_read_b64_tr_b16 v[80:81], v10 offset:4096
  v_mfma_f32_16x16x32_bf16 v[120:123], a[224:227], a[32:35], v[92:95]
  ds_read_b64_tr_b16 v[82:83], v10 offset:6144
  ds_read_b64_tr_b16 v[68:69], v11 offset:0
  v_mfma_f32_16x16x32_bf16 v[120:123], a[228:231], a[36:39], v[120:123]
  ds_read_b64_tr_b16 v[70:71], v11 offset:2048
  v_mfma_f32_16x16x32_bf16 v[120:123], a[232:235], a[40:43], v[120:123]
  ds_read_b64_tr_b16 v[84:85], v11 offset:4096
  ds_read_b64_tr_b16 v[86:87], v11 offset:6144
  v_mfma_f32_16x16x32_bf16 v[120:123], a[236:239], a[44:47], v[120:123]
  v_mfma_f32_16x16x32_bf16 v[120:123], a[240:243], a[48:51], v[120:123]
  v_mfma_f32_16x16x32_bf16 v[120:123], a[244:247], a[52:55], v[120:123]
  v_mfma_f32_16x16x32_bf16 v[120:123], a[248:251], a[56:59], v[120:123]
  buffer_load_dwordx4 v16, s[40:43], s60 offen offset:2048 nt lds
  v_mfma_f32_16x16x32_bf16 v[120:123], a[252:255], a[60:63], v[120:123]
  v_exp_f32 v116, v116
  v_mfma_f32_16x16x32_bf16 v[124:127], a[224:227], a[64:67], v[96:99]
  v_exp_f32 v117, v117
  v_mfma_f32_16x16x32_bf16 v[124:127], a[228:231], a[68:71], v[124:127]
  v_exp_f32 v118, v118
  v_mfma_f32_16x16x32_bf16 v[124:127], a[232:235], a[72:75], v[124:127]
  v_cvt_pk_bf16_f32 v26, v116, v117
  v_mfma_f32_16x16x32_bf16 v[124:127], a[236:239], a[76:79], v[124:127]
  v_exp_f32 v119, v119
  v_mfma_f32_16x16x32_bf16 v[124:127], a[240:243], a[80:83], v[124:127]
  v_add_f32 v33, v33, v116
  v_cvt_pk_bf16_f32 v27, v118, v119
  v_mfma_f32_16x16x32_bf16 v[124:127], a[244:247], a[84:87], v[124:127]
  buffer_load_dwordx4 v17, s[40:43], s60 offen offset:3072 nt lds
  v_add_f32 v33, v33, v117
  v_mfma_f32_16x16x32_bf16 v[124:127], a[248:251], a[88:91], v[124:127]
  ds_write_b64 v12, v[26:27] offset:14336
  v_add_f32 v33, v33, v118
  v_mfma_f32_16x16x32_bf16 v[124:127], a[252:255], a[92:95], v[124:127]
  v_add_f32 v33, v33, v119
  v_mfma_f32_16x16x32_bf16 v[128:131], a[224:227], a[96:99], v[100:103]
  v_exp_f32 v120, v120
  v_mfma_f32_16x16x32_bf16 v[128:131], a[228:231], a[100:103], v[128:131]
  v_exp_f32 v121, v121
  v_mfma_f32_16x16x32_bf16 v[128:131], a[232:235], a[104:107], v[128:131]
  v_exp_f32 v122, v122
  v_mfma_f32_16x16x32_bf16 v[128:131], a[236:239], a[108:111], v[128:131]
  ds_read_b128 v[40:43], v13 offset:0
  v_cvt_pk_bf16_f32 v28, v120, v121
  v_mfma_f32_16x16x32_bf16 v[128:131], a[240:243], a[112:115], v[128:131]
  v_exp_f32 v123, v123
  v_mfma_f32_16x16x32_bf16 v[128:131], a[244:247], a[116:119], v[128:131]
  v_add_f32 v34, v34, v120
  v_cvt_pk_bf16_f32 v29, v122, v123
  v_mfma_f32_16x16x32_bf16 v[128:131], a[248:251], a[120:123], v[128:131]
  ds_read_b128 v[44:47], v13 offset:1024
  v_add_f32 v34, v34, v121
  v_mfma_f32_16x16x32_bf16 v[128:131], a[252:255], a[124:127], v[128:131]
  ds_write_b64 v12, v[28:29] offset:16384
  v_add_f32 v34, v34, v122
  v_mfma_f32_16x16x32_bf16 v[132:135], a[224:227], a[128:131], v[104:107]
  ds_read_b128 v[48:51], v13 offset:2048
  v_add_f32 v34, v34, v123
  v_mfma_f32_16x16x32_bf16 v[132:135], a[228:231], a[132:135], v[132:135]
  s_add_u32 m0, s62, 12288
  s_nop 0
  v_mfma_f32_16x16x32_bf16 v[132:135], a[232:235], a[136:139], v[132:135]
  buffer_load_dwordx4 v18, s[40:43], s60 offen offset:0 nt lds
  ds_read_b128 v[52:55], v13 offset:3072
  v_mfma_f32_16x16x32_bf16 v[132:135], a[236:239], a[140:143], v[132:135]
  v_exp_f32 v124, v124
  v_mfma_f32_16x16x32_bf16 v[132:135], a[240:243], a[144:147], v[132:135]
  v_exp_f32 v125, v125
  v_mfma_f32_16x16x32_bf16 v[132:135], a[244:247], a[148:151], v[132:135]
  v_exp_f32 v126, v126
  v_mfma_f32_16x16x32_bf16 v[132:135], a[248:251], a[152:155], v[132:135]
  buffer_load_dwordx4 v19, s[40:43], s60 offen offset:1024 nt lds
  v_cvt_pk_bf16_f32 v30, v124, v125
  v_mfma_f32_16x16x32_bf16 v[132:135], a[252:255], a[156:159], v[132:135]
  v_exp_f32 v127, v127
  v_mfma_f32_16x16x32_bf16 v[136:139], a[224:227], a[160:163], v[108:111]
  v_add_f32 v35, v35, v124
  v_cvt_pk_bf16_f32 v31, v126, v127
  v_mfma_f32_16x16x32_bf16 v[136:139], a[228:231], a[164:167], v[136:139]
  v_add_f32 v35, v35, v125
  v_mfma_f32_16x16x32_bf16 v[136:139], a[232:235], a[168:171], v[136:139]
  ds_write_b64 v12, v[30:31] offset:18432
  v_add_f32 v35, v35, v126
  v_mfma_f32_16x16x32_bf16 v[136:139], a[236:239], a[172:175], v[136:139]
  buffer_load_dwordx4 v20, s[40:43], s60 offen offset:2048 nt lds
  v_add_f32 v35, v35, v127
  v_mfma_f32_16x16x32_bf16 v[136:139], a[240:243], a[176:179], v[136:139]
  v_exp_f32 v128, v128
  v_mfma_f32_16x16x32_bf16 v[136:139], a[244:247], a[180:183], v[136:139]
  v_exp_f32 v129, v129
  v_mfma_f32_16x16x32_bf16 v[136:139], a[248:251], a[184:187], v[136:139]
  v_exp_f32 v130, v130
  v_mfma_f32_16x16x32_bf16 v[136:139], a[252:255], a[188:191], v[136:139]
  v_cvt_pk_bf16_f32 v26, v128, v129
  v_mfma_f32_16x16x32_bf16 v[140:143], a[224:227], a[192:195], v[112:115]
  v_exp_f32 v131, v131
  v_mfma_f32_16x16x32_bf16 v[140:143], a[228:231], a[196:199], v[140:143]
  v_add_f32 v36, v36, v128
  v_cvt_pk_bf16_f32 v27, v130, v131
  v_mfma_f32_16x16x32_bf16 v[140:143], a[232:235], a[200:203], v[140:143]
  buffer_load_dwordx4 v21, s[40:43], s60 offen offset:3072 nt lds
  v_add_f32 v36, v36, v129
  v_mfma_f32_16x16x32_bf16 v[140:143], a[236:239], a[204:207], v[140:143]
  ds_write_b64 v12, v[26:27] offset:20480
  v_add_f32 v36, v36, v130
  v_mfma_f32_16x16x32_bf16 v[140:143], a[240:243], a[208:211], v[140:143]
  v_add_f32 v36, v36, v131
  v_mfma_f32_16x16x32_bf16 v[140:143], a[244:247], a[212:215], v[140:143]
  v_exp_f32 v132, v132
  v_mfma_f32_16x16x32_bf16 v[140:143], a[248:251], a[216:219], v[140:143]
  v_exp_f32 v133, v133
  v_mfma_f32_16x16x32_bf16 v[140:143], a[252:255], a[220:223], v[140:143]
  v_exp_f32 v134, v134
  s_waitcnt lgkmcnt(6)
  v_mfma_f32_16x16x32_bf16 v[144:147], v[56:59], v[40:43], v[144:147]
  v_cvt_pk_bf16_f32 v28, v132, v133
  s_waitcnt vmcnt(16)
  s_waitcnt lgkmcnt(5)
  v_mfma_f32_16x16x32_bf16 v[144:147], v[72:75], v[44:47], v[144:147]
  v_exp_f32 v135, v135
  v_mfma_f32_16x16x32_bf16 v[148:151], v[76:79], v[44:47], v[148:151]
  v_add_f32 v37, v37, v132
  v_cvt_pk_bf16_f32 v29, v134, v135
  v_mfma_f32_16x16x32_bf16 v[148:151], v[60:63], v[40:43], v[148:151]
  ds_read_b128 a[224:227], v4 offset:0
  v_add_f32 v37, v37, v133
  v_mfma_f32_16x16x32_bf16 v[152:155], v[64:67], v[40:43], v[152:155]
  ds_write_b64 v12, v[28:29] offset:22528
  v_add_f32 v37, v37, v134
  v_mfma_f32_16x16x32_bf16 v[152:155], v[80:83], v[44:47], v[152:155]
  ds_read_b128 a[228:231], v5 offset:0
  v_add_f32 v37, v37, v135
  v_mfma_f32_16x16x32_bf16 v[156:159], v[84:87], v[44:47], v[156:159]
  v_exp_f32 v136, v136
  v_mfma_f32_16x16x32_bf16 v[156:159], v[68:71], v[40:43], v[156:159]
  v_exp_f32 v137, v137
  s_waitcnt lgkmcnt(6)
  v_mfma_f32_16x16x32_bf16 v[160:163], v[56:59], v[48:51], v[160:163]
  ds_read_b128 v[40:43], v13 offset:4096
  ds_read_b128 v[44:47], v13 offset:5120
  s_waitcnt lgkmcnt(7)
  v_mfma_f32_16x16x32_bf16 v[160:163], v[72:75], v[52:55], v[160:163]
  v_exp_f32 v138, v138
  v_mfma_f32_16x16x32_bf16 v[164:167], v[76:79], v[52:55], v[164:167]
  s_add_u32 m0, s62, 16384
  v_cvt_pk_bf16_f32 v30, v136, v137
  v_mfma_f32_16x16x32_bf16 v[164:167], v[60:63], v[48:51], v[164:167]
  v_exp_f32 v139, v139
  v_mfma_f32_16x16x32_bf16 v[168:171], v[64:67], v[48:51], v[168:171]
  s_add_u32 s61, s61, 32768
  v_add_f32 v38, v38, v136
  v_mfma_f32_16x16x32_bf16 v[168:171], v[80:83], v[52:55], v[168:171]
  v_cvt_pk_bf16_f32 v31, v138, v139
  v_add_f32 v38, v38, v137
  v_mfma_f32_16x16x32_bf16 v[172:175], v[84:87], v[52:55], v[172:175]
  buffer_load_dwordx4 v22, s[44:47], s61 offen offset:0 nt lds
  ds_write_b64 v12, v[30:31] offset:24576
  v_mfma_f32_16x16x32_bf16 v[172:175], v[68:71], v[48:51], v[172:175]
  ds_read_b128 v[48:51], v13 offset:6144
  v_add_f32 v38, v38, v138
  s_waitcnt lgkmcnt(3)
  v_mfma_f32_16x16x32_bf16 v[176:179], v[56:59], v[40:43], v[176:179]
  ds_read_b128 v[52:55], v13 offset:7168
  v_add_f32 v38, v38, v139
  s_waitcnt lgkmcnt(3)
  v_mfma_f32_16x16x32_bf16 v[176:179], v[72:75], v[44:47], v[176:179]
  v_exp_f32 v140, v140
  v_mfma_f32_16x16x32_bf16 v[180:183], v[76:79], v[44:47], v[180:183]
  v_exp_f32 v141, v141
  v_mfma_f32_16x16x32_bf16 v[180:183], v[60:63], v[40:43], v[180:183]
  buffer_load_dwordx4 v23, s[44:47], s61 offen offset:1024 nt lds
  ds_read_b128 a[232:235], v6 offset:0
  v_mfma_f32_16x16x32_bf16 v[184:187], v[64:67], v[40:43], v[184:187]
  v_exp_f32 v142, v142
  v_mfma_f32_16x16x32_bf16 v[184:187], v[80:83], v[44:47], v[184:187]
  buffer_load_dwordx4 v24, s[44:47], s61 offen offset:2048 nt lds
  v_cvt_pk_bf16_f32 v26, v140, v141
  v_mfma_f32_16x16x32_bf16 v[188:191], v[84:87], v[44:47], v[188:191]
  v_exp_f32 v143, v143
  v_mfma_f32_16x16x32_bf16 v[188:191], v[68:71], v[40:43], v[188:191]
  ds_read_b128 v[40:43], v13 offset:8192
  ds_read_b128 v[44:47], v13 offset:9216
  s_waitcnt lgkmcnt(4)
  v_mfma_f32_16x16x32_bf16 v[192:195], v[56:59], v[48:51], v[192:195]
  v_add_f32 v39, v39, v140
  v_cvt_pk_bf16_f32 v27, v142, v143
  s_waitcnt lgkmcnt(3)
  v_mfma_f32_16x16x32_bf16 v[192:195], v[72:75], v[52:55], v[192:195]
  ds_read_b128 a[236:239], v7 offset:0
  v_add_f32 v39, v39, v141
  v_mfma_f32_16x16x32_bf16 v[196:199], v[76:79], v[52:55], v[196:199]
  ds_read_b128 a[240:243], v4 offset:256
  ds_write_b64 v12, v[26:27] offset:26624
  v_mfma_f32_16x16x32_bf16 v[196:199], v[60:63], v[48:51], v[196:199]
  buffer_load_dwordx4 v25, s[44:47], s61 offen offset:3072 nt lds
  ds_read_b128 a[244:247], v5 offset:256
  v_mfma_f32_16x16x32_bf16 v[200:203], v[64:67], v[48:51], v[200:203]
  ds_read_b128 a[248:251], v6 offset:256
  v_add_f32 v39, v39, v142
  v_mfma_f32_16x16x32_bf16 v[200:203], v[80:83], v[52:55], v[200:203]
  ds_read_b128 a[252:255], v7 offset:256
  v_add_f32 v39, v39, v143
  v_mfma_f32_16x16x32_bf16 v[204:207], v[84:87], v[52:55], v[204:207]
  v_mfma_f32_16x16x32_bf16 v[204:207], v[68:71], v[48:51], v[204:207]
  ds_read_b128 v[48:51], v13 offset:10240
  s_add_u32 m0, s62, 20480
  s_waitcnt lgkmcnt(8)
  v_mfma_f32_16x16x32_bf16 v[208:211], v[56:59], v[40:43], v[208:211]
  ds_read_b128 v[52:55], v13 offset:11264
  s_add_u32 s66, s61, 16384
  s_waitcnt lgkmcnt(8)
  v_mfma_f32_16x16x32_bf16 v[208:211], v[72:75], v[44:47], v[208:211]
  buffer_load_dwordx4 v22, s[44:47], s66 offen offset:0 nt lds
  v_mfma_f32_16x16x32_bf16 v[212:215], v[76:79], v[44:47], v[212:215]
  v_mfma_f32_16x16x32_bf16 v[212:215], v[60:63], v[40:43], v[212:215]
  v_mfma_f32_16x16x32_bf16 v[216:219], v[64:67], v[40:43], v[216:219]
  v_mfma_f32_16x16x32_bf16 v[216:219], v[80:83], v[44:47], v[216:219]
  v_mfma_f32_16x16x32_bf16 v[220:223], v[84:87], v[44:47], v[220:223]
  buffer_load_dwordx4 v23, s[44:47], s66 offen offset:1024 nt lds
  v_mfma_f32_16x16x32_bf16 v[220:223], v[68:71], v[40:43], v[220:223]
  ds_read_b128 v[40:43], v13 offset:12288
  ds_read_b128 v[44:47], v13 offset:13312
  s_waitcnt lgkmcnt(3)
  v_mfma_f32_16x16x32_bf16 v[224:227], v[56:59], v[48:51], v[224:227]
  s_waitcnt lgkmcnt(2)
  v_mfma_f32_16x16x32_bf16 v[224:227], v[72:75], v[52:55], v[224:227]
  v_mfma_f32_16x16x32_bf16 v[228:231], v[76:79], v[52:55], v[228:231]
  v_mfma_f32_16x16x32_bf16 v[228:231], v[60:63], v[48:51], v[228:231]
  v_mfma_f32_16x16x32_bf16 v[232:235], v[64:67], v[48:51], v[232:235]
  buffer_load_dwordx4 v24, s[44:47], s66 offen offset:2048 nt lds
  v_mfma_f32_16x16x32_bf16 v[232:235], v[80:83], v[52:55], v[232:235]
  v_mfma_f32_16x16x32_bf16 v[236:239], v[84:87], v[52:55], v[236:239]
  v_mfma_f32_16x16x32_bf16 v[236:239], v[68:71], v[48:51], v[236:239]
  s_waitcnt lgkmcnt(1)
  v_mfma_f32_16x16x32_bf16 v[240:243], v[56:59], v[40:43], v[240:243]
  s_waitcnt lgkmcnt(0)
  v_mfma_f32_16x16x32_bf16 v[240:243], v[72:75], v[44:47], v[240:243]
  v_mfma_f32_16x16x32_bf16 v[244:247], v[76:79], v[44:47], v[244:247]
  buffer_load_dwordx4 v25, s[44:47], s66 offen offset:3072 nt lds
  v_mfma_f32_16x16x32_bf16 v[244:247], v[60:63], v[40:43], v[244:247]
  v_mfma_f32_16x16x32_bf16 v[248:251], v[64:67], v[40:43], v[248:251]
  v_mfma_f32_16x16x32_bf16 v[248:251], v[80:83], v[44:47], v[248:251]
  v_mfma_f32_16x16x32_bf16 v[252:255], v[84:87], v[44:47], v[252:255]
  v_mfma_f32_16x16x32_bf16 v[252:255], v[68:71], v[40:43], v[252:255]
  s_waitcnt vmcnt(16)
  s_barrier
  v_mfma_f32_16x16x32_bf16 v[116:119], a[224:227], a[0:3], v[88:91]
  s_add_u32 m0, s62, 0
  ds_read_b64_tr_b16 v[56:57], v8 offset:8192
  v_mfma_f32_16x16x32_bf16 v[116:119], a[228:231], a[4:7], v[116:119]
  s_add_u32 s66, s93, 0
  ds_read_b64_tr_b16 v[58:59], v8 offset:10240
  v_mfma_f32_16x16x32_bf16 v[116:119], a[232:235], a[8:11], v[116:119]
  buffer_load_dwordx4 v32, s[52:55], s66 offen offset:0 lds
  ds_read_b64_tr_b16 v[72:73], v8 offset:12288
  v_mfma_f32_16x16x32_bf16 v[116:119], a[236:239], a[12:15], v[116:119]
  ds_read_b64_tr_b16 v[74:75], v8 offset:14336
  ds_read_b64_tr_b16 v[60:61], v9 offset:8192
  v_mfma_f32_16x16x32_bf16 v[116:119], a[240:243], a[16:19], v[116:119]
  ds_read_b64_tr_b16 v[62:63], v9 offset:10240
  v_mfma_f32_16x16x32_bf16 v[116:119], a[244:247], a[20:23], v[116:119]
  s_add_u32 s67, s93, 6144
  ds_read_b64_tr_b16 v[76:77], v9 offset:12288
  v_mfma_f32_16x16x32_bf16 v[116:119], a[248:251], a[24:27], v[116:119]
  ds_read_b64_tr_b16 v[78:79], v9 offset:14336
  ds_read_b64_tr_b16 v[64:65], v10 offset:8192
  v_mfma_f32_16x16x32_bf16 v[116:119], a[252:255], a[28:31], v[116:119]
  buffer_load_dwordx4 v32, s[52:55], s67 offen offset:1024 lds
  ds_read_b64_tr_b16 v[66:67], v10 offset:10240
  v_mfma_f32_16x16x32_bf16 v[120:123], a[224:227], a[32:35], v[92:95]
  ds_read_b64_tr_b16 v[80:81], v10 offset:12288
  ds_read_b64_tr_b16 v[82:83], v10 offset:14336
  v_mfma_f32_16x16x32_bf16 v[120:123], a[228:231], a[36:39], v[120:123]
  ds_read_b64_tr_b16 v[68:69], v11 offset:8192
  v_mfma_f32_16x16x32_bf16 v[120:123], a[232:235], a[40:43], v[120:123]
  ds_read_b64_tr_b16 v[70:71], v11 offset:10240
  ds_read_b64_tr_b16 v[84:85], v11 offset:12288
  v_mfma_f32_16x16x32_bf16 v[120:123], a[236:239], a[44:47], v[120:123]
  ds_read_b64_tr_b16 v[86:87], v11 offset:14336
  v_mfma_f32_16x16x32_bf16 v[120:123], a[240:243], a[48:51], v[120:123]
  s_add_u32 s66, s93, 12288
  v_mfma_f32_16x16x32_bf16 v[120:123], a[244:247], a[52:55], v[120:123]
  v_mfma_f32_16x16x32_bf16 v[120:123], a[248:251], a[56:59], v[120:123]
  buffer_load_dwordx4 v32, s[52:55], s66 offen offset:2048 lds
  v_mfma_f32_16x16x32_bf16 v[120:123], a[252:255], a[60:63], v[120:123]
  v_exp_f32 v116, v116
  v_mfma_f32_16x16x32_bf16 v[124:127], a[224:227], a[64:67], v[96:99]
  v_exp_f32 v117, v117
  v_mfma_f32_16x16x32_bf16 v[124:127], a[228:231], a[68:71], v[124:127]
  v_exp_f32 v118, v118
  v_mfma_f32_16x16x32_bf16 v[124:127], a[232:235], a[72:75], v[124:127]
  v_cvt_pk_bf16_f32 v26, v116, v117
  v_mfma_f32_16x16x32_bf16 v[124:127], a[236:239], a[76:79], v[124:127]
  v_exp_f32 v119, v119
  v_mfma_f32_16x16x32_bf16 v[124:127], a[240:243], a[80:83], v[124:127]
  v_add_f32 v33, v33, v116
  v_cvt_pk_bf16_f32 v27, v118, v119
  v_mfma_f32_16x16x32_bf16 v[124:127], a[244:247], a[84:87], v[124:127]
  s_add_u32 s67, s93, 18432
  v_add_f32 v33, v33, v117
  v_mfma_f32_16x16x32_bf16 v[124:127], a[248:251], a[88:91], v[124:127]
  ds_write_b64 v12, v[26:27] offset:0
  v_add_f32 v33, v33, v118
  v_mfma_f32_16x16x32_bf16 v[124:127], a[252:255], a[92:95], v[124:127]
  buffer_load_dwordx4 v32, s[52:55], s67 offen offset:3072 lds
  v_add_f32 v33, v33, v119
  v_mfma_f32_16x16x32_bf16 v[128:131], a[224:227], a[96:99], v[100:103]
  v_exp_f32 v120, v120
  v_mfma_f32_16x16x32_bf16 v[128:131], a[228:231], a[100:103], v[128:131]
  v_exp_f32 v121, v121
  v_mfma_f32_16x16x32_bf16 v[128:131], a[232:235], a[104:107], v[128:131]
  v_exp_f32 v122, v122
  v_mfma_f32_16x16x32_bf16 v[128:131], a[236:239], a[108:111], v[128:131]
  s_add_u32 m0, s62, 4096
  v_cvt_pk_bf16_f32 v28, v120, v121
  v_mfma_f32_16x16x32_bf16 v[128:131], a[240:243], a[112:115], v[128:131]
  v_exp_f32 v123, v123
  v_mfma_f32_16x16x32_bf16 v[128:131], a[244:247], a[116:119], v[128:131]
  v_add_f32 v34, v34, v120
  v_cvt_pk_bf16_f32 v29, v122, v123
  v_mfma_f32_16x16x32_bf16 v[128:131], a[248:251], a[120:123], v[128:131]
  s_add_u32 s66, s93, 114688
  v_add_f32 v34, v34, v121
  v_mfma_f32_16x16x32_bf16 v[128:131], a[252:255], a[124:127], v[128:131]
  ds_write_b64 v12, v[28:29] offset:2048
  v_add_f32 v34, v34, v122
  v_mfma_f32_16x16x32_bf16 v[132:135], a[224:227], a[128:131], v[104:107]
  buffer_load_dwordx4 v32, s[52:55], s66 offen offset:0 lds
  v_add_f32 v34, v34, v123
  v_mfma_f32_16x16x32_bf16 v[132:135], a[228:231], a[132:135], v[132:135]
  v_exp_f32 v124, v124
  v_mfma_f32_16x16x32_bf16 v[132:135], a[232:235], a[136:139], v[132:135]
  v_exp_f32 v125, v125
  v_mfma_f32_16x16x32_bf16 v[132:135], a[236:239], a[140:143], v[132:135]
  v_exp_f32 v126, v126
  v_mfma_f32_16x16x32_bf16 v[132:135], a[240:243], a[144:147], v[132:135]
  s_add_u32 s67, s93, 120832
  v_cvt_pk_bf16_f32 v30, v124, v125
  v_mfma_f32_16x16x32_bf16 v[132:135], a[244:247], a[148:151], v[132:135]
  v_exp_f32 v127, v127
  v_mfma_f32_16x16x32_bf16 v[132:135], a[248:251], a[152:155], v[132:135]
  v_add_f32 v35, v35, v124
  v_cvt_pk_bf16_f32 v31, v126, v127
  v_mfma_f32_16x16x32_bf16 v[132:135], a[252:255], a[156:159], v[132:135]
  buffer_load_dwordx4 v32, s[52:55], s67 offen offset:1024 lds
  v_add_f32 v35, v35, v125
  v_mfma_f32_16x16x32_bf16 v[136:139], a[224:227], a[160:163], v[108:111]
  ds_write_b64 v12, v[30:31] offset:4096
  v_add_f32 v35, v35, v126
  v_mfma_f32_16x16x32_bf16 v[136:139], a[228:231], a[164:167], v[136:139]
  s_add_u32 s66, s93, 126976
  v_add_f32 v35, v35, v127
  v_mfma_f32_16x16x32_bf16 v[136:139], a[232:235], a[168:171], v[136:139]
  v_exp_f32 v128, v128
  v_mfma_f32_16x16x32_bf16 v[136:139], a[236:239], a[172:175], v[136:139]
  v_exp_f32 v129, v129
  v_mfma_f32_16x16x32_bf16 v[136:139], a[240:243], a[176:179], v[136:139]
  v_exp_f32 v130, v130
  v_mfma_f32_16x16x32_bf16 v[136:139], a[244:247], a[180:183], v[136:139]
  ds_read_b128 v[40:43], v13 offset:14336
  v_cvt_pk_bf16_f32 v26, v128, v129
  v_mfma_f32_16x16x32_bf16 v[136:139], a[248:251], a[184:187], v[136:139]
  v_exp_f32 v131, v131
  v_mfma_f32_16x16x32_bf16 v[136:139], a[252:255], a[188:191], v[136:139]
  v_add_f32 v36, v36, v128
  v_cvt_pk_bf16_f32 v27, v130, v131
  v_mfma_f32_16x16x32_bf16 v[140:143], a[224:227], a[192:195], v[112:115]
  buffer_load_dwordx4 v32, s[52:55], s66 offen offset:2048 lds
  v_add_f32 v36, v36, v129
  v_mfma_f32_16x16x32_bf16 v[140:143], a[228:231], a[196:199], v[140:143]
  ds_write_b64 v12, v[26:27] offset:6144
  v_add_f32 v36, v36, v130
  v_mfma_f32_16x16x32_bf16 v[140:143], a[232:235], a[200:203], v[140:143]
  ds_read_b128 v[44:47], v13 offset:15360
  v_add_f32 v36, v36, v131
  v_mfma_f32_16x16x32_bf16 v[140:143], a[236:239], a[204:207], v[140:143]
  v_exp_f32 v132, v132
  v_mfma_f32_16x16x32_bf16 v[140:143], a[240:243], a[208:211], v[140:143]
  v_exp_f32 v133, v133
  v_mfma_f32_16x16x32_bf16 v[140:143], a[244:247], a[212:215], v[140:143]
  v_exp_f32 v134, v134
  v_mfma_f32_16x16x32_bf16 v[140:143], a[248:251], a[216:219], v[140:143]
  s_add_u32 s67, s93, 133120
  v_cvt_pk_bf16_f32 v28, v132, v133
  v_mfma_f32_16x16x32_bf16 v[140:143], a[252:255], a[220:223], v[140:143]
  buffer_load_dwordx4 v32, s[52:55], s67 offen offset:3072 lds
  ds_read_b128 v[48:51], v13 offset:16384
  s_waitcnt lgkmcnt(3)
  v_mfma_f32_16x16x32_bf16 v[144:147], v[56:59], v[40:43], v[144:147]
  v_exp_f32 v135, v135
  s_waitcnt lgkmcnt(1)
  v_mfma_f32_16x16x32_bf16 v[144:147], v[72:75], v[44:47], v[144:147]
  v_add_f32 v37, v37, v132
  v_cvt_pk_bf16_f32 v29, v134, v135
  v_mfma_f32_16x16x32_bf16 v[148:151], v[76:79], v[44:47], v[148:151]
  ds_read_b128 v[52:55], v13 offset:17408
  v_add_f32 v37, v37, v133
  v_mfma_f32_16x16x32_bf16 v[148:151], v[60:63], v[40:43], v[148:151]
  ds_write_b64 v12, v[28:29] offset:8192
  v_add_f32 v37, v37, v134
  v_mfma_f32_16x16x32_bf16 v[152:155], v[64:67], v[40:43], v[152:155]
  v_add_f32 v37, v37, v135
  s_waitcnt vmcnt(16)
  v_mfma_f32_16x16x32_bf16 v[152:155], v[80:83], v[44:47], v[152:155]
  v_exp_f32 v136, v136
  v_mfma_f32_16x16x32_bf16 v[156:159], v[84:87], v[44:47], v[156:159]
  v_exp_f32 v137, v137
  v_mfma_f32_16x16x32_bf16 v[156:159], v[68:71], v[40:43], v[156:159]
  v_exp_f32 v138, v138
  s_waitcnt lgkmcnt(2)
  v_mfma_f32_16x16x32_bf16 v[160:163], v[56:59], v[48:51], v[160:163]
  ds_read_b128 v[40:43], v13 offset:18432
  v_cvt_pk_bf16_f32 v30, v136, v137
  s_waitcnt lgkmcnt(2)
  v_mfma_f32_16x16x32_bf16 v[160:163], v[72:75], v[52:55], v[160:163]
  v_exp_f32 v139, v139
  v_mfma_f32_16x16x32_bf16 v[164:167], v[76:79], v[52:55], v[164:167]
  ds_read_b128 v[44:47], v13 offset:19456
  s_add_u32 m0, s62, 24576
  v_mfma_f32_16x16x32_bf16 v[164:167], v[60:63], v[48:51], v[164:167]
  v_add_f32 v38, v38, v136
  v_cvt_pk_bf16_f32 v31, v138, v139
  v_mfma_f32_16x16x32_bf16 v[168:171], v[64:67], v[48:51], v[168:171]
  s_add_u32 s61, s61, 32768
  v_add_f32 v38, v38, v137
  v_mfma_f32_16x16x32_bf16 v[168:171], v[80:83], v[52:55], v[168:171]
  ds_write_b64 v12, v[30:31] offset:10240
  buffer_load_dwordx4 v22, s[44:47], s61 offen offset:0 nt lds
  v_mfma_f32_16x16x32_bf16 v[172:175], v[84:87], v[52:55], v[172:175]
  v_add_f32 v38, v38, v138
  v_add_f32 v38, v38, v139
  v_mfma_f32_16x16x32_bf16 v[172:175], v[68:71], v[48:51], v[172:175]
  ds_read_b128 v[48:51], v13 offset:20480
  buffer_load_dwordx4 v23, s[44:47], s61 offen offset:1024 nt lds
  s_waitcnt lgkmcnt(3)
  v_mfma_f32_16x16x32_bf16 v[176:179], v[56:59], v[40:43], v[176:179]
  v_exp_f32 v140, v140
  s_waitcnt lgkmcnt(2)
  v_mfma_f32_16x16x32_bf16 v[176:179], v[72:75], v[44:47], v[176:179]
  ds_read_b128 v[52:55], v13 offset:21504
  ds_read_b128 a[224:227], v4 offset:8192
  v_mfma_f32_16x16x32_bf16 v[180:183], v[76:79], v[44:47], v[180:183]
  v_exp_f32 v141, v141
  v_mfma_f32_16x16x32_bf16 v[180:183], v[60:63], v[40:43], v[180:183]
  v_exp_f32 v142, v142
  v_mfma_f32_16x16x32_bf16 v[184:187], v[64:67], v[40:43], v[184:187]
  ds_read_b128 a[228:231], v5 offset:8192
  v_cvt_pk_bf16_f32 v26, v140, v141
  v_mfma_f32_16x16x32_bf16 v[184:187], v[80:83], v[44:47], v[184:187]
  v_exp_f32 v143, v143
  v_mfma_f32_16x16x32_bf16 v[188:191], v[84:87], v[44:47], v[188:191]
  buffer_load_dwordx4 v24, s[44:47], s61 offen offset:2048 nt lds
  v_add_f32 v39, v39, v140
  v_mfma_f32_16x16x32_bf16 v[188:191], v[68:71], v[40:43], v[188:191]
  ds_read_b128 v[40:43], v13 offset:22528
  ds_read_b128 v[44:47], v13 offset:23552
  s_waitcnt lgkmcnt(5)
  v_mfma_f32_16x16x32_bf16 v[192:195], v[56:59], v[48:51], v[192:195]
  ds_read_b128 a[232:235], v6 offset:8192
  v_cvt_pk_bf16_f32 v27, v142, v143
  s_waitcnt lgkmcnt(5)
  v_mfma_f32_16x16x32_bf16 v[192:195], v[72:75], v[52:55], v[192:195]
  ds_read_b128 a[236:239], v7 offset:8192
  v_add_f32 v39, v39, v141
  v_mfma_f32_16x16x32_bf16 v[196:199], v[76:79], v[52:55], v[196:199]
  ds_read_b128 a[240:243], v4 offset:8448
  ds_write_b64 v12, v[26:27] offset:12288
  v_mfma_f32_16x16x32_bf16 v[196:199], v[60:63], v[48:51], v[196:199]
  buffer_load_dwordx4 v25, s[44:47], s61 offen offset:3072 nt lds
  ds_read_b128 a[244:247], v5 offset:8448
  v_mfma_f32_16x16x32_bf16 v[200:203], v[64:67], v[48:51], v[200:203]
  ds_read_b128 a[248:251], v6 offset:8448
  v_add_f32 v39, v39, v142
  v_mfma_f32_16x16x32_bf16 v[200:203], v[80:83], v[52:55], v[200:203]
  ds_read_b128 a[252:255], v7 offset:8448
  v_add_f32 v39, v39, v143
  v_mfma_f32_16x16x32_bf16 v[204:207], v[84:87], v[52:55], v[204:207]
  v_mfma_f32_16x16x32_bf16 v[204:207], v[68:71], v[48:51], v[204:207]
  ds_read_b128 v[48:51], v13 offset:24576
  s_add_u32 m0, s62, 28672
  s_waitcnt lgkmcnt(9)
  v_mfma_f32_16x16x32_bf16 v[208:211], v[56:59], v[40:43], v[208:211]
  ds_read_b128 v[52:55], v13 offset:25600
  s_add_u32 s66, s61, 16384
  s_waitcnt lgkmcnt(9)
  v_mfma_f32_16x16x32_bf16 v[208:211], v[72:75], v[44:47], v[208:211]
  buffer_load_dwordx4 v22, s[44:47], s66 offen offset:0 nt lds
  v_mfma_f32_16x16x32_bf16 v[212:215], v[76:79], v[44:47], v[212:215]
  v_mfma_f32_16x16x32_bf16 v[212:215], v[60:63], v[40:43], v[212:215]
  v_mfma_f32_16x16x32_bf16 v[216:219], v[64:67], v[40:43], v[216:219]
  v_mfma_f32_16x16x32_bf16 v[216:219], v[80:83], v[44:47], v[216:219]
  v_mfma_f32_16x16x32_bf16 v[220:223], v[84:87], v[44:47], v[220:223]
  buffer_load_dwordx4 v23, s[44:47], s66 offen offset:1024 nt lds
  v_mfma_f32_16x16x32_bf16 v[220:223], v[68:71], v[40:43], v[220:223]
  ds_read_b128 v[40:43], v13 offset:26624
  ds_read_b128 v[44:47], v13 offset:27648
  s_waitcnt lgkmcnt(3)
  v_mfma_f32_16x16x32_bf16 v[224:227], v[56:59], v[48:51], v[224:227]
  s_waitcnt lgkmcnt(2)
  v_mfma_f32_16x16x32_bf16 v[224:227], v[72:75], v[52:55], v[224:227]
  v_mfma_f32_16x16x32_bf16 v[228:231], v[76:79], v[52:55], v[228:231]
  v_mfma_f32_16x16x32_bf16 v[228:231], v[60:63], v[48:51], v[228:231]
  v_mfma_f32_16x16x32_bf16 v[232:235], v[64:67], v[48:51], v[232:235]
  buffer_load_dwordx4 v24, s[44:47], s66 offen offset:2048 nt lds
  v_mfma_f32_16x16x32_bf16 v[232:235], v[80:83], v[52:55], v[232:235]
  v_mfma_f32_16x16x32_bf16 v[236:239], v[84:87], v[52:55], v[236:239]
  v_mfma_f32_16x16x32_bf16 v[236:239], v[68:71], v[48:51], v[236:239]
  s_waitcnt lgkmcnt(1)
  v_mfma_f32_16x16x32_bf16 v[240:243], v[56:59], v[40:43], v[240:243]
  s_waitcnt lgkmcnt(0)
  v_mfma_f32_16x16x32_bf16 v[240:243], v[72:75], v[44:47], v[240:243]
  v_mfma_f32_16x16x32_bf16 v[244:247], v[76:79], v[44:47], v[244:247]
  buffer_load_dwordx4 v25, s[44:47], s66 offen offset:3072 nt lds
  v_mfma_f32_16x16x32_bf16 v[244:247], v[60:63], v[40:43], v[244:247]
  v_mfma_f32_16x16x32_bf16 v[248:251], v[64:67], v[40:43], v[248:251]
  v_mfma_f32_16x16x32_bf16 v[248:251], v[80:83], v[44:47], v[248:251]
  v_mfma_f32_16x16x32_bf16 v[252:255], v[84:87], v[44:47], v[252:255]
  v_mfma_f32_16x16x32_bf16 v[252:255], v[68:71], v[40:43], v[252:255]
  s_waitcnt vmcnt(16)
  s_barrier
  v_mfma_f32_16x16x32_bf16 v[116:119], a[224:227], a[0:3], v[88:91]
  s_add_u32 m0, s62, 8192
  s_add_u32 s93, s93, 128
  v_mfma_f32_16x16x32_bf16 v[116:119], a[228:231], a[4:7], v[116:119]
  v_mbcnt_lo_u32_b32 v1, -1, 0
  v_mbcnt_hi_u32_b32 v1, -1, v1
  v_lshlrev_b32 v18, 4, v1
  v_mfma_f32_16x16x32_bf16 v[116:119], a[232:235], a[8:11], v[116:119]
  s_cmp_lg_u32 s93, 896
  s_cselect_b32 s93, s93, 0
  v_mfma_f32_16x16x32_bf16 v[116:119], a[236:239], a[12:15], v[116:119]
  v_add_u32 v19, 0x10000, v18
  v_add_u32 v20, 0x20000, v18
  v_mfma_f32_16x16x32_bf16 v[116:119], a[240:243], a[16:19], v[116:119]
  s_add_u32 s66, s93, 0
  s_mul_i32 s3, s34, 6144
  v_add_u32 v22, s62, v18
  v_mfma_f32_16x16x32_bf16 v[116:119], a[244:247], a[20:23], v[116:119]
  v_add_u32 v23, s3, v20
  v_and_b32 v24, 15, v1
  v_mfma_f32_16x16x32_bf16 v[116:119], a[248:251], a[24:27], v[116:119]
  buffer_load_dwordx4 v32, s[52:55], s66 offen offset:0 lds
  v_lshlrev_b32 v24, 4, v24
  v_add_u32 v24, 159744, v24
  v_mfma_f32_16x16x32_bf16 v[116:119], a[252:255], a[28:31], v[116:119]
  s_lshl_b32 s7, s34, 2
  v_add_u32 v25, s7, v24
  v_mfma_f32_16x16x32_bf16 v[120:123], a[224:227], a[32:35], v[92:95]
  v_lshrrev_b32 v0, 4, v1
  v_bfe_u32 v14, v1, 2, 2
  v_mfma_f32_16x16x32_bf16 v[120:123], a[228:231], a[36:39], v[120:123]
  s_add_u32 s67, s93, 6144
  v_lshl_add_u32 v0, v0, 2, v14
  v_bfe_u32 v14, v0, 1, 2
  v_mfma_f32_16x16x32_bf16 v[120:123], a[232:235], a[40:43], v[120:123]
  ds_read_b64_tr_b16 v[56:57], v8 offset:0
  v_xor_b32 v14, s34, v14
  v_mfma_f32_16x16x32_bf16 v[120:123], a[236:239], a[44:47], v[120:123]
  ds_read_b64_tr_b16 v[58:59], v8 offset:2048
  ds_read_b64_tr_b16 v[72:73], v8 offset:4096
  v_mfma_f32_16x16x32_bf16 v[120:123], a[240:243], a[48:51], v[120:123]
  buffer_load_dwordx4 v32, s[52:55], s67 offen offset:1024 lds
  ds_read_b64_tr_b16 v[74:75], v8 offset:6144
  v_lshlrev_b32 v14, 5, v14
  v_mfma_f32_16x16x32_bf16 v[120:123], a[244:247], a[52:55], v[120:123]
  ds_read_b64_tr_b16 v[60:61], v9 offset:0
  v_lshl_add_u32 v14, v0, 7, v14
  v_mfma_f32_16x16x32_bf16 v[120:123], a[248:251], a[56:59], v[120:123]
  s_add_u32 s66, s93, 12288
  ds_read_b64_tr_b16 v[62:63], v9 offset:2048
  v_and_b32 v0, 3, v1
  v_mfma_f32_16x16x32_bf16 v[120:123], a[252:255], a[60:63], v[120:123]
  v_exp_f32 v116, v116
  v_mfma_f32_16x16x32_bf16 v[124:127], a[224:227], a[64:67], v[96:99]
  v_exp_f32 v117, v117
  v_mfma_f32_16x16x32_bf16 v[124:127], a[228:231], a[68:71], v[124:127]
  v_exp_f32 v118, v118
  v_cvt_pk_bf16_f32 v26, v116, v117
  v_mfma_f32_16x16x32_bf16 v[124:127], a[232:235], a[72:75], v[124:127]
  v_exp_f32 v119, v119
  v_mfma_f32_16x16x32_bf16 v[124:127], a[236:239], a[76:79], v[124:127]
  v_add_f32 v33, v33, v116
  v_cvt_pk_bf16_f32 v27, v118, v119
  v_mfma_f32_16x16x32_bf16 v[124:127], a[240:243], a[80:83], v[124:127]
  buffer_load_dwordx4 v32, s[52:55], s66 offen offset:2048 lds
  v_add_f32 v33, v33, v117
  v_lshl_add_u32 v14, v0, 3, v14
  v_mfma_f32_16x16x32_bf16 v[124:127], a[244:247], a[84:87], v[124:127]
  ds_write_b64 v12, v[26:27] offset:14336
  v_add_f32 v33, v33, v118
  v_mfma_f32_16x16x32_bf16 v[124:127], a[248:251], a[88:91], v[124:127]
  s_add_u32 s67, s93, 18432
  v_add_f32 v33, v33, v119
  v_mfma_f32_16x16x32_bf16 v[124:127], a[252:255], a[92:95], v[124:127]
  v_exp_f32 v120, v120
  v_add_u32 v15, 0x10000, v14
  v_mfma_f32_16x16x32_bf16 v[128:131], a[224:227], a[96:99], v[100:103]
  v_exp_f32 v121, v121
  v_mfma_f32_16x16x32_bf16 v[128:131], a[228:231], a[100:103], v[128:131]
  v_exp_f32 v122, v122
  v_cvt_pk_bf16_f32 v28, v120, v121
  v_mfma_f32_16x16x32_bf16 v[128:131], a[232:235], a[104:107], v[128:131]
  v_exp_f32 v123, v123
  v_mfma_f32_16x16x32_bf16 v[128:131], a[236:239], a[108:111], v[128:131]
  buffer_load_dwordx4 v32, s[52:55], s67 offen offset:3072 lds
  v_add_f32 v34, v34, v120
  v_mfma_f32_16x16x32_bf16 v[128:131], a[240:243], a[112:115], v[128:131]
  ds_read_b64_tr_b16 v[76:77], v9 offset:4096
  v_cvt_pk_bf16_f32 v29, v122, v123
  v_add_f32 v34, v34, v121
  v_mfma_f32_16x16x32_bf16 v[128:131], a[244:247], a[116:119], v[128:131]
  ds_write_b64 v12, v[28:29] offset:16384
  v_add_f32 v34, v34, v122
  v_mfma_f32_16x16x32_bf16 v[128:131], a[248:251], a[120:123], v[128:131]
  s_add_u32 m0, s62, 12288
  v_add_f32 v34, v34, v123
  v_mfma_f32_16x16x32_bf16 v[128:131], a[252:255], a[124:127], v[128:131]
  s_mul_i32 s7, s4, 100352
  v_exp_f32 v124, v124
  v_mfma_f32_16x16x32_bf16 v[132:135], a[224:227], a[128:131], v[104:107]
  v_exp_f32 v125, v125
  v_mfma_f32_16x16x32_bf16 v[132:135], a[228:231], a[132:135], v[132:135]
  v_exp_f32 v126, v126
  v_mfma_f32_16x16x32_bf16 v[132:135], a[232:235], a[136:139], v[132:135]
  s_add_u32 s66, s93, 114688
  buffer_load_dwordx4 v32, s[52:55], s66 offen offset:0 lds
  v_cvt_pk_bf16_f32 v30, v124, v125
  v_mfma_f32_16x16x32_bf16 v[132:135], a[236:239], a[140:143], v[132:135]
  v_exp_f32 v127, v127
  v_mfma_f32_16x16x32_bf16 v[132:135], a[240:243], a[144:147], v[132:135]
  v_add_f32 v35, v35, v124
  v_cvt_pk_bf16_f32 v31, v126, v127
  v_add_f32 v35, v35, v125
  v_mfma_f32_16x16x32_bf16 v[132:135], a[244:247], a[148:151], v[132:135]
  ds_write_b64 v12, v[30:31] offset:18432
  v_add_f32 v35, v35, v126
  v_mfma_f32_16x16x32_bf16 v[132:135], a[248:251], a[152:155], v[132:135]
  v_lshl_add_u32 v16, v1, 4, s7
  v_add_f32 v35, v35, v127
  v_mfma_f32_16x16x32_bf16 v[132:135], a[252:255], a[156:159], v[132:135]
  v_lshl_add_u32 v17, v1, 3, s7
  s_mul_i32 s7, s34, 3584
  v_add_u32 v16, s7, v16
  v_mfma_f32_16x16x32_bf16 v[136:139], a[224:227], a[160:163], v[108:111]
  s_add_u32 s67, s93, 120832
  v_add_u32 v17, s7, v17
  v_mfma_f32_16x16x32_bf16 v[136:139], a[228:231], a[164:167], v[136:139]
  buffer_load_dwordx4 v32, s[52:55], s67 offen offset:1024 lds
  ds_read_b64_tr_b16 v[78:79], v9 offset:6144
  v_mfma_f32_16x16x32_bf16 v[136:139], a[232:235], a[168:171], v[136:139]
  ds_read_b64_tr_b16 v[64:65], v10 offset:0
  v_exp_f32 v128, v128
  v_mfma_f32_16x16x32_bf16 v[136:139], a[236:239], a[172:175], v[136:139]
  v_exp_f32 v129, v129
  v_mfma_f32_16x16x32_bf16 v[136:139], a[240:243], a[176:179], v[136:139]
  v_exp_f32 v130, v130
  v_cvt_pk_bf16_f32 v26, v128, v129
  v_mfma_f32_16x16x32_bf16 v[136:139], a[244:247], a[180:183], v[136:139]
  ds_read_b64_tr_b16 v[66:67], v10 offset:2048
  ds_read_b64_tr_b16 v[80:81], v10 offset:4096
  v_mfma_f32_16x16x32_bf16 v[136:139], a[248:251], a[184:187], v[136:139]
  ds_read_b64_tr_b16 v[82:83], v10 offset:6144
  s_add_u32 s66, s93, 126976
  v_mfma_f32_16x16x32_bf16 v[136:139], a[252:255], a[188:191], v[136:139]
  ds_read_b64_tr_b16 v[68:69], v11 offset:0
  ds_read_b64_tr_b16 v[70:71], v11 offset:2048
  buffer_load_dwordx4 v32, s[52:55], s66 offen offset:2048 lds
  v_mfma_f32_16x16x32_bf16 v[140:143], a[224:227], a[192:195], v[112:115]
  ds_read_b64_tr_b16 v[84:85], v11 offset:4096
  ds_read_b64_tr_b16 v[86:87], v11 offset:6144
  v_mfma_f32_16x16x32_bf16 v[140:143], a[228:231], a[196:199], v[140:143]
  v_exp_f32 v131, v131
  v_mfma_f32_16x16x32_bf16 v[140:143], a[232:235], a[200:203], v[140:143]
  ds_read_b128 v[40:43], v13 offset:0
  ds_read_b128 v[44:47], v13 offset:1024
  v_add_f32 v36, v36, v128
  v_mfma_f32_16x16x32_bf16 v[140:143], a[236:239], a[204:207], v[140:143]
  v_cvt_pk_bf16_f32 v27, v130, v131
  v_add_f32 v36, v36, v129
  v_mfma_f32_16x16x32_bf16 v[140:143], a[240:243], a[208:211], v[140:143]
  ds_write_b64 v12, v[26:27] offset:20480
  v_add_f32 v36, v36, v130
  v_add_f32 v36, v36, v131
  v_mfma_f32_16x16x32_bf16 v[140:143], a[244:247], a[212:215], v[140:143]
  v_exp_f32 v132, v132
  v_mfma_f32_16x16x32_bf16 v[140:143], a[248:251], a[216:219], v[140:143]
  v_exp_f32 v133, v133
  v_mfma_f32_16x16x32_bf16 v[140:143], a[252:255], a[220:223], v[140:143]
  s_add_u32 s67, s93, 133120
  buffer_load_dwordx4 v32, s[52:55], s67 offen offset:3072 lds
  ds_read_b128 v[48:51], v13 offset:2048
  s_waitcnt lgkmcnt(3)
  v_mfma_f32_16x16x32_bf16 v[144:147], v[56:59], v[40:43], v[144:147]
  v_exp_f32 v134, v134
  s_waitcnt lgkmcnt(2)
  v_mfma_f32_16x16x32_bf16 v[144:147], v[72:75], v[44:47], v[144:147]
  ds_read_b128 v[52:55], v13 offset:3072
  v_cvt_pk_bf16_f32 v28, v132, v133
  v_mfma_f32_16x16x32_bf16 v[148:151], v[76:79], v[44:47], v[148:151]
  v_exp_f32 v135, v135
  v_add_f32 v37, v37, v132
  v_mfma_f32_16x16x32_bf16 v[148:151], v[60:63], v[40:43], v[148:151]
  v_cvt_pk_bf16_f32 v29, v134, v135
  v_add_f32 v37, v37, v133
  v_mfma_f32_16x16x32_bf16 v[152:155], v[64:67], v[40:43], v[152:155]
  ds_write_b64 v12, v[28:29] offset:22528
  v_add_f32 v37, v37, v134
  v_mfma_f32_16x16x32_bf16 v[152:155], v[80:83], v[44:47], v[152:155]
  v_add_f32 v37, v37, v135
  v_exp_f32 v136, v136
  v_mfma_f32_16x16x32_bf16 v[156:159], v[84:87], v[44:47], v[156:159]
  v_exp_f32 v137, v137
  v_mfma_f32_16x16x32_bf16 v[156:159], v[68:71], v[40:43], v[156:159]
  v_exp_f32 v138, v138
  v_cvt_pk_bf16_f32 v30, v136, v137
  s_waitcnt lgkmcnt(2)
  v_mfma_f32_16x16x32_bf16 v[160:163], v[56:59], v[48:51], v[160:163]
  v_exp_f32 v139, v139
  s_waitcnt lgkmcnt(1)
  v_mfma_f32_16x16x32_bf16 v[160:163], v[72:75], v[52:55], v[160:163]
  v_add_f32 v38, v38, v136
  v_cvt_pk_bf16_f32 v31, v138, v139
  v_mfma_f32_16x16x32_bf16 v[164:167], v[76:79], v[52:55], v[164:167]
  ds_read_b128 v[40:43], v13 offset:4096
  ds_read_b128 v[44:47], v13 offset:5120
  v_add_f32 v38, v38, v137
  v_mfma_f32_16x16x32_bf16 v[164:167], v[60:63], v[48:51], v[164:167]
  s_add_u32 m0, s62, 16384
  ds_write_b64 v12, v[30:31] offset:24576
  v_mfma_f32_16x16x32_bf16 v[168:171], v[64:67], v[48:51], v[168:171]
  s_add_u32 s93, s93, 128
  v_add_f32 v38, v38, v138
  v_mfma_f32_16x16x32_bf16 v[168:171], v[80:83], v[52:55], v[168:171]
  s_cmp_lg_u32 s93, 896
  s_cselect_b32 s93, s93, 0
  v_add_f32 v38, v38, v139
  v_mfma_f32_16x16x32_bf16 v[172:175], v[84:87], v[52:55], v[172:175]
  s_add_u32 s66, s93, 0
  buffer_load_dwordx4 v32, s[52:55], s66 offen offset:0 lds
  v_mfma_f32_16x16x32_bf16 v[172:175], v[68:71], v[48:51], v[172:175]
  v_exp_f32 v140, v140
  s_waitcnt lgkmcnt(2)
  v_mfma_f32_16x16x32_bf16 v[176:179], v[56:59], v[40:43], v[176:179]
  ds_read_b128 v[48:51], v13 offset:6144
  v_exp_f32 v141, v141
  s_waitcnt lgkmcnt(2)
  v_mfma_f32_16x16x32_bf16 v[176:179], v[72:75], v[44:47], v[176:179]
  v_exp_f32 v142, v142
  v_mfma_f32_16x16x32_bf16 v[180:183], v[76:79], v[44:47], v[180:183]
  ds_read_b128 v[52:55], v13 offset:7168
  s_add_u32 s67, s93, 6144
  v_cvt_pk_bf16_f32 v26, v140, v141
  v_mfma_f32_16x16x32_bf16 v[180:183], v[60:63], v[40:43], v[180:183]
  v_exp_f32 v143, v143
  v_mfma_f32_16x16x32_bf16 v[184:187], v[64:67], v[40:43], v[184:187]
  buffer_load_dwordx4 v32, s[52:55], s67 offen offset:1024 lds
  v_add_f32 v39, v39, v140
  v_mfma_f32_16x16x32_bf16 v[184:187], v[80:83], v[44:47], v[184:187]
  s_add_u32 s66, s93, 12288
  v_cvt_pk_bf16_f32 v27, v142, v143
  v_add_f32 v39, v39, v141
  v_mfma_f32_16x16x32_bf16 v[188:191], v[84:87], v[44:47], v[188:191]
  ds_write_b64 v12, v[26:27] offset:26624
  v_add_f32 v39, v39, v142
  v_add_f32 v39, v39, v143
  v_mfma_f32_16x16x32_bf16 v[188:191], v[68:71], v[40:43], v[188:191]
  v_mov_b32 v132, v33
  v_mov_b32 v133, v34
  s_waitcnt lgkmcnt(2)
  v_mfma_f32_16x16x32_bf16 v[192:195], v[56:59], v[48:51], v[192:195]
  v_mov_b32 v134, v35
  v_mov_b32 v135, v36
  s_waitcnt lgkmcnt(1)
  v_mfma_f32_16x16x32_bf16 v[192:195], v[72:75], v[52:55], v[192:195]
  v_mov_b32 v136, v37
  v_mov_b32 v137, v38
  v_mfma_f32_16x16x32_bf16 v[196:199], v[76:79], v[52:55], v[196:199]
  ds_read_b128 v[40:43], v13 offset:8192
  buffer_load_dwordx4 v32, s[52:55], s66 offen offset:2048 lds
  ds_read_b128 v[44:47], v13 offset:9216
  v_mfma_f32_16x16x32_bf16 v[196:199], v[60:63], v[48:51], v[196:199]
  v_mov_b32 v138, v39
  v_permlane32_swap_b32 v33, v132
  v_mfma_f32_16x16x32_bf16 v[200:203], v[64:67], v[48:51], v[200:203]
  v_permlane32_swap_b32 v34, v133
  v_permlane32_swap_b32 v35, v134
  v_mfma_f32_16x16x32_bf16 v[200:203], v[80:83], v[52:55], v[200:203]
  v_permlane32_swap_b32 v36, v135
  v_permlane32_swap_b32 v37, v136
  v_mfma_f32_16x16x32_bf16 v[204:207], v[84:87], v[52:55], v[204:207]
  v_permlane32_swap_b32 v38, v137
  v_permlane32_swap_b32 v39, v138
  v_mfma_f32_16x16x32_bf16 v[204:207], v[68:71], v[48:51], v[204:207]
  v_add_f32 v33, v33, v132
  v_add_f32 v34, v34, v133
  s_waitcnt lgkmcnt(1)
  v_mfma_f32_16x16x32_bf16 v[208:211], v[56:59], v[40:43], v[208:211]
  s_add_u32 s67, s93, 18432
  buffer_load_dwordx4 v32, s[52:55], s67 offen offset:3072 lds
  v_add_f32 v35, v35, v134
  s_waitcnt lgkmcnt(0)
  v_mfma_f32_16x16x32_bf16 v[208:211], v[72:75], v[44:47], v[208:211]
  v_add_f32 v36, v36, v135
  v_add_f32 v37, v37, v136
  v_mfma_f32_16x16x32_bf16 v[212:215], v[76:79], v[44:47], v[212:215]
  ds_read_b128 v[48:51], v13 offset:10240
  ds_read_b128 v[52:55], v13 offset:11264
  v_mfma_f32_16x16x32_bf16 v[212:215], v[60:63], v[40:43], v[212:215]
  v_add_f32 v38, v38, v137
  v_add_f32 v39, v39, v138
  v_mfma_f32_16x16x32_bf16 v[216:219], v[64:67], v[40:43], v[216:219]
  s_add_u32 m0, s62, 20480
  v_mov_b32 v132, v33
  v_mfma_f32_16x16x32_bf16 v[216:219], v[80:83], v[44:47], v[216:219]
  s_add_u32 s66, s93, 114688
  buffer_load_dwordx4 v32, s[52:55], s66 offen offset:0 lds
  v_mfma_f32_16x16x32_bf16 v[220:223], v[84:87], v[44:47], v[220:223]
  v_mov_b32 v133, v34
  v_mov_b32 v134, v35
  v_mfma_f32_16x16x32_bf16 v[220:223], v[68:71], v[40:43], v[220:223]
  v_mov_b32 v135, v36
  v_mov_b32 v136, v37
  s_waitcnt lgkmcnt(1)
  v_mfma_f32_16x16x32_bf16 v[224:227], v[56:59], v[48:51], v[224:227]
  v_mov_b32 v137, v38
  v_mov_b32 v138, v39
  s_waitcnt lgkmcnt(0)
  v_mfma_f32_16x16x32_bf16 v[224:227], v[72:75], v[52:55], v[224:227]
  v_permlane16_swap_b32 v33, v132
  v_permlane16_swap_b32 v34, v133
  v_mfma_f32_16x16x32_bf16 v[228:231], v[76:79], v[52:55], v[228:231]
  ds_read_b128 v[40:43], v13 offset:12288
  ds_read_b128 v[44:47], v13 offset:13312
  v_mfma_f32_16x16x32_bf16 v[228:231], v[60:63], v[48:51], v[228:231]
  s_add_u32 s67, s93, 120832
  buffer_load_dwordx4 v32, s[52:55], s67 offen offset:1024 lds
  v_mfma_f32_16x16x32_bf16 v[232:235], v[64:67], v[48:51], v[232:235]
  v_permlane16_swap_b32 v35, v134
  v_permlane16_swap_b32 v36, v135
  v_mfma_f32_16x16x32_bf16 v[232:235], v[80:83], v[52:55], v[232:235]
  v_permlane16_swap_b32 v37, v136
  v_permlane16_swap_b32 v38, v137
  v_mfma_f32_16x16x32_bf16 v[236:239], v[84:87], v[52:55], v[236:239]
  v_permlane16_swap_b32 v39, v138
  v_add_f32 v33, v33, v132
  v_add_f32 v34, v34, v133
  v_mfma_f32_16x16x32_bf16 v[236:239], v[68:71], v[48:51], v[236:239]
  v_add_f32 v35, v35, v134
  v_add_f32 v36, v36, v135
  s_waitcnt lgkmcnt(1)
  v_mfma_f32_16x16x32_bf16 v[240:243], v[56:59], v[40:43], v[240:243]
  v_add_f32 v37, v37, v136
  v_add_f32 v38, v38, v137
  s_waitcnt lgkmcnt(0)
  v_mfma_f32_16x16x32_bf16 v[240:243], v[72:75], v[44:47], v[240:243]
  s_add_u32 s66, s93, 126976
  buffer_load_dwordx4 v32, s[52:55], s66 offen offset:2048 lds
  v_mfma_f32_16x16x32_bf16 v[244:247], v[76:79], v[44:47], v[244:247]
  s_add_u32 s67, s93, 133120
  v_add_f32 v39, v39, v138
  v_mfma_f32_16x16x32_bf16 v[244:247], v[60:63], v[40:43], v[244:247]
  ds_write_b32 v25, v33 offset:0
  ds_write_b32 v25, v34 offset:256
  v_mfma_f32_16x16x32_bf16 v[248:251], v[64:67], v[40:43], v[248:251]
  ds_write_b32 v25, v35 offset:512
  buffer_load_dwordx4 v32, s[52:55], s67 offen offset:3072 lds
  v_mfma_f32_16x16x32_bf16 v[248:251], v[80:83], v[44:47], v[248:251]
  ds_write_b32 v25, v36 offset:768
  ds_write_b32 v25, v37 offset:1024
  ds_write_b32 v25, v38 offset:1280
  ds_write_b32 v25, v39 offset:1536
  v_mfma_f32_16x16x32_bf16 v[252:255], v[84:87], v[44:47], v[252:255]
  v_mfma_f32_16x16x32_bf16 v[252:255], v[68:71], v[40:43], v[252:255]
  s_waitcnt vmcnt(16) lgkmcnt(0)
  s_barrier
  ds_read_b128 v[40:43], v13 offset:14336
  ds_read_b64_tr_b16 v[56:57], v8 offset:8192
  ds_read_b64_tr_b16 v[58:59], v8 offset:10240
  ds_read_b128 v[44:47], v13 offset:15360
  ds_read_b64_tr_b16 v[72:73], v8 offset:12288
  ds_read_b64_tr_b16 v[74:75], v8 offset:14336
  ds_read_b64_tr_b16 v[76:77], v9 offset:12288
  ds_read_b64_tr_b16 v[78:79], v9 offset:14336
  ds_read_b64_tr_b16 v[60:61], v9 offset:8192
  ds_read_b64_tr_b16 v[62:63], v9 offset:10240
  ds_read_b64_tr_b16 v[64:65], v10 offset:8192
  ds_read_b64_tr_b16 v[66:67], v10 offset:10240
  ds_read_b64_tr_b16 v[80:81], v10 offset:12288
  ds_read_b64_tr_b16 v[82:83], v10 offset:14336
  ds_read_b64_tr_b16 v[84:85], v11 offset:12288
  ds_read_b64_tr_b16 v[86:87], v11 offset:14336
  ds_read_b64_tr_b16 v[68:69], v11 offset:8192
  ds_read_b64_tr_b16 v[70:71], v11 offset:10240
  s_waitcnt lgkmcnt(15)
  v_mfma_f32_16x16x32_bf16 v[144:147], v[56:59], v[40:43], v[144:147]
  ds_read_b128 v[48:51], v13 offset:16384
  ds_read_b128 v[52:55], v13 offset:17408
  s_waitcnt lgkmcnt(14)
  v_mfma_f32_16x16x32_bf16 v[144:147], v[72:75], v[44:47], v[144:147]
  ds_read_b128 v[116:119], v13 offset:18432
  s_waitcnt lgkmcnt(13)
  v_mfma_f32_16x16x32_bf16 v[148:151], v[76:79], v[44:47], v[148:151]
  ds_read_b128 v[120:123], v13 offset:19456
  ds_read_b128 v[124:127], v13 offset:20480
  s_waitcnt lgkmcnt(13)
  v_mfma_f32_16x16x32_bf16 v[148:151], v[60:63], v[40:43], v[148:151]
  ds_read_b128 v[128:131], v13 offset:21504
  s_waitcnt lgkmcnt(12)
  v_mfma_f32_16x16x32_bf16 v[152:155], v[64:67], v[40:43], v[152:155]
  ds_read_b128 v[132:135], v13 offset:22528
  ds_read_b128 v[136:139], v13 offset:23552
  s_waitcnt lgkmcnt(12)
  v_mfma_f32_16x16x32_bf16 v[152:155], v[80:83], v[44:47], v[152:155]
  ds_read_b128 v[140:143], v13 offset:24576
  s_waitcnt lgkmcnt(11)
  v_mfma_f32_16x16x32_bf16 v[156:159], v[84:87], v[44:47], v[156:159]
  ds_read_b128 v[104:107], v13 offset:25600
  ds_read_b128 v[108:111], v13 offset:26624
  s_waitcnt lgkmcnt(11)
  v_mfma_f32_16x16x32_bf16 v[156:159], v[68:71], v[40:43], v[156:159]
  ds_read_b128 v[112:115], v13 offset:27648
  s_waitcnt lgkmcnt(11)
  v_mfma_f32_16x16x32_bf16 v[160:163], v[56:59], v[48:51], v[160:163]
  s_waitcnt lgkmcnt(10)
  v_mfma_f32_16x16x32_bf16 v[160:163], v[72:75], v[52:55], v[160:163]
  v_mfma_f32_16x16x32_bf16 v[164:167], v[76:79], v[52:55], v[164:167]
  v_mfma_f32_16x16x32_bf16 v[164:167], v[60:63], v[48:51], v[164:167]
  v_mfma_f32_16x16x32_bf16 v[168:171], v[64:67], v[48:51], v[168:171]
  v_mfma_f32_16x16x32_bf16 v[168:171], v[80:83], v[52:55], v[168:171]
  v_mfma_f32_16x16x32_bf16 v[172:175], v[84:87], v[52:55], v[172:175]
  v_cvt_pk_bf16_f32 v88, v144, v145
  v_cvt_pk_bf16_f32 v89, v146, v147
  v_mfma_f32_16x16x32_bf16 v[172:175], v[68:71], v[48:51], v[172:175]
  s_waitcnt lgkmcnt(0)
  v_cvt_pk_bf16_f32 v90, v148, v149
  v_mfma_f32_16x16x32_bf16 v[176:179], v[56:59], v[116:119], v[176:179]
  v_cvt_pk_bf16_f32 v91, v150, v151
  v_mfma_f32_16x16x32_bf16 v[176:179], v[72:75], v[120:123], v[176:179]
  ds_write_b128 v22, v[88:91] offset:24576
  v_cvt_pk_bf16_f32 v92, v152, v153
  v_mfma_f32_16x16x32_bf16 v[180:183], v[76:79], v[120:123], v[180:183]
  v_cvt_pk_bf16_f32 v93, v154, v155
  v_cvt_pk_bf16_f32 v94, v156, v157
  v_mfma_f32_16x16x32_bf16 v[180:183], v[60:63], v[116:119], v[180:183]
  v_cvt_pk_bf16_f32 v95, v158, v159
  v_mfma_f32_16x16x32_bf16 v[184:187], v[64:67], v[116:119], v[184:187]
  ds_write_b128 v22, v[92:95] offset:25600
  v_mfma_f32_16x16x32_bf16 v[184:187], v[80:83], v[120:123], v[184:187]
  v_mfma_f32_16x16x32_bf16 v[188:191], v[84:87], v[120:123], v[188:191]
  v_cvt_pk_bf16_f32 v96, v160, v161
  v_cvt_pk_bf16_f32 v97, v162, v163
  v_mfma_f32_16x16x32_bf16 v[188:191], v[68:71], v[116:119], v[188:191]
  v_cvt_pk_bf16_f32 v98, v164, v165
  v_cvt_pk_bf16_f32 v99, v166, v167
  v_mfma_f32_16x16x32_bf16 v[192:195], v[56:59], v[124:127], v[192:195]
  ds_write_b128 v22, v[96:99] offset:26624
  v_cvt_pk_bf16_f32 v100, v168, v169
  v_mfma_f32_16x16x32_bf16 v[192:195], v[72:75], v[128:131], v[192:195]
  v_cvt_pk_bf16_f32 v101, v170, v171
  v_cvt_pk_bf16_f32 v102, v172, v173
  v_mfma_f32_16x16x32_bf16 v[196:199], v[76:79], v[128:131], v[196:199]
  v_cvt_pk_bf16_f32 v103, v174, v175
  v_mfma_f32_16x16x32_bf16 v[196:199], v[60:63], v[124:127], v[196:199]
  ds_write_b128 v22, v[100:103] offset:27648
  v_mfma_f32_16x16x32_bf16 v[200:203], v[64:67], v[124:127], v[200:203]
  v_mfma_f32_16x16x32_bf16 v[200:203], v[80:83], v[128:131], v[200:203]
  v_mfma_f32_16x16x32_bf16 v[204:207], v[84:87], v[128:131], v[204:207]
  v_cvt_pk_bf16_f32 v88, v176, v177
  v_cvt_pk_bf16_f32 v89, v178, v179
  v_mfma_f32_16x16x32_bf16 v[204:207], v[68:71], v[124:127], v[204:207]
  v_cvt_pk_bf16_f32 v90, v180, v181
  v_cvt_pk_bf16_f32 v91, v182, v183
  v_mfma_f32_16x16x32_bf16 v[208:211], v[56:59], v[132:135], v[208:211]
  ds_write_b128 v22, v[88:91] offset:28672
  v_cvt_pk_bf16_f32 v92, v184, v185
  v_mfma_f32_16x16x32_bf16 v[208:211], v[72:75], v[136:139], v[208:211]
  v_cvt_pk_bf16_f32 v93, v186, v187
  v_cvt_pk_bf16_f32 v94, v188, v189
  v_mfma_f32_16x16x32_bf16 v[212:215], v[76:79], v[136:139], v[212:215]
  v_cvt_pk_bf16_f32 v95, v190, v191
  v_mfma_f32_16x16x32_bf16 v[212:215], v[60:63], v[132:135], v[212:215]
  ds_write_b128 v22, v[92:95] offset:29696
  v_mfma_f32_16x16x32_bf16 v[216:219], v[64:67], v[132:135], v[216:219]
  v_mfma_f32_16x16x32_bf16 v[216:219], v[80:83], v[136:139], v[216:219]
  v_mfma_f32_16x16x32_bf16 v[220:223], v[84:87], v[136:139], v[220:223]
  v_cvt_pk_bf16_f32 v96, v192, v193
  v_cvt_pk_bf16_f32 v97, v194, v195
  v_mfma_f32_16x16x32_bf16 v[220:223], v[68:71], v[132:135], v[220:223]
  v_cvt_pk_bf16_f32 v98, v196, v197
  v_cvt_pk_bf16_f32 v99, v198, v199
  v_mfma_f32_16x16x32_bf16 v[224:227], v[56:59], v[140:143], v[224:227]
  ds_write_b128 v22, v[96:99] offset:30720
  v_cvt_pk_bf16_f32 v100, v200, v201
  v_mfma_f32_16x16x32_bf16 v[224:227], v[72:75], v[104:107], v[224:227]
  v_cvt_pk_bf16_f32 v101, v202, v203
  v_cvt_pk_bf16_f32 v102, v204, v205
  v_mfma_f32_16x16x32_bf16 v[228:231], v[76:79], v[104:107], v[228:231]
  v_cvt_pk_bf16_f32 v103, v206, v207
  v_mfma_f32_16x16x32_bf16 v[228:231], v[60:63], v[140:143], v[228:231]
  ds_write_b128 v22, v[100:103] offset:31744
  s_barrier
  v_mfma_f32_16x16x32_bf16 v[232:235], v[64:67], v[140:143], v[232:235]
  v_mfma_f32_16x16x32_bf16 v[232:235], v[80:83], v[104:107], v[232:235]
  v_mfma_f32_16x16x32_bf16 v[236:239], v[84:87], v[104:107], v[236:239]
  v_cvt_pk_bf16_f32 v88, v208, v209
  v_cvt_pk_bf16_f32 v89, v210, v211
  v_mfma_f32_16x16x32_bf16 v[236:239], v[68:71], v[140:143], v[236:239]
  v_cvt_pk_bf16_f32 v90, v212, v213
  v_cvt_pk_bf16_f32 v91, v214, v215
  v_mfma_f32_16x16x32_bf16 v[240:243], v[56:59], v[108:111], v[240:243]
  ds_write_b128 v23, v[88:91] offset:0
  v_cvt_pk_bf16_f32 v92, v216, v217
  v_mfma_f32_16x16x32_bf16 v[240:243], v[72:75], v[112:115], v[240:243]
  v_cvt_pk_bf16_f32 v93, v218, v219
  v_cvt_pk_bf16_f32 v94, v220, v221
  v_mfma_f32_16x16x32_bf16 v[244:247], v[76:79], v[112:115], v[244:247]
  v_cvt_pk_bf16_f32 v95, v222, v223
  v_mfma_f32_16x16x32_bf16 v[244:247], v[60:63], v[108:111], v[244:247]
  ds_write_b128 v23, v[92:95] offset:1024
  v_mfma_f32_16x16x32_bf16 v[248:251], v[64:67], v[108:111], v[248:251]
  v_mfma_f32_16x16x32_bf16 v[248:251], v[80:83], v[112:115], v[248:251]
  v_mfma_f32_16x16x32_bf16 v[252:255], v[84:87], v[112:115], v[252:255]
  v_cvt_pk_bf16_f32 v96, v224, v225
  v_cvt_pk_bf16_f32 v97, v226, v227
  v_cvt_pk_bf16_f32 v98, v228, v229
  v_cvt_pk_bf16_f32 v99, v230, v231
  v_mfma_f32_16x16x32_bf16 v[252:255], v[68:71], v[108:111], v[252:255]
  ds_write_b128 v23, v[96:99] offset:2048
  v_cvt_pk_bf16_f32 v100, v232, v233
  v_cvt_pk_bf16_f32 v101, v234, v235
  v_cvt_pk_bf16_f32 v102, v236, v237
  v_cvt_pk_bf16_f32 v103, v238, v239
  ds_write_b128 v23, v[100:103] offset:3072
  s_nop 3
  v_cvt_pk_bf16_f32 v88, v240, v241
  v_cvt_pk_bf16_f32 v89, v242, v243
  v_cvt_pk_bf16_f32 v90, v244, v245
  v_cvt_pk_bf16_f32 v91, v246, v247
  ds_write_b128 v23, v[88:91] offset:4096
  v_cvt_pk_bf16_f32 v92, v248, v249
  v_cvt_pk_bf16_f32 v93, v250, v251
  v_cvt_pk_bf16_f32 v94, v252, v253
  v_cvt_pk_bf16_f32 v95, v254, v255
  ds_write_b128 v23, v[92:95] offset:5120
  s_waitcnt lgkmcnt(0)
  s_barrier
  ds_read_b64_tr_b16 v[56:57], v14 offset:0
  ds_read_b64_tr_b16 v[58:59], v14 offset:2048
  ds_read_b128 a[0:3], v18 offset:24576
  ds_read_b64_tr_b16 v[60:61], v14 offset:32768
  ds_read_b64_tr_b16 v[62:63], v14 offset:34816
  ds_read_b128 a[4:7], v18 offset:25600
  ds_read_b64_tr_b16 v[64:65], v15 offset:0
  ds_read_b64_tr_b16 v[66:67], v15 offset:2048
  ds_read_b128 a[8:11], v18 offset:57344
  ds_read_b64_tr_b16 v[68:69], v15 offset:32768
  ds_read_b64_tr_b16 v[70:71], v15 offset:34816
  ds_read_b128 a[12:15], v18 offset:58368
  ds_read_b128 a[32:35], v18 offset:26624
  ds_read_b128 a[36:39], v18 offset:27648
  ds_read_b128 a[40:43], v18 offset:59392
  ds_read_b128 a[44:47], v18 offset:60416
  ds_read_b128 a[64:67], v18 offset:28672
  ds_read_b128 a[68:71], v18 offset:29696
  ds_read_b128 a[72:75], v18 offset:61440
  ds_read_b128 a[76:79], v18 offset:62464
  s_waitcnt lgkmcnt(8)
  v_mfma_f32_16x16x32_bf16 v[144:147], v[56:59], a[0:3], 0
  ds_read_b128 a[96:99], v18 offset:30720
  ds_read_b128 a[100:103], v18 offset:31744
  v_mfma_f32_16x16x32_bf16 v[144:147], v[60:63], a[4:7], v[144:147]
  ds_read_b128 a[104:107], v18 offset:63488
  v_mfma_f32_16x16x32_bf16 v[144:147], v[64:67], a[8:11], v[144:147]
  ds_read_b128 a[108:111], v18 offset:64512
  v_mfma_f32_16x16x32_bf16 v[144:147], v[68:71], a[12:15], v[144:147]
  s_waitcnt lgkmcnt(7)
  ds_read_b128 a[128:131], v20 offset:0
  v_mfma_f32_16x16x32_bf16 v[148:151], v[56:59], a[32:35], 0
  ds_read_b128 a[132:135], v20 offset:1024
  ds_read_b128 a[136:139], v20 offset:6144
  v_mfma_f32_16x16x32_bf16 v[148:151], v[60:63], a[36:39], v[148:151]
  ds_read_b128 a[140:143], v20 offset:7168
  v_mfma_f32_16x16x32_bf16 v[148:151], v[64:67], a[40:43], v[148:151]
  v_mfma_f32_16x16x32_bf16 v[148:151], v[68:71], a[44:47], v[148:151]
  s_waitcnt lgkmcnt(7)
  ds_read_b128 a[160:163], v20 offset:2048
  v_mfma_f32_16x16x32_bf16 v[152:155], v[56:59], a[64:67], 0
  ds_read_b128 a[164:167], v20 offset:3072
  ds_read_b128 a[168:171], v20 offset:8192
  v_mfma_f32_16x16x32_bf16 v[152:155], v[60:63], a[68:71], v[152:155]
  ds_read_b128 a[172:175], v20 offset:9216
  v_mfma_f32_16x16x32_bf16 v[152:155], v[64:67], a[72:75], v[152:155]
  v_mfma_f32_16x16x32_bf16 v[152:155], v[68:71], a[76:79], v[152:155]
  s_waitcnt lgkmcnt(7)
  ds_read_b128 a[192:195], v20 offset:4096
  v_mfma_f32_16x16x32_bf16 v[156:159], v[56:59], a[96:99], 0
  ds_read_b128 a[196:199], v20 offset:5120
  ds_read_b128 a[200:203], v20 offset:10240
  v_mfma_f32_16x16x32_bf16 v[156:159], v[60:63], a[100:103], v[156:159]
  ds_read_b128 a[204:207], v20 offset:11264
  v_mfma_f32_16x16x32_bf16 v[156:159], v[64:67], a[104:107], v[156:159]
  ds_read_b64_tr_b16 v[72:73], v14 offset:4096
  ds_read_b64_tr_b16 v[74:75], v14 offset:6144
  v_mfma_f32_16x16x32_bf16 v[156:159], v[68:71], a[108:111], v[156:159]
  s_waitcnt lgkmcnt(7)
  ds_read_b128 a[16:19], v19 offset:24576
  v_mfma_f32_16x16x32_bf16 v[160:163], v[56:59], a[128:131], 0
  ds_read_b128 a[20:23], v19 offset:25600
  ds_read_b128 a[24:27], v19 offset:57344
  v_mfma_f32_16x16x32_bf16 v[160:163], v[60:63], a[132:135], v[160:163]
  ds_read_b128 a[28:31], v19 offset:58368
  v_mfma_f32_16x16x32_bf16 v[160:163], v[64:67], a[136:139], v[160:163]
  ds_read_b64_tr_b16 v[76:77], v14 offset:36864
  ds_read_b64_tr_b16 v[78:79], v14 offset:38912
  v_mfma_f32_16x16x32_bf16 v[160:163], v[68:71], a[140:143], v[160:163]
  s_waitcnt lgkmcnt(7)
  ds_read_b128 a[48:51], v19 offset:26624
  v_mfma_f32_16x16x32_bf16 v[164:167], v[56:59], a[160:163], 0
  ds_read_b128 a[52:55], v19 offset:27648
  ds_read_b128 a[56:59], v19 offset:59392
  v_mfma_f32_16x16x32_bf16 v[164:167], v[60:63], a[164:167], v[164:167]
  ds_read_b64_tr_b16 v[80:81], v15 offset:4096
  v_mfma_f32_16x16x32_bf16 v[164:167], v[64:67], a[168:171], v[164:167]
  ds_read_b128 a[60:63], v19 offset:60416
  ds_read_b64_tr_b16 v[82:83], v15 offset:6144
  v_mfma_f32_16x16x32_bf16 v[164:167], v[68:71], a[172:175], v[164:167]
  s_waitcnt lgkmcnt(7)
  ds_read_b64_tr_b16 v[84:85], v15 offset:36864
  v_mfma_f32_16x16x32_bf16 v[168:171], v[56:59], a[192:195], 0
  ds_read_b64_tr_b16 v[86:87], v15 offset:38912
  v_mfma_f32_16x16x32_bf16 v[168:171], v[60:63], a[196:199], v[168:171]
  v_mfma_f32_16x16x32_bf16 v[168:171], v[64:67], a[200:203], v[168:171]
  v_mfma_f32_16x16x32_bf16 v[168:171], v[68:71], a[204:207], v[168:171]
  s_waitcnt vmcnt(8) lgkmcnt(0)
  s_barrier
  v_mfma_f32_16x16x32_bf16 v[144:147], v[72:75], a[16:19], v[144:147]
  ds_read_b128 a[80:83], v19 offset:28672
  ds_read_b128 a[84:87], v19 offset:29696
  ds_read_b128 a[88:91], v19 offset:61440
  v_mfma_f32_16x16x32_bf16 v[144:147], v[76:79], a[20:23], v[144:147]
  s_add_u32 m0, s62, 0
  s_add_u32 s93, s93, 128
  v_mfma_f32_16x16x32_bf16 v[144:147], v[80:83], a[24:27], v[144:147]
  ds_read_b128 a[92:95], v19 offset:62464
  ds_read_b128 a[112:115], v19 offset:30720
  ds_read_b128 a[116:119], v19 offset:31744
  v_mfma_f32_16x16x32_bf16 v[144:147], v[84:87], a[28:31], v[144:147]
  s_cmp_lg_u32 s93, 896
  s_cselect_b32 s93, s93, 0
  v_mfma_f32_16x16x32_bf16 v[148:151], v[72:75], a[48:51], v[148:151]
  ds_read_b128 v[88:91], v24 offset:0
  ds_read_b128 v[92:95], v24 offset:256
  ds_read_b128 a[120:123], v19 offset:63488
  v_mfma_f32_16x16x32_bf16 v[148:151], v[76:79], a[52:55], v[148:151]
  s_add_u32 s66, s93, 0
  buffer_load_dwordx4 v32, s[52:55], s66 offen offset:0 lds
  v_mfma_f32_16x16x32_bf16 v[148:151], v[80:83], a[56:59], v[148:151]
  ds_read_b128 v[96:99], v24 offset:512
  ds_read_b128 v[100:103], v24 offset:768
  ds_read_b128 a[124:127], v19 offset:64512
  v_mfma_f32_16x16x32_bf16 v[148:151], v[84:87], a[60:63], v[148:151]
  s_waitcnt lgkmcnt(7)
  s_add_u32 s67, s93, 6144
  v_mfma_f32_16x16x32_bf16 v[152:155], v[72:75], a[80:83], v[152:155]
  ds_read_b128 v[104:107], v24 offset:1024
  ds_read_b128 v[108:111], v24 offset:1280
  ds_read_b128 a[144:147], v20 offset:12288
  ds_read_b128 v[112:115], v24 offset:1536
  v_mfma_f32_16x16x32_bf16 v[152:155], v[76:79], a[84:87], v[152:155]
  ds_read_b128 a[148:151], v20 offset:13312
  buffer_load_dwordx4 v32, s[52:55], s67 offen offset:1024 lds
  v_mfma_f32_16x16x32_bf16 v[152:155], v[80:83], a[88:91], v[152:155]
  ds_read_b128 a[152:155], v20 offset:18432
  ds_read_b128 a[156:159], v20 offset:19456
  v_mfma_f32_16x16x32_bf16 v[152:155], v[84:87], a[92:95], v[152:155]
  s_waitcnt lgkmcnt(7)
  ds_read_b128 a[176:179], v20 offset:14336
  v_mfma_f32_16x16x32_bf16 v[156:159], v[72:75], a[112:115], v[156:159]
  ds_read_b128 a[180:183], v20 offset:15360
  ds_read_b128 a[184:187], v20 offset:20480
  v_mfma_f32_16x16x32_bf16 v[156:159], v[76:79], a[116:119], v[156:159]
  ds_read_b128 a[188:191], v20 offset:21504
  s_add_u32 s66, s93, 12288
  v_mfma_f32_16x16x32_bf16 v[156:159], v[80:83], a[120:123], v[156:159]
  buffer_load_dwordx4 v32, s[52:55], s66 offen offset:2048 lds
  v_mfma_f32_16x16x32_bf16 v[156:159], v[84:87], a[124:127], v[156:159]
  s_waitcnt lgkmcnt(7)
  ds_read_b128 a[208:211], v20 offset:16384
  v_mfma_f32_16x16x32_bf16 v[160:163], v[72:75], a[144:147], v[160:163]
  ds_read_b128 a[212:215], v20 offset:17408
  ds_read_b128 a[216:219], v20 offset:22528
  s_waitcnt lgkmcnt(9)
  v_mfma_f32_16x16x32_bf16 v[160:163], v[76:79], a[148:151], v[160:163]
  ds_read_b128 a[220:223], v20 offset:23552
  s_waitcnt lgkmcnt(9)
  v_mfma_f32_16x16x32_bf16 v[160:163], v[80:83], a[152:155], v[160:163]
  ds_read_b64_tr_b16 v[56:57], v14 offset:8192
  ds_read_b64_tr_b16 v[58:59], v14 offset:10240
  s_waitcnt lgkmcnt(10)
  v_mfma_f32_16x16x32_bf16 v[160:163], v[84:87], a[156:159], v[160:163]
  s_waitcnt lgkmcnt(7)
  ds_read_b64_tr_b16 v[60:61], v14 offset:40960
  v_mfma_f32_16x16x32_bf16 v[164:167], v[72:75], a[176:179], v[164:167]
  ds_read_b64_tr_b16 v[62:63], v14 offset:43008
  ds_read_b64_tr_b16 v[64:65], v15 offset:8192
  v_mfma_f32_16x16x32_bf16 v[164:167], v[76:79], a[180:183], v[164:167]
  ds_read_b64_tr_b16 v[66:67], v15 offset:10240
  s_add_u32 s67, s93, 18432
  v_mfma_f32_16x16x32_bf16 v[164:167], v[80:83], a[184:187], v[164:167]
  ds_read_b64_tr_b16 v[68:69], v15 offset:40960
  buffer_load_dwordx4 v32, s[52:55], s67 offen offset:3072 lds
  s_waitcnt lgkmcnt(11)
  v_mfma_f32_16x16x32_bf16 v[164:167], v[84:87], a[188:191], v[164:167]
  ds_read_b64_tr_b16 v[70:71], v15 offset:43008
  s_waitcnt lgkmcnt(11)
  v_mfma_f32_16x16x32_bf16 v[168:171], v[72:75], a[208:211], v[168:171]
  s_waitcnt lgkmcnt(10)
  v_mfma_f32_16x16x32_bf16 v[168:171], v[76:79], a[212:215], v[168:171]
  s_waitcnt lgkmcnt(9)
  v_mfma_f32_16x16x32_bf16 v[168:171], v[80:83], a[216:219], v[168:171]
  s_waitcnt lgkmcnt(8)
  v_mfma_f32_16x16x32_bf16 v[168:171], v[84:87], a[220:223], v[168:171]
  s_waitcnt lgkmcnt(6)
  v_mfma_f32_16x16x32_bf16 v[172:175], v[56:59], a[0:3], 0
  v_add_f32 v88, v88, v89
  v_add_f32 v90, v90, v91
  s_waitcnt lgkmcnt(4)
  v_mfma_f32_16x16x32_bf16 v[172:175], v[60:63], a[4:7], v[172:175]
  s_add_u32 m0, s62, 4096
  v_add_f32 v88, v88, v90
  s_waitcnt lgkmcnt(2)
  v_mfma_f32_16x16x32_bf16 v[172:175], v[64:67], a[8:11], v[172:175]
  v_rcp_f32 v120, v88
  v_add_f32 v92, v92, v93
  s_waitcnt lgkmcnt(0)
  v_mfma_f32_16x16x32_bf16 v[172:175], v[68:71], a[12:15], v[172:175]
  v_add_f32 v94, v94, v95
  v_add_f32 v92, v92, v94
  v_mfma_f32_16x16x32_bf16 v[176:179], v[56:59], a[32:35], 0
  v_rcp_f32 v121, v92
  v_mfma_f32_16x16x32_bf16 v[176:179], v[60:63], a[36:39], v[176:179]
  v_add_f32 v96, v96, v97
  v_add_f32 v98, v98, v99
  v_mfma_f32_16x16x32_bf16 v[176:179], v[64:67], a[40:43], v[176:179]
  s_add_u32 s66, s93, 114688
  buffer_load_dwordx4 v32, s[52:55], s66 offen offset:0 lds
  v_mfma_f32_16x16x32_bf16 v[176:179], v[68:71], a[44:47], v[176:179]
  ds_read_b64_tr_b16 v[72:73], v14 offset:12288
  v_add_f32 v96, v96, v98
  v_mfma_f32_16x16x32_bf16 v[180:183], v[56:59], a[64:67], 0
  v_rcp_f32 v122, v96
  v_add_f32 v100, v100, v101
  v_mfma_f32_16x16x32_bf16 v[180:183], v[60:63], a[68:71], v[180:183]
  v_add_f32 v102, v102, v103
  v_add_f32 v100, v100, v102
  v_mfma_f32_16x16x32_bf16 v[180:183], v[64:67], a[72:75], v[180:183]
  v_rcp_f32 v123, v100
  v_mfma_f32_16x16x32_bf16 v[180:183], v[68:71], a[76:79], v[180:183]
  v_add_f32 v104, v104, v105
  v_add_f32 v106, v106, v107
  v_mfma_f32_16x16x32_bf16 v[184:187], v[56:59], a[96:99], 0
  s_add_u32 s67, s93, 120832
  v_add_f32 v104, v104, v106
  v_mfma_f32_16x16x32_bf16 v[184:187], v[60:63], a[100:103], v[184:187]
  buffer_load_dwordx4 v32, s[52:55], s67 offen offset:1024 lds
  ds_read_b64_tr_b16 v[74:75], v14 offset:14336
  ds_read_b64_tr_b16 v[76:77], v14 offset:45056
  v_mfma_f32_16x16x32_bf16 v[184:187], v[64:67], a[104:107], v[184:187]
  v_rcp_f32 v124, v104
  v_mfma_f32_16x16x32_bf16 v[184:187], v[68:71], a[108:111], v[184:187]
  v_add_f32 v108, v108, v109
  v_add_f32 v110, v110, v111
  v_mfma_f32_16x16x32_bf16 v[188:191], v[56:59], a[128:131], 0
  ds_read_b64_tr_b16 v[78:79], v14 offset:47104
  v_add_f32 v108, v108, v110
  v_mfma_f32_16x16x32_bf16 v[188:191], v[60:63], a[132:135], v[188:191]
  v_rcp_f32 v125, v108
  v_mfma_f32_16x16x32_bf16 v[188:191], v[64:67], a[136:139], v[188:191]
  v_add_f32 v112, v112, v113
  v_add_f32 v114, v114, v115
  v_mfma_f32_16x16x32_bf16 v[188:191], v[68:71], a[140:143], v[188:191]
  s_add_u32 s66, s93, 126976
  ds_read_b64_tr_b16 v[80:81], v15 offset:12288
  v_add_f32 v112, v112, v114
  v_mfma_f32_16x16x32_bf16 v[192:195], v[56:59], a[160:163], 0
  buffer_load_dwordx4 v32, s[52:55], s66 offen offset:2048 lds
  ds_read_b64_tr_b16 v[82:83], v15 offset:14336
  v_mfma_f32_16x16x32_bf16 v[192:195], v[60:63], a[164:167], v[192:195]
  v_rcp_f32 v126, v112
  v_mfma_f32_16x16x32_bf16 v[192:195], v[64:67], a[168:171], v[192:195]
  ds_read_b64_tr_b16 v[84:85], v15 offset:45056
  ds_read_b64_tr_b16 v[86:87], v15 offset:47104
  v_mfma_f32_16x16x32_bf16 v[192:195], v[68:71], a[172:175], v[192:195]
  v_add_f32 v3, v88, v92
  v_add_f32 v3, v3, v96
  v_mfma_f32_16x16x32_bf16 v[196:199], v[56:59], a[192:195], 0
  v_add_f32 v3, v3, v100
  v_add_f32 v3, v3, v104
  v_mfma_f32_16x16x32_bf16 v[196:199], v[60:63], a[196:199], v[196:199]
  s_add_u32 s67, s93, 133120
  v_add_f32 v3, v3, v108
  v_add_f32 v3, v3, v112
  v_mfma_f32_16x16x32_bf16 v[196:199], v[64:67], a[200:203], v[196:199]
  buffer_load_dwordx4 v32, s[52:55], s67 offen offset:3072 lds
  v_mfma_f32_16x16x32_bf16 v[196:199], v[68:71], a[204:207], v[196:199]
  s_cmp_eq_u32 s70, 0
  v_cmp_nge_f32 vcc, 0x53800000, v3
  s_cselect_b64 vcc, vcc, 0
  s_waitcnt vmcnt(8) lgkmcnt(0)
  s_barrier
  s_cbranch_vccnz L_restart
  v_mfma_f32_16x16x32_bf16 v[172:175], v[72:75], a[16:19], v[172:175]
  v_mul_f32 v144, v144, v120
  v_mul_f32 v145, v145, v120
  v_mul_f32 v146, v146, v120
  v_mfma_f32_16x16x32_bf16 v[172:175], v[76:79], a[20:23], v[172:175]
  v_mul_f32 v147, v147, v120
  v_cvt_pk_bf16_f32 v200, v144, v145
  v_mfma_f32_16x16x32_bf16 v[172:175], v[80:83], a[24:27], v[172:175]
  v_cvt_pk_bf16_f32 v201, v146, v147
  v_mul_f32 v148, v148, v121
  v_mfma_f32_16x16x32_bf16 v[172:175], v[84:87], a[28:31], v[172:175]
  v_mul_f32 v149, v149, v121
  v_mul_f32 v150, v150, v121
  v_mul_f32 v151, v151, v121
  v_mfma_f32_16x16x32_bf16 v[176:179], v[72:75], a[48:51], v[176:179]
  s_add_u32 m0, s62, 8192
  s_add_u32 s93, s93, 128
  v_cvt_pk_bf16_f32 v202, v148, v149
  v_mfma_f32_16x16x32_bf16 v[176:179], v[76:79], a[52:55], v[176:179]
  s_cmp_lg_u32 s93, 896
  s_cselect_b32 s93, s93, 0
  v_mfma_f32_16x16x32_bf16 v[176:179], v[80:83], a[56:59], v[176:179]
  s_add_u32 s66, s93, 0
  buffer_load_dwordx4 v32, s[52:55], s66 offen offset:0 lds
  v_mfma_f32_16x16x32_bf16 v[176:179], v[84:87], a[60:63], v[176:179]
  ds_read_b64_tr_b16 v[56:57], v14 offset:16384
  ds_read_b64_tr_b16 v[58:59], v14 offset:18432
  v_cvt_pk_bf16_f32 v203, v150, v151
  v_mfma_f32_16x16x32_bf16 v[180:183], v[72:75], a[80:83], v[180:183]
  buffer_store_dwordx4 v[200:203], v16, s[56:59], s68 offen offset:0 sc1
  v_mul_f32 v152, v152, v122
  v_mfma_f32_16x16x32_bf16 v[180:183], v[76:79], a[84:87], v[180:183]
  v_mul_f32 v153, v153, v122
  v_mul_f32 v154, v154, v122
  v_mfma_f32_16x16x32_bf16 v[180:183], v[80:83], a[88:91], v[180:183]
  v_mul_f32 v155, v155, v122
  v_cvt_pk_bf16_f32 v204, v152, v153
  v_mfma_f32_16x16x32_bf16 v[180:183], v[84:87], a[92:95], v[180:183]
  v_cvt_pk_bf16_f32 v205, v154, v155
  v_mul_f32 v156, v156, v123
  v_mul_f32 v157, v157, v123
  v_mfma_f32_16x16x32_bf16 v[184:187], v[72:75], a[112:115], v[184:187]
  v_mul_f32 v158, v158, v123
  v_mul_f32 v159, v159, v123
  v_cvt_pk_bf16_f32 v206, v156, v157
  v_mfma_f32_16x16x32_bf16 v[184:187], v[76:79], a[116:119], v[184:187]
  s_add_u32 s67, s93, 6144
  buffer_load_dwordx4 v32, s[52:55], s67 offen offset:1024 lds
  v_mfma_f32_16x16x32_bf16 v[184:187], v[80:83], a[120:123], v[184:187]
  ds_read_b64_tr_b16 v[60:61], v14 offset:49152
  v_cvt_pk_bf16_f32 v207, v158, v159
  v_mfma_f32_16x16x32_bf16 v[184:187], v[84:87], a[124:127], v[184:187]
  buffer_store_dwordx4 v[204:207], v16, s[56:59], s68 offen offset:1024 sc1
  v_mul_f32 v160, v160, v124
  v_mfma_f32_16x16x32_bf16 v[188:191], v[72:75], a[144:147], v[188:191]
  v_mul_f32 v161, v161, v124
  v_mul_f32 v162, v162, v124
  v_mul_f32 v163, v163, v124
  v_mfma_f32_16x16x32_bf16 v[188:191], v[76:79], a[148:151], v[188:191]
  v_cvt_pk_bf16_f32 v208, v160, v161
  v_cvt_pk_bf16_f32 v209, v162, v163
  v_mfma_f32_16x16x32_bf16 v[188:191], v[80:83], a[152:155], v[188:191]
  v_mul_f32 v164, v164, v125
  v_mul_f32 v165, v165, v125
  v_mfma_f32_16x16x32_bf16 v[188:191], v[84:87], a[156:159], v[188:191]
  v_mul_f32 v166, v166, v125
  v_mul_f32 v167, v167, v125
  v_cvt_pk_bf16_f32 v210, v164, v165
  v_mfma_f32_16x16x32_bf16 v[192:195], v[72:75], a[176:179], v[192:195]
  s_add_u32 s66, s93, 12288
  buffer_load_dwordx4 v32, s[52:55], s66 offen offset:2048 lds
  v_cvt_pk_bf16_f32 v211, v166, v167
  v_mfma_f32_16x16x32_bf16 v[192:195], v[76:79], a[180:183], v[192:195]
  buffer_store_dwordx4 v[208:211], v16, s[56:59], s68 offen offset:2048 sc1
  v_mfma_f32_16x16x32_bf16 v[192:195], v[80:83], a[184:187], v[192:195]
  ds_read_b64_tr_b16 v[62:63], v14 offset:51200
  ds_read_b64_tr_b16 v[64:65], v15 offset:16384
  v_mfma_f32_16x16x32_bf16 v[192:195], v[84:87], a[188:191], v[192:195]
  ds_read_b64_tr_b16 v[66:67], v15 offset:18432
  v_mul_f32 v168, v168, v126
  v_mul_f32 v169, v169, v126
  v_mfma_f32_16x16x32_bf16 v[196:199], v[72:75], a[208:211], v[196:199]
  ds_read_b64_tr_b16 v[68:69], v15 offset:49152
  ds_read_b64_tr_b16 v[70:71], v15 offset:51200
  v_mul_f32 v170, v170, v126
  v_mfma_f32_16x16x32_bf16 v[196:199], v[76:79], a[212:215], v[196:199]
  v_mul_f32 v171, v171, v126
  v_cvt_pk_bf16_f32 v212, v168, v169
  v_mfma_f32_16x16x32_bf16 v[196:199], v[80:83], a[216:219], v[196:199]
  s_add_u32 s67, s93, 18432
  v_cvt_pk_bf16_f32 v213, v170, v171
  v_mfma_f32_16x16x32_bf16 v[196:199], v[84:87], a[220:223], v[196:199]
  buffer_store_dwordx2 v[212:213], v17, s[56:59], s68 offen offset:3072 sc1
  buffer_load_dwordx4 v32, s[52:55], s67 offen offset:3072 lds
  s_waitcnt lgkmcnt(6)
  v_mfma_f32_16x16x32_bf16 v[144:147], v[56:59], a[0:3], 0
  s_add_u32 m0, s62, 12288
  ds_read_b64_tr_b16 v[72:73], v14 offset:20480
  s_waitcnt lgkmcnt(5)
  v_mfma_f32_16x16x32_bf16 v[144:147], v[60:63], a[4:7], v[144:147]
  s_add_u32 s66, s93, 114688
  ds_read_b64_tr_b16 v[74:75], v14 offset:22528
  s_waitcnt lgkmcnt(4)
  v_mfma_f32_16x16x32_bf16 v[144:147], v[64:67], a[8:11], v[144:147]
  ds_read_b64_tr_b16 v[76:77], v14 offset:53248
  buffer_load_dwordx4 v32, s[52:55], s66 offen offset:0 lds
  s_waitcnt lgkmcnt(3)
  v_mfma_f32_16x16x32_bf16 v[144:147], v[68:71], a[12:15], v[144:147]
  ds_read_b64_tr_b16 v[78:79], v14 offset:55296
  ds_read_b64_tr_b16 v[80:81], v15 offset:20480
  v_mfma_f32_16x16x32_bf16 v[148:151], v[56:59], a[32:35], 0
  s_add_u32 s68, s68, 14336
  ds_read_b64_tr_b16 v[82:83], v15 offset:22528
  v_mfma_f32_16x16x32_bf16 v[148:151], v[60:63], a[36:39], v[148:151]
  s_cmp_lg_u32 s68, 100352
  s_cselect_b32 s68, s68, 0
  v_mfma_f32_16x16x32_bf16 v[148:151], v[64:67], a[40:43], v[148:151]
  v_mul_f32 v172, v172, v120
  v_mul_f32 v173, v173, v120
  v_mfma_f32_16x16x32_bf16 v[148:151], v[68:71], a[44:47], v[148:151]
  v_mul_f32 v174, v174, v120
  v_mul_f32 v175, v175, v120
  v_mfma_f32_16x16x32_bf16 v[152:155], v[56:59], a[64:67], 0
  v_cvt_pk_bf16_f32 v216, v172, v173
  v_cvt_pk_bf16_f32 v217, v174, v175
  v_mfma_f32_16x16x32_bf16 v[152:155], v[60:63], a[68:71], v[152:155]
  v_mul_f32 v176, v176, v121
  v_mul_f32 v177, v177, v121
  v_mfma_f32_16x16x32_bf16 v[152:155], v[64:67], a[72:75], v[152:155]
  v_mul_f32 v178, v178, v121
  v_mul_f32 v179, v179, v121
  v_mfma_f32_16x16x32_bf16 v[152:155], v[68:71], a[76:79], v[152:155]
  v_cvt_pk_bf16_f32 v218, v176, v177
  v_cvt_pk_bf16_f32 v219, v178, v179
  v_mfma_f32_16x16x32_bf16 v[156:159], v[56:59], a[96:99], 0
  s_add_u32 s67, s93, 120832
  buffer_load_dwordx4 v32, s[52:55], s67 offen offset:1024 lds
  v_mfma_f32_16x16x32_bf16 v[156:159], v[60:63], a[100:103], v[156:159]
  buffer_store_dwordx4 v[216:219], v16, s[56:59], s68 offen offset:0 sc1
  v_mfma_f32_16x16x32_bf16 v[156:159], v[64:67], a[104:107], v[156:159]
  v_mul_f32 v180, v180, v122
  v_mul_f32 v181, v181, v122
  v_mfma_f32_16x16x32_bf16 v[156:159], v[68:71], a[108:111], v[156:159]
  v_mul_f32 v182, v182, v122
  v_mul_f32 v183, v183, v122
  v_mfma_f32_16x16x32_bf16 v[160:163], v[56:59], a[128:131], 0
  s_add_u32 s66, s93, 126976
  v_cvt_pk_bf16_f32 v220, v180, v181
  v_mfma_f32_16x16x32_bf16 v[160:163], v[60:63], a[132:135], v[160:163]
  ds_read_b64_tr_b16 v[84:85], v15 offset:53248
  v_cvt_pk_bf16_f32 v221, v182, v183
  v_mfma_f32_16x16x32_bf16 v[160:163], v[64:67], a[136:139], v[160:163]
  buffer_load_dwordx4 v32, s[52:55], s66 offen offset:2048 lds
  v_mul_f32 v184, v184, v123
  v_mfma_f32_16x16x32_bf16 v[160:163], v[68:71], a[140:143], v[160:163]
  ds_read_b64_tr_b16 v[86:87], v15 offset:55296
  v_mul_f32 v185, v185, v123
  v_mfma_f32_16x16x32_bf16 v[164:167], v[56:59], a[160:163], 0
  s_add_u32 s67, s93, 133120
  v_mul_f32 v186, v186, v123
  v_mfma_f32_16x16x32_bf16 v[164:167], v[60:63], a[164:167], v[164:167]
  buffer_load_dwordx4 v32, s[52:55], s67 offen offset:3072 lds
  v_mfma_f32_16x16x32_bf16 v[164:167], v[64:67], a[168:171], v[164:167]
  v_mfma_f32_16x16x32_bf16 v[164:167], v[68:71], a[172:175], v[164:167]
  v_mfma_f32_16x16x32_bf16 v[168:171], v[56:59], a[192:195], 0
  v_mfma_f32_16x16x32_bf16 v[168:171], v[60:63], a[196:199], v[168:171]
  v_mfma_f32_16x16x32_bf16 v[168:171], v[64:67], a[200:203], v[168:171]
  v_mfma_f32_16x16x32_bf16 v[168:171], v[68:71], a[204:207], v[168:171]
  s_waitcnt vmcnt(13) lgkmcnt(0)
  s_barrier
  v_mfma_f32_16x16x32_bf16 v[144:147], v[72:75], a[16:19], v[144:147]
  v_mul_f32 v187, v187, v123
  v_cvt_pk_bf16_f32 v222, v184, v185
  v_mfma_f32_16x16x32_bf16 v[144:147], v[76:79], a[20:23], v[144:147]
  s_add_u32 m0, s62, 24576
  v_cvt_pk_bf16_f32 v223, v186, v187
  v_mfma_f32_16x16x32_bf16 v[144:147], v[80:83], a[24:27], v[144:147]
  s_add_u32 s93, s93, 128
  ds_read_b64_tr_b16 v[56:57], v14 offset:0
  v_mfma_f32_16x16x32_bf16 v[144:147], v[84:87], a[28:31], v[144:147]
  s_cmp_lg_u32 s93, 896
  s_cselect_b32 s93, s93, 0
  v_mfma_f32_16x16x32_bf16 v[148:151], v[72:75], a[48:51], v[148:151]
  buffer_store_dwordx4 v[220:223], v16, s[56:59], s68 offen offset:1024 sc1
  v_mfma_f32_16x16x32_bf16 v[148:151], v[76:79], a[52:55], v[148:151]
  s_add_u32 s66, s93, 0
  v_mul_f32 v188, v188, v124
  v_mfma_f32_16x16x32_bf16 v[148:151], v[80:83], a[56:59], v[148:151]
  buffer_load_dwordx4 v32, s[52:55], s66 offen offset:0 lds
  v_mul_f32 v189, v189, v124
  v_mfma_f32_16x16x32_bf16 v[148:151], v[84:87], a[60:63], v[148:151]
  v_mul_f32 v190, v190, v124
  v_mul_f32 v191, v191, v124
  v_mfma_f32_16x16x32_bf16 v[152:155], v[72:75], a[80:83], v[152:155]
  v_cvt_pk_bf16_f32 v224, v188, v189
  v_cvt_pk_bf16_f32 v225, v190, v191
  v_mfma_f32_16x16x32_bf16 v[152:155], v[76:79], a[84:87], v[152:155]
  v_mul_f32 v192, v192, v125
  v_mul_f32 v193, v193, v125
  v_mfma_f32_16x16x32_bf16 v[152:155], v[80:83], a[88:91], v[152:155]
  v_mul_f32 v194, v194, v125
  v_mul_f32 v195, v195, v125
  v_mfma_f32_16x16x32_bf16 v[152:155], v[84:87], a[92:95], v[152:155]
  s_add_u32 s67, s93, 6144
  v_cvt_pk_bf16_f32 v226, v192, v193
  v_mfma_f32_16x16x32_bf16 v[156:159], v[72:75], a[112:115], v[156:159]
  ds_read_b64_tr_b16 v[58:59], v14 offset:2048
  v_cvt_pk_bf16_f32 v227, v194, v195
  v_mfma_f32_16x16x32_bf16 v[156:159], v[76:79], a[116:119], v[156:159]
  buffer_load_dwordx4 v32, s[52:55], s67 offen offset:1024 lds
  ds_read_b64_tr_b16 v[60:61], v14 offset:32768
  v_mfma_f32_16x16x32_bf16 v[156:159], v[80:83], a[120:123], v[156:159]
  buffer_store_dwordx4 v[224:227], v16, s[56:59], s68 offen offset:2048 sc1
  v_mfma_f32_16x16x32_bf16 v[156:159], v[84:87], a[124:127], v[156:159]
  v_mul_f32 v196, v196, v126
  v_mul_f32 v197, v197, v126
  v_mfma_f32_16x16x32_bf16 v[160:163], v[72:75], a[144:147], v[160:163]
  ds_read_b64_tr_b16 v[62:63], v14 offset:34816
  v_mul_f32 v198, v198, v126
  v_mfma_f32_16x16x32_bf16 v[160:163], v[76:79], a[148:151], v[160:163]
  s_add_u32 s66, s93, 12288
  ds_read_b64_tr_b16 v[64:65], v15 offset:0
  v_mfma_f32_16x16x32_bf16 v[160:163], v[80:83], a[152:155], v[160:163]
  ds_read_b64_tr_b16 v[66:67], v15 offset:2048
  v_mul_f32 v199, v199, v126
  v_mfma_f32_16x16x32_bf16 v[160:163], v[84:87], a[156:159], v[160:163]
  buffer_load_dwordx4 v32, s[52:55], s66 offen offset:2048 lds
  v_cvt_pk_bf16_f32 v228, v196, v197
  v_mfma_f32_16x16x32_bf16 v[164:167], v[72:75], a[176:179], v[164:167]
  ds_read_b64_tr_b16 v[68:69], v15 offset:32768
  v_cvt_pk_bf16_f32 v229, v198, v199
  v_mfma_f32_16x16x32_bf16 v[164:167], v[76:79], a[180:183], v[164:167]
  buffer_store_dwordx2 v[228:229], v17, s[56:59], s68 offen offset:3072 sc1
  v_mfma_f32_16x16x32_bf16 v[164:167], v[80:83], a[184:187], v[164:167]
  ds_read_b64_tr_b16 v[70:71], v15 offset:34816
  s_add_u32 s67, s93, 18432
  v_mfma_f32_16x16x32_bf16 v[164:167], v[84:87], a[188:191], v[164:167]
  buffer_load_dwordx4 v32, s[52:55], s67 offen offset:3072 lds
  v_mfma_f32_16x16x32_bf16 v[168:171], v[72:75], a[208:211], v[168:171]
  v_mfma_f32_16x16x32_bf16 v[168:171], v[76:79], a[212:215], v[168:171]
  v_mfma_f32_16x16x32_bf16 v[168:171], v[80:83], a[216:219], v[168:171]
  v_mfma_f32_16x16x32_bf16 v[168:171], v[84:87], a[220:223], v[168:171]
  s_waitcnt lgkmcnt(6)
  v_mfma_f32_16x16x32_bf16 v[172:175], v[56:59], a[0:3], 0
  s_add_u32 m0, s62, 28672
  ds_read_b64_tr_b16 v[72:73], v14 offset:4096
  s_waitcnt lgkmcnt(5)
  v_mfma_f32_16x16x32_bf16 v[172:175], v[60:63], a[4:7], v[172:175]
  s_add_u32 s66, s93, 114688
  ds_read_b64_tr_b16 v[74:75], v14 offset:6144
  s_waitcnt lgkmcnt(4)
  v_mfma_f32_16x16x32_bf16 v[172:175], v[64:67], a[8:11], v[172:175]
  ds_read_b64_tr_b16 v[76:77], v14 offset:36864
  buffer_load_dwordx4 v32, s[52:55], s66 offen offset:0 lds
  s_waitcnt lgkmcnt(3)
  v_mfma_f32_16x16x32_bf16 v[172:175], v[68:71], a[12:15], v[172:175]
  ds_read_b64_tr_b16 v[78:79], v14 offset:38912
  ds_read_b64_tr_b16 v[80:81], v15 offset:4096
  v_mfma_f32_16x16x32_bf16 v[176:179], v[56:59], a[32:35], 0
  s_add_u32 s68, s68, 14336
  ds_read_b64_tr_b16 v[82:83], v15 offset:6144
  v_mfma_f32_16x16x32_bf16 v[176:179], v[60:63], a[36:39], v[176:179]
  s_cmp_lg_u32 s68, 100352
  s_cselect_b32 s68, s68, 0
  v_mfma_f32_16x16x32_bf16 v[176:179], v[64:67], a[40:43], v[176:179]
  v_mul_f32 v144, v144, v120
  v_mul_f32 v145, v145, v120
  v_mfma_f32_16x16x32_bf16 v[176:179], v[68:71], a[44:47], v[176:179]
  v_mul_f32 v146, v146, v120
  v_mul_f32 v147, v147, v120
  v_mfma_f32_16x16x32_bf16 v[180:183], v[56:59], a[64:67], 0
  v_cvt_pk_bf16_f32 v200, v144, v145
  v_cvt_pk_bf16_f32 v201, v146, v147
  v_mfma_f32_16x16x32_bf16 v[180:183], v[60:63], a[68:71], v[180:183]
  v_mul_f32 v148, v148, v121
  v_mul_f32 v149, v149, v121
  v_mfma_f32_16x16x32_bf16 v[180:183], v[64:67], a[72:75], v[180:183]
  v_mul_f32 v150, v150, v121
  v_mul_f32 v151, v151, v121
  v_mfma_f32_16x16x32_bf16 v[180:183], v[68:71], a[76:79], v[180:183]
  v_cvt_pk_bf16_f32 v202, v148, v149
  v_cvt_pk_bf16_f32 v203, v150, v151
  v_mfma_f32_16x16x32_bf16 v[184:187], v[56:59], a[96:99], 0
  s_add_u32 s67, s93, 120832
  buffer_load_dwordx4 v32, s[52:55], s67 offen offset:1024 lds
  v_mfma_f32_16x16x32_bf16 v[184:187], v[60:63], a[100:103], v[184:187]
  buffer_store_dwordx4 v[200:203], v16, s[56:59], s68 offen offset:0 sc1
  v_mfma_f32_16x16x32_bf16 v[184:187], v[64:67], a[104:107], v[184:187]
  v_mul_f32 v152, v152, v122
  v_mul_f32 v153, v153, v122
  v_mfma_f32_16x16x32_bf16 v[184:187], v[68:71], a[108:111], v[184:187]
  v_mul_f32 v154, v154, v122
  v_mul_f32 v155, v155, v122
  v_mfma_f32_16x16x32_bf16 v[188:191], v[56:59], a[128:131], 0
  s_add_u32 s66, s93, 126976
  v_cvt_pk_bf16_f32 v204, v152, v153
  v_mfma_f32_16x16x32_bf16 v[188:191], v[60:63], a[132:135], v[188:191]
  ds_read_b64_tr_b16 v[84:85], v15 offset:36864
  v_cvt_pk_bf16_f32 v205, v154, v155
  v_mfma_f32_16x16x32_bf16 v[188:191], v[64:67], a[136:139], v[188:191]
  buffer_load_dwordx4 v32, s[52:55], s66 offen offset:2048 lds
  v_mul_f32 v156, v156, v123
  v_mfma_f32_16x16x32_bf16 v[188:191], v[68:71], a[140:143], v[188:191]
  ds_read_b64_tr_b16 v[86:87], v15 offset:38912
  v_mul_f32 v157, v157, v123
  v_mfma_f32_16x16x32_bf16 v[192:195], v[56:59], a[160:163], 0
  s_add_u32 s67, s93, 133120
  v_mul_f32 v158, v158, v123
  v_mfma_f32_16x16x32_bf16 v[192:195], v[60:63], a[164:167], v[192:195]
  buffer_load_dwordx4 v32, s[52:55], s67 offen offset:3072 lds
  v_mfma_f32_16x16x32_bf16 v[192:195], v[64:67], a[168:171], v[192:195]
  v_mfma_f32_16x16x32_bf16 v[192:195], v[68:71], a[172:175], v[192:195]
  v_mfma_f32_16x16x32_bf16 v[196:199], v[56:59], a[192:195], 0
  v_mfma_f32_16x16x32_bf16 v[196:199], v[60:63], a[196:199], v[196:199]
  v_mfma_f32_16x16x32_bf16 v[196:199], v[64:67], a[200:203], v[196:199]
  v_mfma_f32_16x16x32_bf16 v[196:199], v[68:71], a[204:207], v[196:199]
  s_waitcnt vmcnt(12) lgkmcnt(0)
  s_barrier
  v_mfma_f32_16x16x32_bf16 v[172:175], v[72:75], a[16:19], v[172:175]
  v_mul_f32 v159, v159, v123
  v_cvt_pk_bf16_f32 v206, v156, v157
  v_mfma_f32_16x16x32_bf16 v[172:175], v[76:79], a[20:23], v[172:175]
  s_add_u32 m0, s62, 16384
  v_cvt_pk_bf16_f32 v207, v158, v159
  v_mfma_f32_16x16x32_bf16 v[172:175], v[80:83], a[24:27], v[172:175]
  s_add_u32 s93, s93, 128
  ds_read_b64_tr_b16 v[56:57], v14 offset:8192
  v_mfma_f32_16x16x32_bf16 v[172:175], v[84:87], a[28:31], v[172:175]
  s_cmp_lg_u32 s93, 896
  s_cselect_b32 s93, s93, 0
  v_mfma_f32_16x16x32_bf16 v[176:179], v[72:75], a[48:51], v[176:179]
  buffer_store_dwordx4 v[204:207], v16, s[56:59], s68 offen offset:1024 sc1
  v_mfma_f32_16x16x32_bf16 v[176:179], v[76:79], a[52:55], v[176:179]
  s_add_u32 s66, s93, 0
  v_mul_f32 v160, v160, v124
  v_mfma_f32_16x16x32_bf16 v[176:179], v[80:83], a[56:59], v[176:179]
  buffer_load_dwordx4 v32, s[52:55], s66 offen offset:0 lds
  v_mul_f32 v161, v161, v124
  v_mfma_f32_16x16x32_bf16 v[176:179], v[84:87], a[60:63], v[176:179]
  v_mul_f32 v162, v162, v124
  v_mul_f32 v163, v163, v124
  v_mfma_f32_16x16x32_bf16 v[180:183], v[72:75], a[80:83], v[180:183]
  v_cvt_pk_bf16_f32 v208, v160, v161
  v_cvt_pk_bf16_f32 v209, v162, v163
  v_mfma_f32_16x16x32_bf16 v[180:183], v[76:79], a[84:87], v[180:183]
  v_mul_f32 v164, v164, v125
  v_mul_f32 v165, v165, v125
  v_mfma_f32_16x16x32_bf16 v[180:183], v[80:83], a[88:91], v[180:183]
  v_mul_f32 v166, v166, v125
  v_mul_f32 v167, v167, v125
  v_mfma_f32_16x16x32_bf16 v[180:183], v[84:87], a[92:95], v[180:183]
  s_add_u32 s67, s93, 6144
  v_cvt_pk_bf16_f32 v210, v164, v165
  v_mfma_f32_16x16x32_bf16 v[184:187], v[72:75], a[112:115], v[184:187]
  s_lshl_b32 s3, s92, 4
  v_mov_b32 v4, s3
  global_load_dword v5, v4, s[30:31] sc1
  v_mfma_f32_16x16x32_bf16 v[184:187], v[76:79], a[116:119], v[184:187]
  buffer_load_dwordx4 v32, s[52:55], s67 offen offset:1024 lds
  v_cvt_pk_bf16_f32 v211, v166, v167
  v_mfma_f32_16x16x32_bf16 v[184:187], v[80:83], a[120:123], v[184:187]
  buffer_store_dwordx4 v[208:211], v16, s[56:59], s68 offen offset:2048 sc1
  v_mfma_f32_16x16x32_bf16 v[184:187], v[84:87], a[124:127], v[184:187]
  ds_read_b64_tr_b16 v[58:59], v14 offset:10240
  v_mul_f32 v168, v168, v126
  v_mfma_f32_16x16x32_bf16 v[188:191], v[72:75], a[144:147], v[188:191]
  ds_read_b64_tr_b16 v[60:61], v14 offset:40960
  v_mul_f32 v169, v169, v126
  v_mfma_f32_16x16x32_bf16 v[188:191], v[76:79], a[148:151], v[188:191]
  ds_read_b64_tr_b16 v[62:63], v14 offset:43008
  v_mul_f32 v170, v170, v126
  v_mfma_f32_16x16x32_bf16 v[188:191], v[80:83], a[152:155], v[188:191]
  s_add_u32 s66, s93, 12288
  ds_read_b64_tr_b16 v[64:65], v15 offset:8192
  v_mfma_f32_16x16x32_bf16 v[188:191], v[84:87], a[156:159], v[188:191]
  buffer_load_dwordx4 v32, s[52:55], s66 offen offset:2048 lds
  v_mul_f32 v171, v171, v126
  v_mfma_f32_16x16x32_bf16 v[192:195], v[72:75], a[176:179], v[192:195]
  ds_read_b64_tr_b16 v[66:67], v15 offset:10240
  v_cvt_pk_bf16_f32 v212, v168, v169
  v_mfma_f32_16x16x32_bf16 v[192:195], v[76:79], a[180:183], v[192:195]
  ds_read_b64_tr_b16 v[68:69], v15 offset:40960
  v_cvt_pk_bf16_f32 v213, v170, v171
  v_mfma_f32_16x16x32_bf16 v[192:195], v[80:83], a[184:187], v[192:195]
  ds_read_b64_tr_b16 v[70:71], v15 offset:43008
  s_add_u32 s67, s93, 18432
  v_mfma_f32_16x16x32_bf16 v[192:195], v[84:87], a[188:191], v[192:195]
  buffer_store_dwordx2 v[212:213], v17, s[56:59], s68 offen offset:3072 sc1
  v_mfma_f32_16x16x32_bf16 v[196:199], v[72:75], a[208:211], v[196:199]
  buffer_load_dwordx4 v32, s[52:55], s67 offen offset:3072 lds
  v_mfma_f32_16x16x32_bf16 v[196:199], v[76:79], a[212:215], v[196:199]
  v_mfma_f32_16x16x32_bf16 v[196:199], v[80:83], a[216:219], v[196:199]
  v_mfma_f32_16x16x32_bf16 v[196:199], v[84:87], a[220:223], v[196:199]
  s_waitcnt lgkmcnt(6)
  v_mfma_f32_16x16x32_bf16 v[144:147], v[56:59], a[0:3], 0
  s_add_u32 m0, s62, 20480
  ds_read_b64_tr_b16 v[72:73], v14 offset:12288
  s_waitcnt lgkmcnt(5)
  v_mfma_f32_16x16x32_bf16 v[144:147], v[60:63], a[4:7], v[144:147]
  s_add_u32 s66, s93, 114688
  ds_read_b64_tr_b16 v[74:75], v14 offset:14336
  s_waitcnt lgkmcnt(4)
  v_mfma_f32_16x16x32_bf16 v[144:147], v[64:67], a[8:11], v[144:147]
  ds_read_b64_tr_b16 v[76:77], v14 offset:45056
  buffer_load_dwordx4 v32, s[52:55], s66 offen offset:0 lds
  s_waitcnt lgkmcnt(3)
  v_mfma_f32_16x16x32_bf16 v[144:147], v[68:71], a[12:15], v[144:147]
  ds_read_b64_tr_b16 v[78:79], v14 offset:47104
  ds_read_b64_tr_b16 v[80:81], v15 offset:12288
  v_mfma_f32_16x16x32_bf16 v[148:151], v[56:59], a[32:35], 0
  s_add_u32 s68, s68, 14336
  ds_read_b64_tr_b16 v[82:83], v15 offset:14336
  v_mfma_f32_16x16x32_bf16 v[148:151], v[60:63], a[36:39], v[148:151]
  s_cmp_lg_u32 s68, 100352
  s_cselect_b32 s68, s68, 0
  v_mfma_f32_16x16x32_bf16 v[148:151], v[64:67], a[40:43], v[148:151]
  v_mul_f32 v172, v172, v120
  v_mul_f32 v173, v173, v120
  v_mfma_f32_16x16x32_bf16 v[148:151], v[68:71], a[44:47], v[148:151]
  v_mul_f32 v174, v174, v120
  v_mul_f32 v175, v175, v120
  v_mfma_f32_16x16x32_bf16 v[152:155], v[56:59], a[64:67], 0
  v_cvt_pk_bf16_f32 v216, v172, v173
  v_cvt_pk_bf16_f32 v217, v174, v175
  v_mfma_f32_16x16x32_bf16 v[152:155], v[60:63], a[68:71], v[152:155]
  v_mul_f32 v176, v176, v121
  v_mul_f32 v177, v177, v121
  v_mfma_f32_16x16x32_bf16 v[152:155], v[64:67], a[72:75], v[152:155]
  v_mul_f32 v178, v178, v121
  v_mul_f32 v179, v179, v121
  v_mfma_f32_16x16x32_bf16 v[152:155], v[68:71], a[76:79], v[152:155]
  v_cvt_pk_bf16_f32 v218, v176, v177
  v_cvt_pk_bf16_f32 v219, v178, v179
  v_mfma_f32_16x16x32_bf16 v[156:159], v[56:59], a[96:99], 0
  s_add_u32 s67, s93, 120832
  buffer_load_dwordx4 v32, s[52:55], s67 offen offset:1024 lds
  v_mfma_f32_16x16x32_bf16 v[156:159], v[60:63], a[100:103], v[156:159]
  buffer_store_dwordx4 v[216:219], v16, s[56:59], s68 offen offset:0 sc1
  v_mfma_f32_16x16x32_bf16 v[156:159], v[64:67], a[104:107], v[156:159]
  v_mul_f32 v180, v180, v122
  v_mul_f32 v181, v181, v122
  v_mfma_f32_16x16x32_bf16 v[156:159], v[68:71], a[108:111], v[156:159]
  v_mul_f32 v182, v182, v122
  v_mul_f32 v183, v183, v122
  v_mfma_f32_16x16x32_bf16 v[160:163], v[56:59], a[128:131], 0
  s_add_u32 s66, s93, 126976
  v_cvt_pk_bf16_f32 v220, v180, v181
  v_mfma_f32_16x16x32_bf16 v[160:163], v[60:63], a[132:135], v[160:163]
  ds_read_b64_tr_b16 v[84:85], v15 offset:45056
  v_cvt_pk_bf16_f32 v221, v182, v183
  v_mfma_f32_16x16x32_bf16 v[160:163], v[64:67], a[136:139], v[160:163]
  buffer_load_dwordx4 v32, s[52:55], s66 offen offset:2048 lds
  v_mul_f32 v184, v184, v123
  v_mfma_f32_16x16x32_bf16 v[160:163], v[68:71], a[140:143], v[160:163]
  ds_read_b64_tr_b16 v[86:87], v15 offset:47104
  v_mul_f32 v185, v185, v123
  v_mfma_f32_16x16x32_bf16 v[164:167], v[56:59], a[160:163], 0
  s_add_u32 s67, s93, 133120
  v_mul_f32 v186, v186, v123
  v_mfma_f32_16x16x32_bf16 v[164:167], v[60:63], a[164:167], v[164:167]
  buffer_load_dwordx4 v32, s[52:55], s67 offen offset:3072 lds
  v_mfma_f32_16x16x32_bf16 v[164:167], v[64:67], a[168:171], v[164:167]
  v_mfma_f32_16x16x32_bf16 v[164:167], v[68:71], a[172:175], v[164:167]
  v_mfma_f32_16x16x32_bf16 v[168:171], v[56:59], a[192:195], 0
  v_mfma_f32_16x16x32_bf16 v[168:171], v[60:63], a[196:199], v[168:171]
  v_mfma_f32_16x16x32_bf16 v[168:171], v[64:67], a[200:203], v[168:171]
  v_mfma_f32_16x16x32_bf16 v[168:171], v[68:71], a[204:207], v[168:171]
  s_waitcnt vmcnt(13) lgkmcnt(0)
  s_barrier
  v_mfma_f32_16x16x32_bf16 v[144:147], v[72:75], a[16:19], v[144:147]
  v_mul_f32 v187, v187, v123
  v_cvt_pk_bf16_f32 v222, v184, v185
  v_mfma_f32_16x16x32_bf16 v[144:147], v[76:79], a[20:23], v[144:147]
  ds_read_b64_tr_b16 v[56:57], v14 offset:24576
  v_cvt_pk_bf16_f32 v223, v186, v187
  v_mfma_f32_16x16x32_bf16 v[144:147], v[80:83], a[24:27], v[144:147]
  buffer_store_dwordx4 v[220:223], v16, s[56:59], s68 offen offset:1024 sc1
  v_mfma_f32_16x16x32_bf16 v[144:147], v[84:87], a[28:31], v[144:147]
  v_mul_f32 v188, v188, v124
  v_mul_f32 v189, v189, v124
  v_mfma_f32_16x16x32_bf16 v[148:151], v[72:75], a[48:51], v[148:151]
  v_mul_f32 v190, v190, v124
  v_mul_f32 v191, v191, v124
  v_mfma_f32_16x16x32_bf16 v[148:151], v[76:79], a[52:55], v[148:151]
  v_cvt_pk_bf16_f32 v224, v188, v189
  v_cvt_pk_bf16_f32 v225, v190, v191
  v_mfma_f32_16x16x32_bf16 v[148:151], v[80:83], a[56:59], v[148:151]
  v_mul_f32 v192, v192, v125
  v_mul_f32 v193, v193, v125
  v_mfma_f32_16x16x32_bf16 v[148:151], v[84:87], a[60:63], v[148:151]
  v_mul_f32 v194, v194, v125
  v_mul_f32 v195, v195, v125
  v_mfma_f32_16x16x32_bf16 v[152:155], v[72:75], a[80:83], v[152:155]
  v_cvt_pk_bf16_f32 v226, v192, v193
  v_cvt_pk_bf16_f32 v227, v194, v195
  v_mfma_f32_16x16x32_bf16 v[152:155], v[76:79], a[84:87], v[152:155]
  buffer_store_dwordx4 v[224:227], v16, s[56:59], s68 offen offset:2048 sc1
  v_mfma_f32_16x16x32_bf16 v[152:155], v[80:83], a[88:91], v[152:155]
  ds_read_b64_tr_b16 v[58:59], v14 offset:26624
  v_mul_f32 v196, v196, v126
  v_mfma_f32_16x16x32_bf16 v[152:155], v[84:87], a[92:95], v[152:155]
  ds_read_b64_tr_b16 v[60:61], v14 offset:57344
  v_mul_f32 v197, v197, v126
  v_mfma_f32_16x16x32_bf16 v[156:159], v[72:75], a[112:115], v[156:159]
  ds_read_b64_tr_b16 v[62:63], v14 offset:59392
  v_mul_f32 v198, v198, v126
  v_mfma_f32_16x16x32_bf16 v[156:159], v[76:79], a[116:119], v[156:159]
  ds_read_b64_tr_b16 v[64:65], v15 offset:24576
  v_mul_f32 v199, v199, v126
  v_mfma_f32_16x16x32_bf16 v[156:159], v[80:83], a[120:123], v[156:159]
  ds_read_b64_tr_b16 v[66:67], v15 offset:26624
  v_cvt_pk_bf16_f32 v228, v196, v197
  v_mfma_f32_16x16x32_bf16 v[156:159], v[84:87], a[124:127], v[156:159]
  ds_read_b64_tr_b16 v[68:69], v15 offset:57344
  v_cvt_pk_bf16_f32 v229, v198, v199
  v_mfma_f32_16x16x32_bf16 v[160:163], v[72:75], a[144:147], v[160:163]
  buffer_store_dwordx2 v[228:229], v17, s[56:59], s68 offen offset:3072 sc1
  v_mfma_f32_16x16x32_bf16 v[160:163], v[76:79], a[148:151], v[160:163]
  ds_read_b64_tr_b16 v[70:71], v15 offset:59392
  v_mfma_f32_16x16x32_bf16 v[160:163], v[80:83], a[152:155], v[160:163]
  v_mfma_f32_16x16x32_bf16 v[160:163], v[84:87], a[156:159], v[160:163]
  v_mfma_f32_16x16x32_bf16 v[164:167], v[72:75], a[176:179], v[164:167]
  v_mfma_f32_16x16x32_bf16 v[164:167], v[76:79], a[180:183], v[164:167]
  v_mfma_f32_16x16x32_bf16 v[164:167], v[80:83], a[184:187], v[164:167]
  v_mfma_f32_16x16x32_bf16 v[164:167], v[84:87], a[188:191], v[164:167]
  v_mfma_f32_16x16x32_bf16 v[168:171], v[72:75], a[208:211], v[168:171]
  v_mfma_f32_16x16x32_bf16 v[168:171], v[76:79], a[212:215], v[168:171]
  v_mfma_f32_16x16x32_bf16 v[168:171], v[80:83], a[216:219], v[168:171]
  v_mfma_f32_16x16x32_bf16 v[168:171], v[84:87], a[220:223], v[168:171]
  s_waitcnt lgkmcnt(6)
  v_mfma_f32_16x16x32_bf16 v[172:175], v[56:59], a[0:3], 0
  ds_read_b64_tr_b16 v[72:73], v14 offset:28672
  ds_read_b64_tr_b16 v[74:75], v14 offset:30720
  s_waitcnt lgkmcnt(6)
  v_mfma_f32_16x16x32_bf16 v[172:175], v[60:63], a[4:7], v[172:175]
  ds_read_b64_tr_b16 v[76:77], v14 offset:61440
  s_waitcnt lgkmcnt(5)
  v_mfma_f32_16x16x32_bf16 v[172:175], v[64:67], a[8:11], v[172:175]
  ds_read_b64_tr_b16 v[78:79], v14 offset:63488
  ds_read_b64_tr_b16 v[80:81], v15 offset:28672
  s_waitcnt lgkmcnt(5)
  v_mfma_f32_16x16x32_bf16 v[172:175], v[68:71], a[12:15], v[172:175]
  ds_read_b64_tr_b16 v[82:83], v15 offset:30720
  v_mfma_f32_16x16x32_bf16 v[176:179], v[56:59], a[32:35], 0
  s_add_u32 s68, s68, 14336
  ds_read_b64_tr_b16 v[84:85], v15 offset:61440
  v_mfma_f32_16x16x32_bf16 v[176:179], v[60:63], a[36:39], v[176:179]
  s_cmp_lg_u32 s68, 100352
  s_cselect_b32 s68, s68, 0
  v_mfma_f32_16x16x32_bf16 v[176:179], v[64:67], a[40:43], v[176:179]
  v_mul_f32 v144, v144, v120
  v_mul_f32 v145, v145, v120
  v_mfma_f32_16x16x32_bf16 v[176:179], v[68:71], a[44:47], v[176:179]
  v_mul_f32 v146, v146, v120
  v_mul_f32 v147, v147, v120
  v_mfma_f32_16x16x32_bf16 v[180:183], v[56:59], a[64:67], 0
  v_cvt_pk_bf16_f32 v200, v144, v145
  v_cvt_pk_bf16_f32 v201, v146, v147
  v_mfma_f32_16x16x32_bf16 v[180:183], v[60:63], a[68:71], v[180:183]
  v_mul_f32 v148, v148, v121
  v_mul_f32 v149, v149, v121
  v_mfma_f32_16x16x32_bf16 v[180:183], v[64:67], a[72:75], v[180:183]
  v_mul_f32 v150, v150, v121
  v_mul_f32 v151, v151, v121
  v_mfma_f32_16x16x32_bf16 v[180:183], v[68:71], a[76:79], v[180:183]
  v_cvt_pk_bf16_f32 v202, v148, v149
  v_cvt_pk_bf16_f32 v203, v150, v151
  v_mfma_f32_16x16x32_bf16 v[184:187], v[56:59], a[96:99], 0
  buffer_store_dwordx4 v[200:203], v16, s[56:59], s68 offen offset:0 sc1
  v_mfma_f32_16x16x32_bf16 v[184:187], v[60:63], a[100:103], v[184:187]
  v_mul_f32 v152, v152, v122
  v_mul_f32 v153, v153, v122
  v_mfma_f32_16x16x32_bf16 v[184:187], v[64:67], a[104:107], v[184:187]
  v_mul_f32 v154, v154, v122
  v_mul_f32 v155, v155, v122
  v_mfma_f32_16x16x32_bf16 v[184:187], v[68:71], a[108:111], v[184:187]
  v_cvt_pk_bf16_f32 v204, v152, v153
  v_cvt_pk_bf16_f32 v205, v154, v155
  v_mfma_f32_16x16x32_bf16 v[188:191], v[56:59], a[128:131], 0
  v_mul_f32 v156, v156, v123
  v_mul_f32 v157, v157, v123
  v_mfma_f32_16x16x32_bf16 v[188:191], v[60:63], a[132:135], v[188:191]
  ds_read_b64_tr_b16 v[86:87], v15 offset:63488
  v_mul_f32 v158, v158, v123
  v_mfma_f32_16x16x32_bf16 v[188:191], v[64:67], a[136:139], v[188:191]
  v_mfma_f32_16x16x32_bf16 v[188:191], v[68:71], a[140:143], v[188:191]
  v_mfma_f32_16x16x32_bf16 v[192:195], v[56:59], a[160:163], 0
  v_mfma_f32_16x16x32_bf16 v[192:195], v[60:63], a[164:167], v[192:195]
  v_mfma_f32_16x16x32_bf16 v[192:195], v[64:67], a[168:171], v[192:195]
  v_mfma_f32_16x16x32_bf16 v[192:195], v[68:71], a[172:175], v[192:195]
  v_mfma_f32_16x16x32_bf16 v[196:199], v[56:59], a[192:195], 0
  v_mfma_f32_16x16x32_bf16 v[196:199], v[60:63], a[196:199], v[196:199]
  v_mfma_f32_16x16x32_bf16 v[196:199], v[64:67], a[200:203], v[196:199]
  v_mfma_f32_16x16x32_bf16 v[196:199], v[68:71], a[204:207], v[196:199]
  s_waitcnt vmcnt(4) lgkmcnt(0)
  s_barrier
  v_mfma_f32_16x16x32_bf16 v[172:175], v[72:75], a[16:19], v[172:175]
  v_mul_f32 v159, v159, v123
  v_cvt_pk_bf16_f32 v206, v156, v157
  v_mfma_f32_16x16x32_bf16 v[172:175], v[76:79], a[20:23], v[172:175]
  ds_read_b64_tr_b16 v[56:57], v14 offset:16384
  v_cvt_pk_bf16_f32 v207, v158, v159
  v_mfma_f32_16x16x32_bf16 v[172:175], v[80:83], a[24:27], v[172:175]
  buffer_store_dwordx4 v[204:207], v16, s[56:59], s68 offen offset:1024 sc1
  v_mfma_f32_16x16x32_bf16 v[172:175], v[84:87], a[28:31], v[172:175]
  v_mul_f32 v160, v160, v124
  v_mul_f32 v161, v161, v124
  v_mfma_f32_16x16x32_bf16 v[176:179], v[72:75], a[48:51], v[176:179]
  v_mul_f32 v162, v162, v124
  v_mul_f32 v163, v163, v124
  v_mfma_f32_16x16x32_bf16 v[176:179], v[76:79], a[52:55], v[176:179]
  v_cvt_pk_bf16_f32 v208, v160, v161
  v_cvt_pk_bf16_f32 v209, v162, v163
  v_mfma_f32_16x16x32_bf16 v[176:179], v[80:83], a[56:59], v[176:179]
  v_mul_f32 v164, v164, v125
  v_mul_f32 v165, v165, v125
  v_mfma_f32_16x16x32_bf16 v[176:179], v[84:87], a[60:63], v[176:179]
  v_mul_f32 v166, v166, v125
  v_mul_f32 v167, v167, v125
  v_mfma_f32_16x16x32_bf16 v[180:183], v[72:75], a[80:83], v[180:183]
  v_cvt_pk_bf16_f32 v210, v164, v165
  v_cvt_pk_bf16_f32 v211, v166, v167
  v_mfma_f32_16x16x32_bf16 v[180:183], v[76:79], a[84:87], v[180:183]
  buffer_store_dwordx4 v[208:211], v16, s[56:59], s68 offen offset:2048 sc1
  v_mfma_f32_16x16x32_bf16 v[180:183], v[80:83], a[88:91], v[180:183]
  ds_read_b64_tr_b16 v[58:59], v14 offset:18432
  v_mul_f32 v168, v168, v126
  v_mfma_f32_16x16x32_bf16 v[180:183], v[84:87], a[92:95], v[180:183]
  ds_read_b64_tr_b16 v[60:61], v14 offset:49152
  v_mul_f32 v169, v169, v126
  v_mfma_f32_16x16x32_bf16 v[184:187], v[72:75], a[112:115], v[184:187]
  ds_read_b64_tr_b16 v[62:63], v14 offset:51200
  v_mul_f32 v170, v170, v126
  v_mfma_f32_16x16x32_bf16 v[184:187], v[76:79], a[116:119], v[184:187]
  ds_read_b64_tr_b16 v[64:65], v15 offset:16384
  v_mul_f32 v171, v171, v126
  v_mfma_f32_16x16x32_bf16 v[184:187], v[80:83], a[120:123], v[184:187]
  ds_read_b64_tr_b16 v[66:67], v15 offset:18432
  v_cvt_pk_bf16_f32 v212, v168, v169
  v_mfma_f32_16x16x32_bf16 v[184:187], v[84:87], a[124:127], v[184:187]
  ds_read_b64_tr_b16 v[68:69], v15 offset:49152
  v_cvt_pk_bf16_f32 v213, v170, v171
  v_mfma_f32_16x16x32_bf16 v[188:191], v[72:75], a[144:147], v[188:191]
  buffer_store_dwordx2 v[212:213], v17, s[56:59], s68 offen offset:3072 sc1
  v_mfma_f32_16x16x32_bf16 v[188:191], v[76:79], a[148:151], v[188:191]
  ds_read_b64_tr_b16 v[70:71], v15 offset:51200
  v_mfma_f32_16x16x32_bf16 v[188:191], v[80:83], a[152:155], v[188:191]
  v_mfma_f32_16x16x32_bf16 v[188:191], v[84:87], a[156:159], v[188:191]
  v_mfma_f32_16x16x32_bf16 v[192:195], v[72:75], a[176:179], v[192:195]
  v_mfma_f32_16x16x32_bf16 v[192:195], v[76:79], a[180:183], v[192:195]
  v_mfma_f32_16x16x32_bf16 v[192:195], v[80:83], a[184:187], v[192:195]
  v_mfma_f32_16x16x32_bf16 v[192:195], v[84:87], a[188:191], v[192:195]
  v_mfma_f32_16x16x32_bf16 v[196:199], v[72:75], a[208:211], v[196:199]
  v_mfma_f32_16x16x32_bf16 v[196:199], v[76:79], a[212:215], v[196:199]
  v_mfma_f32_16x16x32_bf16 v[196:199], v[80:83], a[216:219], v[196:199]
  v_mfma_f32_16x16x32_bf16 v[196:199], v[84:87], a[220:223], v[196:199]
  s_waitcnt lgkmcnt(6)
  v_mfma_f32_16x16x32_bf16 v[144:147], v[56:59], a[0:3], 0
  ds_read_b64_tr_b16 v[72:73], v14 offset:20480
  ds_read_b64_tr_b16 v[74:75], v14 offset:22528
  s_waitcnt lgkmcnt(6)
  v_mfma_f32_16x16x32_bf16 v[144:147], v[60:63], a[4:7], v[144:147]
  ds_read_b64_tr_b16 v[76:77], v14 offset:53248
  s_waitcnt lgkmcnt(5)
  v_mfma_f32_16x16x32_bf16 v[144:147], v[64:67], a[8:11], v[144:147]
  ds_read_b64_tr_b16 v[78:79], v14 offset:55296
  ds_read_b64_tr_b16 v[80:81], v15 offset:20480
  s_waitcnt lgkmcnt(5)
  v_mfma_f32_16x16x32_bf16 v[144:147], v[68:71], a[12:15], v[144:147]
  ds_read_b64_tr_b16 v[82:83], v15 offset:22528
  v_mfma_f32_16x16x32_bf16 v[148:151], v[56:59], a[32:35], 0
  s_add_u32 s68, s68, 14336
  ds_read_b64_tr_b16 v[84:85], v15 offset:53248
  v_mfma_f32_16x16x32_bf16 v[148:151], v[60:63], a[36:39], v[148:151]
  s_cmp_lg_u32 s68, 100352
  s_cselect_b32 s68, s68, 0
  v_mfma_f32_16x16x32_bf16 v[148:151], v[64:67], a[40:43], v[148:151]
  v_mul_f32 v172, v172, v120
  v_mul_f32 v173, v173, v120
  v_mfma_f32_16x16x32_bf16 v[148:151], v[68:71], a[44:47], v[148:151]
  v_mul_f32 v174, v174, v120
  v_mul_f32 v175, v175, v120
  v_mfma_f32_16x16x32_bf16 v[152:155], v[56:59], a[64:67], 0
  v_cvt_pk_bf16_f32 v216, v172, v173
  v_cvt_pk_bf16_f32 v217, v174, v175
  v_mfma_f32_16x16x32_bf16 v[152:155], v[60:63], a[68:71], v[152:155]
  v_mul_f32 v176, v176, v121
  v_mul_f32 v177, v177, v121
  v_mfma_f32_16x16x32_bf16 v[152:155], v[64:67], a[72:75], v[152:155]
  v_mul_f32 v178, v178, v121
  v_mul_f32 v179, v179, v121
  v_mfma_f32_16x16x32_bf16 v[152:155], v[68:71], a[76:79], v[152:155]
  v_cvt_pk_bf16_f32 v218, v176, v177
  v_cvt_pk_bf16_f32 v219, v178, v179
  v_mfma_f32_16x16x32_bf16 v[156:159], v[56:59], a[96:99], 0
  buffer_store_dwordx4 v[216:219], v16, s[56:59], s68 offen offset:0 sc1
  v_mfma_f32_16x16x32_bf16 v[156:159], v[60:63], a[100:103], v[156:159]
  v_mul_f32 v180, v180, v122
  v_mul_f32 v181, v181, v122
  v_mfma_f32_16x16x32_bf16 v[156:159], v[64:67], a[104:107], v[156:159]
  v_mul_f32 v182, v182, v122
  v_mul_f32 v183, v183, v122
  v_mfma_f32_16x16x32_bf16 v[156:159], v[68:71], a[108:111], v[156:159]
  v_cvt_pk_bf16_f32 v220, v180, v181
  v_cvt_pk_bf16_f32 v221, v182, v183
  v_mfma_f32_16x16x32_bf16 v[160:163], v[56:59], a[128:131], 0
  v_mul_f32 v184, v184, v123
  v_mul_f32 v185, v185, v123
  v_mfma_f32_16x16x32_bf16 v[160:163], v[60:63], a[132:135], v[160:163]
  ds_read_b64_tr_b16 v[86:87], v15 offset:55296
  v_mul_f32 v186, v186, v123
  v_mfma_f32_16x16x32_bf16 v[160:163], v[64:67], a[136:139], v[160:163]
  v_mfma_f32_16x16x32_bf16 v[160:163], v[68:71], a[140:143], v[160:163]
  v_mfma_f32_16x16x32_bf16 v[164:167], v[56:59], a[160:163], 0
  v_mfma_f32_16x16x32_bf16 v[164:167], v[60:63], a[164:167], v[164:167]
  v_mfma_f32_16x16x32_bf16 v[164:167], v[64:67], a[168:171], v[164:167]
  v_mfma_f32_16x16x32_bf16 v[164:167], v[68:71], a[172:175], v[164:167]
  v_mfma_f32_16x16x32_bf16 v[168:171], v[56:59], a[192:195], 0
  v_mfma_f32_16x16x32_bf16 v[168:171], v[60:63], a[196:199], v[168:171]
  v_mfma_f32_16x16x32_bf16 v[168:171], v[64:67], a[200:203], v[168:171]
  v_mfma_f32_16x16x32_bf16 v[168:171], v[68:71], a[204:207], v[168:171]
  s_waitcnt lgkmcnt(6)
  v_mfma_f32_16x16x32_bf16 v[144:147], v[72:75], a[16:19], v[144:147]
  v_mul_f32 v187, v187, v123
  v_cvt_pk_bf16_f32 v222, v184, v185
  s_waitcnt lgkmcnt(4)
  v_mfma_f32_16x16x32_bf16 v[144:147], v[76:79], a[20:23], v[144:147]
  v_cvt_pk_bf16_f32 v223, v186, v187
  s_waitcnt lgkmcnt(2)
  v_mfma_f32_16x16x32_bf16 v[144:147], v[80:83], a[24:27], v[144:147]
  buffer_store_dwordx4 v[220:223], v16, s[56:59], s68 offen offset:1024 sc1
  v_mul_f32 v188, v188, v124
  v_mul_f32 v189, v189, v124
  v_mul_f32 v190, v190, v124
  s_waitcnt lgkmcnt(0)
  v_mfma_f32_16x16x32_bf16 v[144:147], v[84:87], a[28:31], v[144:147]
  v_mul_f32 v191, v191, v124
  v_cvt_pk_bf16_f32 v224, v188, v189
  v_mfma_f32_16x16x32_bf16 v[148:151], v[72:75], a[48:51], v[148:151]
  v_cvt_pk_bf16_f32 v225, v190, v191
  v_mul_f32 v192, v192, v125
  v_mfma_f32_16x16x32_bf16 v[148:151], v[76:79], a[52:55], v[148:151]
  v_mul_f32 v193, v193, v125
  v_mul_f32 v194, v194, v125
  v_mul_f32 v195, v195, v125
  v_mfma_f32_16x16x32_bf16 v[148:151], v[80:83], a[56:59], v[148:151]
  v_cvt_pk_bf16_f32 v226, v192, v193
  v_cvt_pk_bf16_f32 v227, v194, v195
  v_mfma_f32_16x16x32_bf16 v[148:151], v[84:87], a[60:63], v[148:151]
  buffer_store_dwordx4 v[224:227], v16, s[56:59], s68 offen offset:2048 sc1
  v_mul_f32 v196, v196, v126
  v_mfma_f32_16x16x32_bf16 v[152:155], v[72:75], a[80:83], v[152:155]
  v_mul_f32 v197, v197, v126
  v_mul_f32 v198, v198, v126
  v_mfma_f32_16x16x32_bf16 v[152:155], v[76:79], a[84:87], v[152:155]
  v_mul_f32 v199, v199, v126
  v_cvt_pk_bf16_f32 v228, v196, v197
  v_cvt_pk_bf16_f32 v229, v198, v199
  v_mfma_f32_16x16x32_bf16 v[152:155], v[80:83], a[88:91], v[152:155]
  buffer_store_dwordx2 v[228:229], v17, s[56:59], s68 offen offset:3072 sc1
  v_mfma_f32_16x16x32_bf16 v[152:155], v[84:87], a[92:95], v[152:155]
  s_add_u32 s68, s68, 14336
  v_mfma_f32_16x16x32_bf16 v[156:159], v[72:75], a[112:115], v[156:159]
  s_cmp_lg_u32 s68, 100352
  s_cselect_b32 s68, s68, 0
  v_mul_f32 v144, v144, v120
  v_mfma_f32_16x16x32_bf16 v[156:159], v[76:79], a[116:119], v[156:159]
  v_mul_f32 v145, v145, v120
  v_mul_f32 v146, v146, v120
  v_mfma_f32_16x16x32_bf16 v[156:159], v[80:83], a[120:123], v[156:159]
  v_mul_f32 v147, v147, v120
  v_cvt_pk_bf16_f32 v200, v144, v145
  v_cvt_pk_bf16_f32 v201, v146, v147
  v_mfma_f32_16x16x32_bf16 v[156:159], v[84:87], a[124:127], v[156:159]
  v_mul_f32 v148, v148, v121
  v_mul_f32 v149, v149, v121
  v_mfma_f32_16x16x32_bf16 v[160:163], v[72:75], a[144:147], v[160:163]
  v_mul_f32 v150, v150, v121
  v_mul_f32 v151, v151, v121
  v_mfma_f32_16x16x32_bf16 v[160:163], v[76:79], a[148:151], v[160:163]
  v_cvt_pk_bf16_f32 v202, v148, v149
  v_cvt_pk_bf16_f32 v203, v150, v151
  v_mfma_f32_16x16x32_bf16 v[160:163], v[80:83], a[152:155], v[160:163]
  buffer_store_dwordx4 v[200:203], v16, s[56:59], s68 offen offset:0 sc1
  v_mfma_f32_16x16x32_bf16 v[160:163], v[84:87], a[156:159], v[160:163]
  v_mul_f32 v152, v152, v122
  v_mul_f32 v153, v153, v122
  v_mul_f32 v154, v154, v122
  v_mfma_f32_16x16x32_bf16 v[164:167], v[72:75], a[176:179], v[164:167]
  v_mul_f32 v155, v155, v122
  v_cvt_pk_bf16_f32 v204, v152, v153
  v_mfma_f32_16x16x32_bf16 v[164:167], v[76:79], a[180:183], v[164:167]
  v_cvt_pk_bf16_f32 v205, v154, v155
  v_mul_f32 v156, v156, v123
  v_mfma_f32_16x16x32_bf16 v[164:167], v[80:83], a[184:187], v[164:167]
  v_mul_f32 v157, v157, v123
  v_mul_f32 v158, v158, v123
  v_mfma_f32_16x16x32_bf16 v[164:167], v[84:87], a[188:191], v[164:167]
  v_mul_f32 v159, v159, v123
  v_cvt_pk_bf16_f32 v206, v156, v157
  v_mfma_f32_16x16x32_bf16 v[168:171], v[72:75], a[208:211], v[168:171]
  v_cvt_pk_bf16_f32 v207, v158, v159
  v_mfma_f32_16x16x32_bf16 v[168:171], v[76:79], a[212:215], v[168:171]
  buffer_store_dwordx4 v[204:207], v16, s[56:59], s68 offen offset:1024 sc1
  v_mul_f32 v160, v160, v124
  v_mul_f32 v161, v161, v124
  v_mfma_f32_16x16x32_bf16 v[168:171], v[80:83], a[216:219], v[168:171]
  v_mul_f32 v162, v162, v124
  v_mul_f32 v163, v163, v124
  v_mfma_f32_16x16x32_bf16 v[168:171], v[84:87], a[220:223], v[168:171]
  v_cvt_pk_bf16_f32 v208, v160, v161
  v_cvt_pk_bf16_f32 v209, v162, v163
  s_nop 3
  v_mul_f32 v164, v164, v125
  v_mul_f32 v165, v165, v125
  v_mul_f32 v166, v166, v125
  v_mul_f32 v167, v167, v125
  v_cvt_pk_bf16_f32 v210, v164, v165
  v_cvt_pk_bf16_f32 v211, v166, v167
  buffer_store_dwordx4 v[208:211], v16, s[56:59], s68 offen offset:2048 sc1
  v_mul_f32 v168, v168, v126
  v_mul_f32 v169, v169, v126
  v_mul_f32 v170, v170, v126
  v_mul_f32 v171, v171, v126
  v_cvt_pk_bf16_f32 v212, v168, v169
  v_cvt_pk_bf16_f32 v213, v170, v171
  buffer_store_dwordx2 v[212:213], v17, s[56:59], s68 offen offset:3072 sc1
  s_and_b32 s3, s92, 7
  s_mul_i32 s3, s3, 200704
  s_lshr_b32 s7, s92, 3
  s_mul_i32 s7, s7, 896
  s_add_u32 s3, s3, s7
  s_add_u32 s88, s28, s3
  s_addc_u32 s89, s29, 0
  s_mov_b32 s90, 199808
  s_mov_b32 s91, 0x20000
  s_lshr_b32 s11, s4, 2
  s_and_b32 s12, s4, 3
  s_mul_i32 s3, s11, 3584
  s_lshl_b32 s7, s12, 10
  s_add_u32 s3, s3, s7
  s_mul_i32 s7, s34, 14336
  s_add_u32 s13, s3, s7
  s_mul_i32 s3, s12, 57344
  s_lshl_b32 s7, s11, 5
  s_add_u32 s3, s3, s7
  s_lshl_b32 s7, s34, 7
  s_add_u32 s14, s3, s7
  s_cmp_lt_u32 s34, 3
  s_cselect_b32 s15, 57344, 0x40000000
  s_cselect_b32 s16, 512, 0x40000000
  v_and_b32 v8, 15, v1
  v_mul_u32_u24 v9, 1792, v8
  v_add_u32 v9, s14, v9
  v_lshrrev_b32 v10, 4, v1
  v_lshlrev_b32 v8, 2, v8
  v_readfirstlane_b32 s3, v5
  s_mov_b32 s63, 200000
  s_cmp_lg_u32 s3, 0
  s_cbranch_scc1 L_chkok
L_chk:
  global_load_dword v5, v4, s[30:31] sc1
  s_sub_u32 s63, s63, 1
  s_waitcnt vmcnt(0)
  v_readfirstlane_b32 s3, v5
  s_cmp_eq_u32 s63, 0
  s_cbranch_scc1 L_chkok
  s_cmp_eq_u32 s3, 0
  s_cbranch_scc1 L_chk
L_chkok:
  global_load_dword v6, v8, s[100:101] sc1
  s_waitcnt vmcnt(1)
  s_barrier
  s_cmp_lg_u32 s34, 3
  s_cbranch_scc1 L_noflag
  s_lshl_b32 s3, s4, 2
  v_mov_b32 v4, s3
  v_mov_b32 v7, 1
  s_mov_b64 exec, 1
  global_store_dword v4, v7, s[100:101] sc1
  s_mov_b64 exec, -1
  s_waitcnt vmcnt(1)
  s_branch L_flagged
L_noflag:
  s_waitcnt vmcnt(0)
L_flagged:
  s_cmp_eq_u32 s12, 3
  s_cbranch_scc1 L_half
  v_lshl_add_u32 v2, v1, 4, s13
  v_add_u32 v3, s15, v2
  v_and_b32 v11, 1, v10
  v_mul_u32_u24 v11, 28672, v11
  v_add_u32 v9, v9, v11
  v_lshrrev_b32 v11, 1, v10
  v_lshl_add_u32 v9, v11, 4, v9
  v_add_u32 v11, s16, v9
  s_mov_b32 s8, 0
  s_lshl_b32 s10, 1, s4
  s_mov_b32 s63, 200000
  v_cmp_ne_u32 vcc, 0, v6
  s_or_b32 s9, vcc_lo, s10
  s_and_b32 s9, s9, 0xffff
  s_branch L_somef
L_pollf:
  global_load_dword v6, v8, s[100:101] sc1
  s_sleep 4
  global_load_dword v7, v8, s[100:101] sc1
  s_waitcnt vmcnt(1)
  v_cmp_ne_u32 vcc, 0, v6
  s_or_b32 s9, vcc_lo, s10
  s_and_b32 s9, s9, 0xffff
  s_andn2_b32 s9, s9, s8
  s_cbranch_scc1 L_somef
  s_waitcnt vmcnt(0)
  v_cmp_ne_u32 vcc, 0, v7
  s_sub_u32 s63, s63, 1
  s_cmp_eq_u32 s63, 0
  s_cselect_b32 s10, 0xffff, s10
  s_or_b32 s9, vcc_lo, s10
  s_and_b32 s9, s9, 0xffff
  s_andn2_b32 s9, s9, s8
  s_cbranch_scc1 L_somef
  s_branch L_pollf
L_somef:
  s_and_b32 s3, s9, 0xf
  s_cbranch_scc0 L_nf3
  s_bitcmp1_b32 s9, 0
  s_cbranch_scc0 L_nf0
  s_mov_b32 s66, 0
  buffer_load_dwordx4 v[128:131], v2, s[56:59], s66 offen sc1
  buffer_load_dwordx4 v[192:195], v3, s[56:59], s66 offen sc1
L_nf0:
  s_bitcmp1_b32 s9, 1
  s_cbranch_scc0 L_nf1
  s_mov_b32 s66, 100352
  buffer_load_dwordx4 v[132:135], v2, s[56:59], s66 offen sc1
  buffer_load_dwordx4 v[196:199], v3, s[56:59], s66 offen sc1
L_nf1:
  s_bitcmp1_b32 s9, 2
  s_cbranch_scc0 L_nf2
  s_mov_b32 s66, 200704
  buffer_load_dwordx4 v[136:139], v2, s[56:59], s66 offen sc1
  buffer_load_dwordx4 v[200:203], v3, s[56:59], s66 offen sc1
L_nf2:
  s_bitcmp1_b32 s9, 3
  s_cbranch_scc0 L_nf3
  s_mov_b32 s66, 301056
  buffer_load_dwordx4 v[140:143], v2, s[56:59], s66 offen sc1
  buffer_load_dwordx4 v[204:207], v3, s[56:59], s66 offen sc1
L_nf3:
  s_and_b32 s3, s9, 0xf0
  s_cbranch_scc0 L_nf7
  s_bitcmp1_b32 s9, 4
  s_cbranch_scc0 L_nf4
  s_mov_b32 s66, 401408
  buffer_load_dwordx4 v[144:147], v2, s[56:59], s66 offen sc1
  buffer_load_dwordx4 v[208:211], v3, s[56:59], s66 offen sc1
L_nf4:
  s_bitcmp1_b32 s9, 5
  s_cbranch_scc0 L_nf5
  s_mov_b32 s66, 501760
  buffer_load_dwordx4 v[148:151], v2, s[56:59], s66 offen sc1
  buffer_load_dwordx4 v[212:215], v3, s[56:59], s66 offen sc1
L_nf5:
  s_bitcmp1_b32 s9, 6
  s_cbranch_scc0 L_nf6
  s_mov_b32 s66, 602112
  buffer_load_dwordx4 v[152:155], v2, s[56:59], s66 offen sc1
  buffer_load_dwordx4 v[216:219], v3, s[56:59], s66 offen sc1
L_nf6:
  s_bitcmp1_b32 s9, 7
  s_cbranch_scc0 L_nf7
  s_mov_b32 s66, 702464
  buffer_load_dwordx4 v[156:159], v2, s[56:59], s66 offen sc1
  buffer_load_dwordx4 v[220:223], v3, s[56:59], s66 offen sc1
L_nf7:
  s_and_b32 s3, s9, 0xf00
  s_cbranch_scc0 L_nf11
  s_bitcmp1_b32 s9, 8
  s_cbranch_scc0 L_nf8
  s_mov_b32 s66, 802816
  buffer_load_dwordx4 v[160:163], v2, s[56:59], s66 offen sc1
  buffer_load_dwordx4 v[224:227], v3, s[56:59], s66 offen sc1
L_nf8:
  s_bitcmp1_b32 s9, 9
  s_cbranch_scc0 L_nf9
  s_mov_b32 s66, 903168
  buffer_load_dwordx4 v[164:167], v2, s[56:59], s66 offen sc1
  buffer_load_dwordx4 v[228:231], v3, s[56:59], s66 offen sc1
L_nf9:
  s_bitcmp1_b32 s9, 10
  s_cbranch_scc0 L_nf10
  s_mov_b32 s66, 1003520
  buffer_load_dwordx4 v[168:171], v2, s[56:59], s66 offen sc1
  buffer_load_dwordx4 v[232:235], v3, s[56:59], s66 offen sc1
L_nf10:
  s_bitcmp1_b32 s9, 11
  s_cbranch_scc0 L_nf11
  s_mov_b32 s66, 1103872
  buffer_load_dwordx4 v[172:175], v2, s[56:59], s66 offen sc1
  buffer_load_dwordx4 v[236:239], v3, s[56:59], s66 offen sc1
L_nf11:
  s_and_b32 s3, s9, 0xf000
  s_cbranch_scc0 L_nf15
  s_bitcmp1_b32 s9, 12
  s_cbranch_scc0 L_nf12
  s_mov_b32 s66, 1204224
  buffer_load_dwordx4 v[176:179], v2, s[56:59], s66 offen sc1
  buffer_load_dwordx4 v[240:243], v3, s[56:59], s66 offen sc1
L_nf12:
  s_bitcmp1_b32 s9, 13
  s_cbranch_scc0 L_nf13
  s_mov_b32 s66, 1304576
  buffer_load_dwordx4 v[180:183], v2, s[56:59], s66 offen sc1
  buffer_load_dwordx4 v[244:247], v3, s[56:59], s66 offen sc1
L_nf13:
  s_bitcmp1_b32 s9, 14
  s_cbranch_scc0 L_nf14
  s_mov_b32 s66, 1404928
  buffer_load_dwordx4 v[184:187], v2, s[56:59], s66 offen sc1
  buffer_load_dwordx4 v[248:251], v3, s[56:59], s66 offen sc1
L_nf14:
  s_bitcmp1_b32 s9, 15
  s_cbranch_scc0 L_nf15
  s_mov_b32 s66, 1505280
  buffer_load_dwordx4 v[188:191], v2, s[56:59], s66 offen sc1
  buffer_load_dwordx4 v[252:255], v3, s[56:59], s66 offen sc1
L_nf15:
  s_or_b32 s8, s8, s9
  s_cmp_lg_u32 s8, 0xffff
  s_cbranch_scc1 L_pollf
  s_and_b32 s3, s9, 0xf
  s_cbranch_scc0 L_wf0
  s_waitcnt vmcnt(24)
  s_cmp_eq_u32 s9, 0xffff
  s_cbranch_scc1 L_wf0
  s_waitcnt vmcnt(0)
L_wf0:
  v_lshlrev_b32 v16, 16, v128
  v_and_b32 v17, 0xffff0000, v128
  v_lshlrev_b32 v18, 16, v129
  v_and_b32 v19, 0xffff0000, v129
  v_lshlrev_b32 v20, 16, v130
  v_and_b32 v21, 0xffff0000, v130
  v_lshlrev_b32 v22, 16, v131
  v_and_b32 v23, 0xffff0000, v131
  v_lshlrev_b32 v24, 16, v192
  v_and_b32 v25, 0xffff0000, v192
  v_lshlrev_b32 v26, 16, v193
  v_and_b32 v27, 0xffff0000, v193
  v_lshlrev_b32 v28, 16, v194
  v_and_b32 v29, 0xffff0000, v194
  v_lshlrev_b32 v30, 16, v195
  v_and_b32 v31, 0xffff0000, v195
  v_lshlrev_b32 v40, 16, v132
  v_and_b32 v41, 0xffff0000, v132
  v_lshlrev_b32 v42, 16, v133
  v_and_b32 v43, 0xffff0000, v133
  v_lshlrev_b32 v44, 16, v134
  v_and_b32 v45, 0xffff0000, v134
  v_lshlrev_b32 v46, 16, v135
  v_and_b32 v47, 0xffff0000, v135
  v_lshlrev_b32 v48, 16, v196
  v_and_b32 v49, 0xffff0000, v196
  v_lshlrev_b32 v50, 16, v197
  v_and_b32 v51, 0xffff0000, v197
  v_lshlrev_b32 v52, 16, v198
  v_and_b32 v53, 0xffff0000, v198
  v_lshlrev_b32 v54, 16, v199
  v_and_b32 v55, 0xffff0000, v199
  v_pk_add_f32 v[16:17], v[16:17], v[40:41]
  v_pk_add_f32 v[18:19], v[18:19], v[42:43]
  v_pk_add_f32 v[20:21], v[20:21], v[44:45]
  v_pk_add_f32 v[22:23], v[22:23], v[46:47]
  v_pk_add_f32 v[24:25], v[24:25], v[48:49]
  v_pk_add_f32 v[26:27], v[26:27], v[50:51]
  v_pk_add_f32 v[28:29], v[28:29], v[52:53]
  v_pk_add_f32 v[30:31], v[30:31], v[54:55]
  v_lshlrev_b32 v40, 16, v136
  v_and_b32 v41, 0xffff0000, v136
  v_lshlrev_b32 v42, 16, v137
  v_and_b32 v43, 0xffff0000, v137
  v_lshlrev_b32 v44, 16, v138
  v_and_b32 v45, 0xffff0000, v138
  v_lshlrev_b32 v46, 16, v139
  v_and_b32 v47, 0xffff0000, v139
  v_lshlrev_b32 v48, 16, v200
  v_and_b32 v49, 0xffff0000, v200
  v_lshlrev_b32 v50, 16, v201
  v_and_b32 v51, 0xffff0000, v201
  v_lshlrev_b32 v52, 16, v202
  v_and_b32 v53, 0xffff0000, v202
  v_lshlrev_b32 v54, 16, v203
  v_and_b32 v55, 0xffff0000, v203
  v_pk_add_f32 v[16:17], v[16:17], v[40:41]
  v_pk_add_f32 v[18:19], v[18:19], v[42:43]
  v_pk_add_f32 v[20:21], v[20:21], v[44:45]
  v_pk_add_f32 v[22:23], v[22:23], v[46:47]
  v_pk_add_f32 v[24:25], v[24:25], v[48:49]
  v_pk_add_f32 v[26:27], v[26:27], v[50:51]
  v_pk_add_f32 v[28:29], v[28:29], v[52:53]
  v_pk_add_f32 v[30:31], v[30:31], v[54:55]
  v_lshlrev_b32 v40, 16, v140
  v_and_b32 v41, 0xffff0000, v140
  v_lshlrev_b32 v42, 16, v141
  v_and_b32 v43, 0xffff0000, v141
  v_lshlrev_b32 v44, 16, v142
  v_and_b32 v45, 0xffff0000, v142
  v_lshlrev_b32 v46, 16, v143
  v_and_b32 v47, 0xffff0000, v143
  v_lshlrev_b32 v48, 16, v204
  v_and_b32 v49, 0xffff0000, v204
  v_lshlrev_b32 v50, 16, v205
  v_and_b32 v51, 0xffff0000, v205
  v_lshlrev_b32 v52, 16, v206
  v_and_b32 v53, 0xffff0000, v206
  v_lshlrev_b32 v54, 16, v207
  v_and_b32 v55, 0xffff0000, v207
  v_pk_add_f32 v[16:17], v[16:17], v[40:41]
  v_pk_add_f32 v[18:19], v[18:19], v[42:43]
  v_pk_add_f32 v[20:21], v[20:21], v[44:45]
  v_pk_add_f32 v[22:23], v[22:23], v[46:47]
  v_pk_add_f32 v[24:25], v[24:25], v[48:49]
  v_pk_add_f32 v[26:27], v[26:27], v[50:51]
  v_pk_add_f32 v[28:29], v[28:29], v[52:53]
  v_pk_add_f32 v[30:31], v[30:31], v[54:55]
  s_and_b32 s3, s9, 0xf0
  s_cbranch_scc0 L_wf4
  s_waitcnt vmcnt(16)
  s_cmp_eq_u32 s9, 0xffff
  s_cbranch_scc1 L_wf4
  s_waitcnt vmcnt(0)
L_wf4:
  v_lshlrev_b32 v40, 16, v144
  v_and_b32 v41, 0xffff0000, v144
  v_lshlrev_b32 v42, 16, v145
  v_and_b32 v43, 0xffff0000, v145
  v_lshlrev_b32 v44, 16, v146
  v_and_b32 v45, 0xffff0000, v146
  v_lshlrev_b32 v46, 16, v147
  v_and_b32 v47, 0xffff0000, v147
  v_lshlrev_b32 v48, 16, v208
  v_and_b32 v49, 0xffff0000, v208
  v_lshlrev_b32 v50, 16, v209
  v_and_b32 v51, 0xffff0000, v209
  v_lshlrev_b32 v52, 16, v210
  v_and_b32 v53, 0xffff0000, v210
  v_lshlrev_b32 v54, 16, v211
  v_and_b32 v55, 0xffff0000, v211
  v_pk_add_f32 v[16:17], v[16:17], v[40:41]
  v_pk_add_f32 v[18:19], v[18:19], v[42:43]
  v_pk_add_f32 v[20:21], v[20:21], v[44:45]
  v_pk_add_f32 v[22:23], v[22:23], v[46:47]
  v_pk_add_f32 v[24:25], v[24:25], v[48:49]
  v_pk_add_f32 v[26:27], v[26:27], v[50:51]
  v_pk_add_f32 v[28:29], v[28:29], v[52:53]
  v_pk_add_f32 v[30:31], v[30:31], v[54:55]
  v_lshlrev_b32 v40, 16, v148
  v_and_b32 v41, 0xffff0000, v148
  v_lshlrev_b32 v42, 16, v149
  v_and_b32 v43, 0xffff0000, v149
  v_lshlrev_b32 v44, 16, v150
  v_and_b32 v45, 0xffff0000, v150
  v_lshlrev_b32 v46, 16, v151
  v_and_b32 v47, 0xffff0000, v151
  v_lshlrev_b32 v48, 16, v212
  v_and_b32 v49, 0xffff0000, v212
  v_lshlrev_b32 v50, 16, v213
  v_and_b32 v51, 0xffff0000, v213
  v_lshlrev_b32 v52, 16, v214
  v_and_b32 v53, 0xffff0000, v214
  v_lshlrev_b32 v54, 16, v215
  v_and_b32 v55, 0xffff0000, v215
  v_pk_add_f32 v[16:17], v[16:17], v[40:41]
  v_pk_add_f32 v[18:19], v[18:19], v[42:43]
  v_pk_add_f32 v[20:21], v[20:21], v[44:45]
  v_pk_add_f32 v[22:23], v[22:23], v[46:47]
  v_pk_add_f32 v[24:25], v[24:25], v[48:49]
  v_pk_add_f32 v[26:27], v[26:27], v[50:51]
  v_pk_add_f32 v[28:29], v[28:29], v[52:53]
  v_pk_add_f32 v[30:31], v[30:31], v[54:55]
  v_lshlrev_b32 v40, 16, v152
  v_and_b32 v41, 0xffff0000, v152
  v_lshlrev_b32 v42, 16, v153
  v_and_b32 v43, 0xffff0000, v153
  v_lshlrev_b32 v44, 16, v154
  v_and_b32 v45, 0xffff0000, v154
  v_lshlrev_b32 v46, 16, v155
  v_and_b32 v47, 0xffff0000, v155
  v_lshlrev_b32 v48, 16, v216
  v_and_b32 v49, 0xffff0000, v216
  v_lshlrev_b32 v50, 16, v217
  v_and_b32 v51, 0xffff0000, v217
  v_lshlrev_b32 v52, 16, v218
  v_and_b32 v53, 0xffff0000, v218
  v_lshlrev_b32 v54, 16, v219
  v_and_b32 v55, 0xffff0000, v219
  v_pk_add_f32 v[16:17], v[16:17], v[40:41]
  v_pk_add_f32 v[18:19], v[18:19], v[42:43]
  v_pk_add_f32 v[20:21], v[20:21], v[44:45]
  v_pk_add_f32 v[22:23], v[22:23], v[46:47]
  v_pk_add_f32 v[24:25], v[24:25], v[48:49]
  v_pk_add_f32 v[26:27], v[26:27], v[50:51]
  v_pk_add_f32 v[28:29], v[28:29], v[52:53]
  v_pk_add_f32 v[30:31], v[30:31], v[54:55]
  v_lshlrev_b32 v40, 16, v156
  v_and_b32 v41, 0xffff0000, v156
  v_lshlrev_b32 v42, 16, v157
  v_and_b32 v43, 0xffff0000, v157
  v_lshlrev_b32 v44, 16, v158
  v_and_b32 v45, 0xffff0000, v158
  v_lshlrev_b32 v46, 16, v159
  v_and_b32 v47, 0xffff0000, v159
  v_lshlrev_b32 v48, 16, v220
  v_and_b32 v49, 0xffff0000, v220
  v_lshlrev_b32 v50, 16, v221
  v_and_b32 v51, 0xffff0000, v221
  v_lshlrev_b32 v52, 16, v222
  v_and_b32 v53, 0xffff0000, v222
  v_lshlrev_b32 v54, 16, v223
  v_and_b32 v55, 0xffff0000, v223
  v_pk_add_f32 v[16:17], v[16:17], v[40:41]
  v_pk_add_f32 v[18:19], v[18:19], v[42:43]
  v_pk_add_f32 v[20:21], v[20:21], v[44:45]
  v_pk_add_f32 v[22:23], v[22:23], v[46:47]
  v_pk_add_f32 v[24:25], v[24:25], v[48:49]
  v_pk_add_f32 v[26:27], v[26:27], v[50:51]
  v_pk_add_f32 v[28:29], v[28:29], v[52:53]
  v_pk_add_f32 v[30:31], v[30:31], v[54:55]
  s_and_b32 s3, s9, 0xf00
  s_cbranch_scc0 L_wf8
  s_waitcnt vmcnt(8)
  s_cmp_eq_u32 s9, 0xffff
  s_cbranch_scc1 L_wf8
  s_waitcnt vmcnt(0)
L_wf8:
  v_lshlrev_b32 v40, 16, v160
  v_and_b32 v41, 0xffff0000, v160
  v_lshlrev_b32 v42, 16, v161
  v_and_b32 v43, 0xffff0000, v161
  v_lshlrev_b32 v44, 16, v162
  v_and_b32 v45, 0xffff0000, v162
  v_lshlrev_b32 v46, 16, v163
  v_and_b32 v47, 0xffff0000, v163
  v_lshlrev_b32 v48, 16, v224
  v_and_b32 v49, 0xffff0000, v224
  v_lshlrev_b32 v50, 16, v225
  v_and_b32 v51, 0xffff0000, v225
  v_lshlrev_b32 v52, 16, v226
  v_and_b32 v53, 0xffff0000, v226
  v_lshlrev_b32 v54, 16, v227
  v_and_b32 v55, 0xffff0000, v227
  v_pk_add_f32 v[16:17], v[16:17], v[40:41]
  v_pk_add_f32 v[18:19], v[18:19], v[42:43]
  v_pk_add_f32 v[20:21], v[20:21], v[44:45]
  v_pk_add_f32 v[22:23], v[22:23], v[46:47]
  v_pk_add_f32 v[24:25], v[24:25], v[48:49]
  v_pk_add_f32 v[26:27], v[26:27], v[50:51]
  v_pk_add_f32 v[28:29], v[28:29], v[52:53]
  v_pk_add_f32 v[30:31], v[30:31], v[54:55]
  v_lshlrev_b32 v40, 16, v164
  v_and_b32 v41, 0xffff0000, v164
  v_lshlrev_b32 v42, 16, v165
  v_and_b32 v43, 0xffff0000, v165
  v_lshlrev_b32 v44, 16, v166
  v_and_b32 v45, 0xffff0000, v166
  v_lshlrev_b32 v46, 16, v167
  v_and_b32 v47, 0xffff0000, v167
  v_lshlrev_b32 v48, 16, v228
  v_and_b32 v49, 0xffff0000, v228
  v_lshlrev_b32 v50, 16, v229
  v_and_b32 v51, 0xffff0000, v229
  v_lshlrev_b32 v52, 16, v230
  v_and_b32 v53, 0xffff0000, v230
  v_lshlrev_b32 v54, 16, v231
  v_and_b32 v55, 0xffff0000, v231
  v_pk_add_f32 v[16:17], v[16:17], v[40:41]
  v_pk_add_f32 v[18:19], v[18:19], v[42:43]
  v_pk_add_f32 v[20:21], v[20:21], v[44:45]
  v_pk_add_f32 v[22:23], v[22:23], v[46:47]
  v_pk_add_f32 v[24:25], v[24:25], v[48:49]
  v_pk_add_f32 v[26:27], v[26:27], v[50:51]
  v_pk_add_f32 v[28:29], v[28:29], v[52:53]
  v_pk_add_f32 v[30:31], v[30:31], v[54:55]
  v_lshlrev_b32 v40, 16, v168
  v_and_b32 v41, 0xffff0000, v168
  v_lshlrev_b32 v42, 16, v169
  v_and_b32 v43, 0xffff0000, v169
  v_lshlrev_b32 v44, 16, v170
  v_and_b32 v45, 0xffff0000, v170
  v_lshlrev_b32 v46, 16, v171
  v_and_b32 v47, 0xffff0000, v171
  v_lshlrev_b32 v48, 16, v232
  v_and_b32 v49, 0xffff0000, v232
  v_lshlrev_b32 v50, 16, v233
  v_and_b32 v51, 0xffff0000, v233
  v_lshlrev_b32 v52, 16, v234
  v_and_b32 v53, 0xffff0000, v234
  v_lshlrev_b32 v54, 16, v235
  v_and_b32 v55, 0xffff0000, v235
  v_pk_add_f32 v[16:17], v[16:17], v[40:41]
  v_pk_add_f32 v[18:19], v[18:19], v[42:43]
  v_pk_add_f32 v[20:21], v[20:21], v[44:45]
  v_pk_add_f32 v[22:23], v[22:23], v[46:47]
  v_pk_add_f32 v[24:25], v[24:25], v[48:49]
  v_pk_add_f32 v[26:27], v[26:27], v[50:51]
  v_pk_add_f32 v[28:29], v[28:29], v[52:53]
  v_pk_add_f32 v[30:31], v[30:31], v[54:55]
  v_lshlrev_b32 v40, 16, v172
  v_and_b32 v41, 0xffff0000, v172
  v_lshlrev_b32 v42, 16, v173
  v_and_b32 v43, 0xffff0000, v173
  v_lshlrev_b32 v44, 16, v174
  v_and_b32 v45, 0xffff0000, v174
  v_lshlrev_b32 v46, 16, v175
  v_and_b32 v47, 0xffff0000, v175
  v_lshlrev_b32 v48, 16, v236
  v_and_b32 v49, 0xffff0000, v236
  v_lshlrev_b32 v50, 16, v237
  v_and_b32 v51, 0xffff0000, v237
  v_lshlrev_b32 v52, 16, v238
  v_and_b32 v53, 0xffff0000, v238
  v_lshlrev_b32 v54, 16, v239
  v_and_b32 v55, 0xffff0000, v239
  v_pk_add_f32 v[16:17], v[16:17], v[40:41]
  v_pk_add_f32 v[18:19], v[18:19], v[42:43]
  v_pk_add_f32 v[20:21], v[20:21], v[44:45]
  v_pk_add_f32 v[22:23], v[22:23], v[46:47]
  v_pk_add_f32 v[24:25], v[24:25], v[48:49]
  v_pk_add_f32 v[26:27], v[26:27], v[50:51]
  v_pk_add_f32 v[28:29], v[28:29], v[52:53]
  v_pk_add_f32 v[30:31], v[30:31], v[54:55]
  s_and_b32 s3, s9, 0xf000
  s_cbranch_scc0 L_wf12
  s_waitcnt vmcnt(0)
L_wf12:
  v_lshlrev_b32 v40, 16, v176
  v_and_b32 v41, 0xffff0000, v176
  v_lshlrev_b32 v42, 16, v177
  v_and_b32 v43, 0xffff0000, v177
  v_lshlrev_b32 v44, 16, v178
  v_and_b32 v45, 0xffff0000, v178
  v_lshlrev_b32 v46, 16, v179
  v_and_b32 v47, 0xffff0000, v179
  v_lshlrev_b32 v48, 16, v240
  v_and_b32 v49, 0xffff0000, v240
  v_lshlrev_b32 v50, 16, v241
  v_and_b32 v51, 0xffff0000, v241
  v_lshlrev_b32 v52, 16, v242
  v_and_b32 v53, 0xffff0000, v242
  v_lshlrev_b32 v54, 16, v243
  v_and_b32 v55, 0xffff0000, v243
  v_pk_add_f32 v[16:17], v[16:17], v[40:41]
  v_pk_add_f32 v[18:19], v[18:19], v[42:43]
  v_pk_add_f32 v[20:21], v[20:21], v[44:45]
  v_pk_add_f32 v[22:23], v[22:23], v[46:47]
  v_pk_add_f32 v[24:25], v[24:25], v[48:49]
  v_pk_add_f32 v[26:27], v[26:27], v[50:51]
  v_pk_add_f32 v[28:29], v[28:29], v[52:53]
  v_pk_add_f32 v[30:31], v[30:31], v[54:55]
  v_lshlrev_b32 v40, 16, v180
  v_and_b32 v41, 0xffff0000, v180
  v_lshlrev_b32 v42, 16, v181
  v_and_b32 v43, 0xffff0000, v181
  v_lshlrev_b32 v44, 16, v182
  v_and_b32 v45, 0xffff0000, v182
  v_lshlrev_b32 v46, 16, v183
  v_and_b32 v47, 0xffff0000, v183
  v_lshlrev_b32 v48, 16, v244
  v_and_b32 v49, 0xffff0000, v244
  v_lshlrev_b32 v50, 16, v245
  v_and_b32 v51, 0xffff0000, v245
  v_lshlrev_b32 v52, 16, v246
  v_and_b32 v53, 0xffff0000, v246
  v_lshlrev_b32 v54, 16, v247
  v_and_b32 v55, 0xffff0000, v247
  v_pk_add_f32 v[16:17], v[16:17], v[40:41]
  v_pk_add_f32 v[18:19], v[18:19], v[42:43]
  v_pk_add_f32 v[20:21], v[20:21], v[44:45]
  v_pk_add_f32 v[22:23], v[22:23], v[46:47]
  v_pk_add_f32 v[24:25], v[24:25], v[48:49]
  v_pk_add_f32 v[26:27], v[26:27], v[50:51]
  v_pk_add_f32 v[28:29], v[28:29], v[52:53]
  v_pk_add_f32 v[30:31], v[30:31], v[54:55]
  v_lshlrev_b32 v40, 16, v184
  v_and_b32 v41, 0xffff0000, v184
  v_lshlrev_b32 v42, 16, v185
  v_and_b32 v43, 0xffff0000, v185
  v_lshlrev_b32 v44, 16, v186
  v_and_b32 v45, 0xffff0000, v186
  v_lshlrev_b32 v46, 16, v187
  v_and_b32 v47, 0xffff0000, v187
  v_lshlrev_b32 v48, 16, v248
  v_and_b32 v49, 0xffff0000, v248
  v_lshlrev_b32 v50, 16, v249
  v_and_b32 v51, 0xffff0000, v249
  v_lshlrev_b32 v52, 16, v250
  v_and_b32 v53, 0xffff0000, v250
  v_lshlrev_b32 v54, 16, v251
  v_and_b32 v55, 0xffff0000, v251
  v_pk_add_f32 v[16:17], v[16:17], v[40:41]
  v_pk_add_f32 v[18:19], v[18:19], v[42:43]
  v_pk_add_f32 v[20:21], v[20:21], v[44:45]
  v_pk_add_f32 v[22:23], v[22:23], v[46:47]
  v_pk_add_f32 v[24:25], v[24:25], v[48:49]
  v_pk_add_f32 v[26:27], v[26:27], v[50:51]
  v_pk_add_f32 v[28:29], v[28:29], v[52:53]
  v_pk_add_f32 v[30:31], v[30:31], v[54:55]
  v_lshlrev_b32 v40, 16, v188
  v_and_b32 v41, 0xffff0000, v188
  v_lshlrev_b32 v42, 16, v189
  v_and_b32 v43, 0xffff0000, v189
  v_lshlrev_b32 v44, 16, v190
  v_and_b32 v45, 0xffff0000, v190
  v_lshlrev_b32 v46, 16, v191
  v_and_b32 v47, 0xffff0000, v191
  v_lshlrev_b32 v48, 16, v252
  v_and_b32 v49, 0xffff0000, v252
  v_lshlrev_b32 v50, 16, v253
  v_and_b32 v51, 0xffff0000, v253
  v_lshlrev_b32 v52, 16, v254
  v_and_b32 v53, 0xffff0000, v254
  v_lshlrev_b32 v54, 16, v255
  v_and_b32 v55, 0xffff0000, v255
  v_pk_add_f32 v[16:17], v[16:17], v[40:41]
  v_pk_add_f32 v[18:19], v[18:19], v[42:43]
  v_pk_add_f32 v[20:21], v[20:21], v[44:45]
  v_pk_add_f32 v[22:23], v[22:23], v[46:47]
  v_pk_add_f32 v[24:25], v[24:25], v[48:49]
  v_pk_add_f32 v[26:27], v[26:27], v[50:51]
  v_pk_add_f32 v[28:29], v[28:29], v[52:53]
  v_pk_add_f32 v[30:31], v[30:31], v[54:55]
  v_cvt_pk_bf16_f32 v32, v16, v17
  v_cvt_pk_bf16_f32 v33, v18, v19
  v_cvt_pk_bf16_f32 v34, v20, v21
  v_cvt_pk_bf16_f32 v35, v22, v23
  s_nop 1
  v_permlane16_swap_b32 v32, v34
  v_permlane16_swap_b32 v33, v35
  buffer_store_dwordx4 v[32:35], v9, s[88:91], 0 offen sc1
  v_cvt_pk_bf16_f32 v36, v24, v25
  v_cvt_pk_bf16_f32 v37, v26, v27
  v_cvt_pk_bf16_f32 v38, v28, v29
  v_cvt_pk_bf16_f32 v39, v30, v31
  s_nop 1
  v_permlane16_swap_b32 v36, v38
  v_permlane16_swap_b32 v37, v39
  buffer_store_dwordx4 v[36:39], v11, s[88:91], 0 offen sc1
  s_branch L_done
L_half:
  v_lshl_add_u32 v2, v1, 3, s13
  v_add_u32 v3, s15, v2
  v_lshl_add_u32 v9, v10, 3, v9
  v_add_u32 v11, s16, v9
  s_mov_b32 s8, 0
  s_lshl_b32 s10, 1, s4
  s_mov_b32 s63, 200000
  v_cmp_ne_u32 vcc, 0, v6
  s_or_b32 s9, vcc_lo, s10
  s_and_b32 s9, s9, 0xffff
  s_branch L_someh
L_pollh:
  global_load_dword v6, v8, s[100:101] sc1
  s_sleep 4
  global_load_dword v7, v8, s[100:101] sc1
  s_waitcnt vmcnt(1)
  v_cmp_ne_u32 vcc, 0, v6
  s_or_b32 s9, vcc_lo, s10
  s_and_b32 s9, s9, 0xffff
  s_andn2_b32 s9, s9, s8
  s_cbranch_scc1 L_someh
  s_waitcnt vmcnt(0)
  v_cmp_ne_u32 vcc, 0, v7
  s_sub_u32 s63, s63, 1
  s_cmp_eq_u32 s63, 0
  s_cselect_b32 s10, 0xffff, s10
  s_or_b32 s9, vcc_lo, s10
  s_and_b32 s9, s9, 0xffff
  s_andn2_b32 s9, s9, s8
  s_cbranch_scc1 L_someh
  s_branch L_pollh
L_someh:
  s_and_b32 s3, s9, 0xf
  s_cbranch_scc0 L_nh3
  s_bitcmp1_b32 s9, 0
  s_cbranch_scc0 L_nh0
  s_mov_b32 s66, 0
  buffer_load_dwordx2 v[128:129], v2, s[56:59], s66 offen sc1
  buffer_load_dwordx2 v[192:193], v3, s[56:59], s66 offen sc1
L_nh0:
  s_bitcmp1_b32 s9, 1
  s_cbranch_scc0 L_nh1
  s_mov_b32 s66, 100352
  buffer_load_dwordx2 v[130:131], v2, s[56:59], s66 offen sc1
  buffer_load_dwordx2 v[194:195], v3, s[56:59], s66 offen sc1
L_nh1:
  s_bitcmp1_b32 s9, 2
  s_cbranch_scc0 L_nh2
  s_mov_b32 s66, 200704
  buffer_load_dwordx2 v[132:133], v2, s[56:59], s66 offen sc1
  buffer_load_dwordx2 v[196:197], v3, s[56:59], s66 offen sc1
L_nh2:
  s_bitcmp1_b32 s9, 3
  s_cbranch_scc0 L_nh3
  s_mov_b32 s66, 301056
  buffer_load_dwordx2 v[134:135], v2, s[56:59], s66 offen sc1
  buffer_load_dwordx2 v[198:199], v3, s[56:59], s66 offen sc1
L_nh3:
  s_and_b32 s3, s9, 0xf0
  s_cbranch_scc0 L_nh7
  s_bitcmp1_b32 s9, 4
  s_cbranch_scc0 L_nh4
  s_mov_b32 s66, 401408
  buffer_load_dwordx2 v[136:137], v2, s[56:59], s66 offen sc1
  buffer_load_dwordx2 v[200:201], v3, s[56:59], s66 offen sc1
L_nh4:
  s_bitcmp1_b32 s9, 5
  s_cbranch_scc0 L_nh5
  s_mov_b32 s66, 501760
  buffer_load_dwordx2 v[138:139], v2, s[56:59], s66 offen sc1
  buffer_load_dwordx2 v[202:203], v3, s[56:59], s66 offen sc1
L_nh5:
  s_bitcmp1_b32 s9, 6
  s_cbranch_scc0 L_nh6
  s_mov_b32 s66, 602112
  buffer_load_dwordx2 v[140:141], v2, s[56:59], s66 offen sc1
  buffer_load_dwordx2 v[204:205], v3, s[56:59], s66 offen sc1
L_nh6:
  s_bitcmp1_b32 s9, 7
  s_cbranch_scc0 L_nh7
  s_mov_b32 s66, 702464
  buffer_load_dwordx2 v[142:143], v2, s[56:59], s66 offen sc1
  buffer_load_dwordx2 v[206:207], v3, s[56:59], s66 offen sc1
L_nh7:
  s_and_b32 s3, s9, 0xf00
  s_cbranch_scc0 L_nh11
  s_bitcmp1_b32 s9, 8
  s_cbranch_scc0 L_nh8
  s_mov_b32 s66, 802816
  buffer_load_dwordx2 v[144:145], v2, s[56:59], s66 offen sc1
  buffer_load_dwordx2 v[208:209], v3, s[56:59], s66 offen sc1
L_nh8:
  s_bitcmp1_b32 s9, 9
  s_cbranch_scc0 L_nh9
  s_mov_b32 s66, 903168
  buffer_load_dwordx2 v[146:147], v2, s[56:59], s66 offen sc1
  buffer_load_dwordx2 v[210:211], v3, s[56:59], s66 offen sc1
L_nh9:
  s_bitcmp1_b32 s9, 10
  s_cbranch_scc0 L_nh10
  s_mov_b32 s66, 1003520
  buffer_load_dwordx2 v[148:149], v2, s[56:59], s66 offen sc1
  buffer_load_dwordx2 v[212:213], v3, s[56:59], s66 offen sc1
L_nh10:
  s_bitcmp1_b32 s9, 11
  s_cbranch_scc0 L_nh11
  s_mov_b32 s66, 1103872
  buffer_load_dwordx2 v[150:151], v2, s[56:59], s66 offen sc1
  buffer_load_dwordx2 v[214:215], v3, s[56:59], s66 offen sc1
L_nh11:
  s_and_b32 s3, s9, 0xf000
  s_cbranch_scc0 L_nh15
  s_bitcmp1_b32 s9, 12
  s_cbranch_scc0 L_nh12
  s_mov_b32 s66, 1204224
  buffer_load_dwordx2 v[152:153], v2, s[56:59], s66 offen sc1
  buffer_load_dwordx2 v[216:217], v3, s[56:59], s66 offen sc1
L_nh12:
  s_bitcmp1_b32 s9, 13
  s_cbranch_scc0 L_nh13
  s_mov_b32 s66, 1304576
  buffer_load_dwordx2 v[154:155], v2, s[56:59], s66 offen sc1
  buffer_load_dwordx2 v[218:219], v3, s[56:59], s66 offen sc1
L_nh13:
  s_bitcmp1_b32 s9, 14
  s_cbranch_scc0 L_nh14
  s_mov_b32 s66, 1404928
  buffer_load_dwordx2 v[156:157], v2, s[56:59], s66 offen sc1
  buffer_load_dwordx2 v[220:221], v3, s[56:59], s66 offen sc1
L_nh14:
  s_bitcmp1_b32 s9, 15
  s_cbranch_scc0 L_nh15
  s_mov_b32 s66, 1505280
  buffer_load_dwordx2 v[158:159], v2, s[56:59], s66 offen sc1
  buffer_load_dwordx2 v[222:223], v3, s[56:59], s66 offen sc1
L_nh15:
  s_or_b32 s8, s8, s9
  s_cmp_lg_u32 s8, 0xffff
  s_cbranch_scc1 L_pollh
  s_and_b32 s3, s9, 0xf
  s_cbranch_scc0 L_wh0
  s_waitcnt vmcnt(24)
  s_cmp_eq_u32 s9, 0xffff
  s_cbranch_scc1 L_wh0
  s_waitcnt vmcnt(0)
L_wh0:
  v_lshlrev_b32 v16, 16, v128
  v_and_b32 v17, 0xffff0000, v128
  v_lshlrev_b32 v18, 16, v129
  v_and_b32 v19, 0xffff0000, v129
  v_lshlrev_b32 v24, 16, v192
  v_and_b32 v25, 0xffff0000, v192
  v_lshlrev_b32 v26, 16, v193
  v_and_b32 v27, 0xffff0000, v193
  v_lshlrev_b32 v40, 16, v130
  v_and_b32 v41, 0xffff0000, v130
  v_lshlrev_b32 v42, 16, v131
  v_and_b32 v43, 0xffff0000, v131
  v_lshlrev_b32 v48, 16, v194
  v_and_b32 v49, 0xffff0000, v194
  v_lshlrev_b32 v50, 16, v195
  v_and_b32 v51, 0xffff0000, v195
  v_pk_add_f32 v[16:17], v[16:17], v[40:41]
  v_pk_add_f32 v[18:19], v[18:19], v[42:43]
  v_pk_add_f32 v[24:25], v[24:25], v[48:49]
  v_pk_add_f32 v[26:27], v[26:27], v[50:51]
  v_lshlrev_b32 v40, 16, v132
  v_and_b32 v41, 0xffff0000, v132
  v_lshlrev_b32 v42, 16, v133
  v_and_b32 v43, 0xffff0000, v133
  v_lshlrev_b32 v48, 16, v196
  v_and_b32 v49, 0xffff0000, v196
  v_lshlrev_b32 v50, 16, v197
  v_and_b32 v51, 0xffff0000, v197
  v_pk_add_f32 v[16:17], v[16:17], v[40:41]
  v_pk_add_f32 v[18:19], v[18:19], v[42:43]
  v_pk_add_f32 v[24:25], v[24:25], v[48:49]
  v_pk_add_f32 v[26:27], v[26:27], v[50:51]
  v_lshlrev_b32 v40, 16, v134
  v_and_b32 v41, 0xffff0000, v134
  v_lshlrev_b32 v42, 16, v135
  v_and_b32 v43, 0xffff0000, v135
  v_lshlrev_b32 v48, 16, v198
  v_and_b32 v49, 0xffff0000, v198
  v_lshlrev_b32 v50, 16, v199
  v_and_b32 v51, 0xffff0000, v199
  v_pk_add_f32 v[16:17], v[16:17], v[40:41]
  v_pk_add_f32 v[18:19], v[18:19], v[42:43]
  v_pk_add_f32 v[24:25], v[24:25], v[48:49]
  v_pk_add_f32 v[26:27], v[26:27], v[50:51]
  s_and_b32 s3, s9, 0xf0
  s_cbranch_scc0 L_wh4
  s_waitcnt vmcnt(16)
  s_cmp_eq_u32 s9, 0xffff
  s_cbranch_scc1 L_wh4
  s_waitcnt vmcnt(0)
L_wh4:
  v_lshlrev_b32 v40, 16, v136
  v_and_b32 v41, 0xffff0000, v136
  v_lshlrev_b32 v42, 16, v137
  v_and_b32 v43, 0xffff0000, v137
  v_lshlrev_b32 v48, 16, v200
  v_and_b32 v49, 0xffff0000, v200
  v_lshlrev_b32 v50, 16, v201
  v_and_b32 v51, 0xffff0000, v201
  v_pk_add_f32 v[16:17], v[16:17], v[40:41]
  v_pk_add_f32 v[18:19], v[18:19], v[42:43]
  v_pk_add_f32 v[24:25], v[24:25], v[48:49]
  v_pk_add_f32 v[26:27], v[26:27], v[50:51]
  v_lshlrev_b32 v40, 16, v138
  v_and_b32 v41, 0xffff0000, v138
  v_lshlrev_b32 v42, 16, v139
  v_and_b32 v43, 0xffff0000, v139
  v_lshlrev_b32 v48, 16, v202
  v_and_b32 v49, 0xffff0000, v202
  v_lshlrev_b32 v50, 16, v203
  v_and_b32 v51, 0xffff0000, v203
  v_pk_add_f32 v[16:17], v[16:17], v[40:41]
  v_pk_add_f32 v[18:19], v[18:19], v[42:43]
  v_pk_add_f32 v[24:25], v[24:25], v[48:49]
  v_pk_add_f32 v[26:27], v[26:27], v[50:51]
  v_lshlrev_b32 v40, 16, v140
  v_and_b32 v41, 0xffff0000, v140
  v_lshlrev_b32 v42, 16, v141
  v_and_b32 v43, 0xffff0000, v141
  v_lshlrev_b32 v48, 16, v204
  v_and_b32 v49, 0xffff0000, v204
  v_lshlrev_b32 v50, 16, v205
  v_and_b32 v51, 0xffff0000, v205
  v_pk_add_f32 v[16:17], v[16:17], v[40:41]
  v_pk_add_f32 v[18:19], v[18:19], v[42:43]
  v_pk_add_f32 v[24:25], v[24:25], v[48:49]
  v_pk_add_f32 v[26:27], v[26:27], v[50:51]
  v_lshlrev_b32 v40, 16, v142
  v_and_b32 v41, 0xffff0000, v142
  v_lshlrev_b32 v42, 16, v143
  v_and_b32 v43, 0xffff0000, v143
  v_lshlrev_b32 v48, 16, v206
  v_and_b32 v49, 0xffff0000, v206
  v_lshlrev_b32 v50, 16, v207
  v_and_b32 v51, 0xffff0000, v207
  v_pk_add_f32 v[16:17], v[16:17], v[40:41]
  v_pk_add_f32 v[18:19], v[18:19], v[42:43]
  v_pk_add_f32 v[24:25], v[24:25], v[48:49]
  v_pk_add_f32 v[26:27], v[26:27], v[50:51]
  s_and_b32 s3, s9, 0xf00
  s_cbranch_scc0 L_wh8
  s_waitcnt vmcnt(8)
  s_cmp_eq_u32 s9, 0xffff
  s_cbranch_scc1 L_wh8
  s_waitcnt vmcnt(0)
L_wh8:
  v_lshlrev_b32 v40, 16, v144
  v_and_b32 v41, 0xffff0000, v144
  v_lshlrev_b32 v42, 16, v145
  v_and_b32 v43, 0xffff0000, v145
  v_lshlrev_b32 v48, 16, v208
  v_and_b32 v49, 0xffff0000, v208
  v_lshlrev_b32 v50, 16, v209
  v_and_b32 v51, 0xffff0000, v209
  v_pk_add_f32 v[16:17], v[16:17], v[40:41]
  v_pk_add_f32 v[18:19], v[18:19], v[42:43]
  v_pk_add_f32 v[24:25], v[24:25], v[48:49]
  v_pk_add_f32 v[26:27], v[26:27], v[50:51]
  v_lshlrev_b32 v40, 16, v146
  v_and_b32 v41, 0xffff0000, v146
  v_lshlrev_b32 v42, 16, v147
  v_and_b32 v43, 0xffff0000, v147
  v_lshlrev_b32 v48, 16, v210
  v_and_b32 v49, 0xffff0000, v210
  v_lshlrev_b32 v50, 16, v211
  v_and_b32 v51, 0xffff0000, v211
  v_pk_add_f32 v[16:17], v[16:17], v[40:41]
  v_pk_add_f32 v[18:19], v[18:19], v[42:43]
  v_pk_add_f32 v[24:25], v[24:25], v[48:49]
  v_pk_add_f32 v[26:27], v[26:27], v[50:51]
  v_lshlrev_b32 v40, 16, v148
  v_and_b32 v41, 0xffff0000, v148
  v_lshlrev_b32 v42, 16, v149
  v_and_b32 v43, 0xffff0000, v149
  v_lshlrev_b32 v48, 16, v212
  v_and_b32 v49, 0xffff0000, v212
  v_lshlrev_b32 v50, 16, v213
  v_and_b32 v51, 0xffff0000, v213
  v_pk_add_f32 v[16:17], v[16:17], v[40:41]
  v_pk_add_f32 v[18:19], v[18:19], v[42:43]
  v_pk_add_f32 v[24:25], v[24:25], v[48:49]
  v_pk_add_f32 v[26:27], v[26:27], v[50:51]
  v_lshlrev_b32 v40, 16, v150
  v_and_b32 v41, 0xffff0000, v150
  v_lshlrev_b32 v42, 16, v151
  v_and_b32 v43, 0xffff0000, v151
  v_lshlrev_b32 v48, 16, v214
  v_and_b32 v49, 0xffff0000, v214
  v_lshlrev_b32 v50, 16, v215
  v_and_b32 v51, 0xffff0000, v215
  v_pk_add_f32 v[16:17], v[16:17], v[40:41]
  v_pk_add_f32 v[18:19], v[18:19], v[42:43]
  v_pk_add_f32 v[24:25], v[24:25], v[48:49]
  v_pk_add_f32 v[26:27], v[26:27], v[50:51]
  s_and_b32 s3, s9, 0xf000
  s_cbranch_scc0 L_wh12
  s_waitcnt vmcnt(0)
L_wh12:
  v_lshlrev_b32 v40, 16, v152
  v_and_b32 v41, 0xffff0000, v152
  v_lshlrev_b32 v42, 16, v153
  v_and_b32 v43, 0xffff0000, v153
  v_lshlrev_b32 v48, 16, v216
  v_and_b32 v49, 0xffff0000, v216
  v_lshlrev_b32 v50, 16, v217
  v_and_b32 v51, 0xffff0000, v217
  v_pk_add_f32 v[16:17], v[16:17], v[40:41]
  v_pk_add_f32 v[18:19], v[18:19], v[42:43]
  v_pk_add_f32 v[24:25], v[24:25], v[48:49]
  v_pk_add_f32 v[26:27], v[26:27], v[50:51]
  v_lshlrev_b32 v40, 16, v154
  v_and_b32 v41, 0xffff0000, v154
  v_lshlrev_b32 v42, 16, v155
  v_and_b32 v43, 0xffff0000, v155
  v_lshlrev_b32 v48, 16, v218
  v_and_b32 v49, 0xffff0000, v218
  v_lshlrev_b32 v50, 16, v219
  v_and_b32 v51, 0xffff0000, v219
  v_pk_add_f32 v[16:17], v[16:17], v[40:41]
  v_pk_add_f32 v[18:19], v[18:19], v[42:43]
  v_pk_add_f32 v[24:25], v[24:25], v[48:49]
  v_pk_add_f32 v[26:27], v[26:27], v[50:51]
  v_lshlrev_b32 v40, 16, v156
  v_and_b32 v41, 0xffff0000, v156
  v_lshlrev_b32 v42, 16, v157
  v_and_b32 v43, 0xffff0000, v157
  v_lshlrev_b32 v48, 16, v220
  v_and_b32 v49, 0xffff0000, v220
  v_lshlrev_b32 v50, 16, v221
  v_and_b32 v51, 0xffff0000, v221
  v_pk_add_f32 v[16:17], v[16:17], v[40:41]
  v_pk_add_f32 v[18:19], v[18:19], v[42:43]
  v_pk_add_f32 v[24:25], v[24:25], v[48:49]
  v_pk_add_f32 v[26:27], v[26:27], v[50:51]
  v_lshlrev_b32 v40, 16, v158
  v_and_b32 v41, 0xffff0000, v158
  v_lshlrev_b32 v42, 16, v159
  v_and_b32 v43, 0xffff0000, v159
  v_lshlrev_b32 v48, 16, v222
  v_and_b32 v49, 0xffff0000, v222
  v_lshlrev_b32 v50, 16, v223
  v_and_b32 v51, 0xffff0000, v223
  v_pk_add_f32 v[16:17], v[16:17], v[40:41]
  v_pk_add_f32 v[18:19], v[18:19], v[42:43]
  v_pk_add_f32 v[24:25], v[24:25], v[48:49]
  v_pk_add_f32 v[26:27], v[26:27], v[50:51]
  v_cvt_pk_bf16_f32 v32, v16, v17
  v_cvt_pk_bf16_f32 v33, v18, v19
  buffer_store_dwordx2 v[32:33], v9, s[88:91], 0 offen sc1
  v_cvt_pk_bf16_f32 v36, v24, v25
  v_cvt_pk_bf16_f32 v37, v26, v27
  buffer_store_dwordx2 v[36:37], v11, s[88:91], 0 offen sc1
L_done:
L_end:
  s_endpgm
L_restart:
  s_waitcnt vmcnt(0) lgkmcnt(0)
  s_barrier
  s_mov_b32 s70, 1
  v_mbcnt_lo_u32_b32 v1, -1, 0
  v_mbcnt_hi_u32_b32 v1, -1, v1
  v_mov_b32 v2, s34
  s_branch L_top
L_safe:
  s_barrier
  ds_read_b128 a[0:3], v48 offset:24576
  ds_read_b128 a[4:7], v48 offset:25600
  ds_read_b128 a[8:11], v48 offset:57344
  ds_read_b128 a[12:15], v48 offset:58368
  ds_read_b128 a[16:19], v49 offset:24576
  ds_read_b128 a[20:23], v49 offset:25600
  ds_read_b128 a[24:27], v49 offset:57344
  ds_read_b128 a[28:31], v49 offset:58368
  ds_read_b128 a[32:35], v48 offset:26624
  ds_read_b128 a[36:39], v48 offset:27648
  ds_read_b128 a[40:43], v48 offset:59392
  ds_read_b128 a[44:47], v48 offset:60416
  ds_read_b128 a[48:51], v49 offset:26624
  ds_read_b128 a[52:55], v49 offset:27648
  ds_read_b128 a[56:59], v49 offset:59392
  ds_read_b128 a[60:63], v49 offset:60416
  ds_read_b128 a[64:67], v48 offset:28672
  ds_read_b128 a[68:71], v48 offset:29696
  ds_read_b128 a[72:75], v48 offset:61440
  ds_read_b128 a[76:79], v48 offset:62464
  ds_read_b128 a[80:83], v49 offset:28672
  ds_read_b128 a[84:87], v49 offset:29696
  ds_read_b128 a[88:91], v49 offset:61440
  ds_read_b128 a[92:95], v49 offset:62464
  ds_read_b128 a[96:99], v48 offset:30720
  ds_read_b128 a[100:103], v48 offset:31744
  ds_read_b128 a[104:107], v48 offset:63488
  ds_read_b128 a[108:111], v48 offset:64512
  ds_read_b128 a[112:115], v49 offset:30720
  ds_read_b128 a[116:119], v49 offset:31744
  ds_read_b128 a[120:123], v49 offset:63488
  ds_read_b128 a[124:127], v49 offset:64512
  ds_read_b128 a[128:131], v50 offset:0
  ds_read_b128 a[132:135], v50 offset:1024
  ds_read_b128 a[136:139], v50 offset:6144
  ds_read_b128 a[140:143], v50 offset:7168
  ds_read_b128 a[144:147], v50 offset:12288
  ds_read_b128 a[148:151], v50 offset:13312
  ds_read_b128 a[152:155], v50 offset:18432
  ds_read_b128 a[156:159], v50 offset:19456
  ds_read_b128 a[160:163], v50 offset:2048
  ds_read_b128 a[164:167], v50 offset:3072
  ds_read_b128 a[168:171], v50 offset:8192
  ds_read_b128 a[172:175], v50 offset:9216
  ds_read_b128 a[176:179], v50 offset:14336
  ds_read_b128 a[180:183], v50 offset:15360
  ds_read_b128 a[184:187], v50 offset:20480
  ds_read_b128 a[188:191], v50 offset:21504
  ds_read_b128 a[192:195], v50 offset:4096
  ds_read_b128 a[196:199], v50 offset:5120
  ds_read_b128 a[200:203], v50 offset:10240
  ds_read_b128 a[204:207], v50 offset:11264
  ds_read_b128 a[208:211], v50 offset:16384
  ds_read_b128 a[212:215], v50 offset:17408
  ds_read_b128 a[216:219], v50 offset:22528
  ds_read_b128 a[220:223], v50 offset:23552
  s_mov_b32 s63, 1015808
L_safe_loop:
  s_waitcnt vmcnt(0) lgkmcnt(0)
  s_add_u32 m0, s62, 0
  s_mov_b32 s60, s63
  buffer_load_dwordx4 v14, s[40:43], s60 offen offset:0 nt lds
  buffer_load_dwordx4 v15, s[40:43], s60 offen offset:1024 nt lds
  buffer_load_dwordx4 v16, s[40:43], s60 offen offset:2048 nt lds
  buffer_load_dwordx4 v17, s[40:43], s60 offen offset:3072 nt lds
  s_add_u32 m0, s62, 4096
  s_nop 0
  buffer_load_dwordx4 v18, s[40:43], s60 offen offset:0 nt lds
  buffer_load_dwordx4 v19, s[40:43], s60 offen offset:1024 nt lds
  buffer_load_dwordx4 v20, s[40:43], s60 offen offset:2048 nt lds
  buffer_load_dwordx4 v21, s[40:43], s60 offen offset:3072 nt lds
  s_waitcnt vmcnt(0)
  ds_read_b128 a[224:227], v4 offset:0
  ds_read_b128 a[228:231], v5 offset:0
  ds_read_b128 a[232:235], v6 offset:0
  ds_read_b128 a[236:239], v7 offset:0
  ds_read_b128 a[240:243], v4 offset:256
  ds_read_b128 a[244:247], v5 offset:256
  ds_read_b128 a[248:251], v6 offset:256
  ds_read_b128 a[252:255], v7 offset:256
  s_cmp_eq_u32 s63, 0
  s_cbranch_scc1 L_safe_done
  s_waitcnt lgkmcnt(7)
  v_mfma_f32_16x16x32_bf16 v[116:119], a[224:227], a[0:3], 0
  s_waitcnt lgkmcnt(6)
  v_mfma_f32_16x16x32_bf16 v[116:119], a[228:231], a[4:7], v[116:119]
  s_waitcnt lgkmcnt(5)
  v_mfma_f32_16x16x32_bf16 v[116:119], a[232:235], a[8:11], v[116:119]
  s_waitcnt lgkmcnt(4)
  v_mfma_f32_16x16x32_bf16 v[116:119], a[236:239], a[12:15], v[116:119]
  s_waitcnt lgkmcnt(3)
  v_mfma_f32_16x16x32_bf16 v[116:119], a[240:243], a[16:19], v[116:119]
  s_waitcnt lgkmcnt(2)
  v_mfma_f32_16x16x32_bf16 v[116:119], a[244:247], a[20:23], v[116:119]
  s_waitcnt lgkmcnt(1)
  v_mfma_f32_16x16x32_bf16 v[116:119], a[248:251], a[24:27], v[116:119]
  s_waitcnt lgkmcnt(0)
  v_mfma_f32_16x16x32_bf16 v[116:119], a[252:255], a[28:31], v[116:119]
  v_mfma_f32_16x16x32_bf16 v[120:123], a[224:227], a[32:35], 0
  v_mfma_f32_16x16x32_bf16 v[120:123], a[228:231], a[36:39], v[120:123]
  v_mfma_f32_16x16x32_bf16 v[120:123], a[232:235], a[40:43], v[120:123]
  v_mfma_f32_16x16x32_bf16 v[120:123], a[236:239], a[44:47], v[120:123]
  v_mfma_f32_16x16x32_bf16 v[120:123], a[240:243], a[48:51], v[120:123]
  v_mfma_f32_16x16x32_bf16 v[120:123], a[244:247], a[52:55], v[120:123]
  v_mfma_f32_16x16x32_bf16 v[120:123], a[248:251], a[56:59], v[120:123]
  v_mfma_f32_16x16x32_bf16 v[120:123], a[252:255], a[60:63], v[120:123]
  v_mfma_f32_16x16x32_bf16 v[124:127], a[224:227], a[64:67], 0
  v_mfma_f32_16x16x32_bf16 v[124:127], a[228:231], a[68:71], v[124:127]
  v_mfma_f32_16x16x32_bf16 v[124:127], a[232:235], a[72:75], v[124:127]
  v_mfma_f32_16x16x32_bf16 v[124:127], a[236:239], a[76:79], v[124:127]
  v_mfma_f32_16x16x32_bf16 v[124:127], a[240:243], a[80:83], v[124:127]
  v_mfma_f32_16x16x32_bf16 v[124:127], a[244:247], a[84:87], v[124:127]
  v_mfma_f32_16x16x32_bf16 v[124:127], a[248:251], a[88:91], v[124:127]
  v_mfma_f32_16x16x32_bf16 v[124:127], a[252:255], a[92:95], v[124:127]
  v_mfma_f32_16x16x32_bf16 v[128:131], a[224:227], a[96:99], 0
  v_mfma_f32_16x16x32_bf16 v[128:131], a[228:231], a[100:103], v[128:131]
  v_mfma_f32_16x16x32_bf16 v[128:131], a[232:235], a[104:107], v[128:131]
  v_mfma_f32_16x16x32_bf16 v[128:131], a[236:239], a[108:111], v[128:131]
  v_mfma_f32_16x16x32_bf16 v[128:131], a[240:243], a[112:115], v[128:131]
  v_mfma_f32_16x16x32_bf16 v[128:131], a[244:247], a[116:119], v[128:131]
  v_mfma_f32_16x16x32_bf16 v[128:131], a[248:251], a[120:123], v[128:131]
  v_mfma_f32_16x16x32_bf16 v[128:131], a[252:255], a[124:127], v[128:131]
  v_mfma_f32_16x16x32_bf16 v[132:135], a[224:227], a[128:131], 0
  v_mfma_f32_16x16x32_bf16 v[132:135], a[228:231], a[132:135], v[132:135]
  v_mfma_f32_16x16x32_bf16 v[132:135], a[232:235], a[136:139], v[132:135]
  v_mfma_f32_16x16x32_bf16 v[132:135], a[236:239], a[140:143], v[132:135]
  v_mfma_f32_16x16x32_bf16 v[132:135], a[240:243], a[144:147], v[132:135]
  v_mfma_f32_16x16x32_bf16 v[132:135], a[244:247], a[148:151], v[132:135]
  v_mfma_f32_16x16x32_bf16 v[132:135], a[248:251], a[152:155], v[132:135]
  v_mfma_f32_16x16x32_bf16 v[132:135], a[252:255], a[156:159], v[132:135]
  v_mfma_f32_16x16x32_bf16 v[136:139], a[224:227], a[160:163], 0
  v_mfma_f32_16x16x32_bf16 v[136:139], a[228:231], a[164:167], v[136:139]
  v_mfma_f32_16x16x32_bf16 v[136:139], a[232:235], a[168:171], v[136:139]
  v_mfma_f32_16x16x32_bf16 v[136:139], a[236:239], a[172:175], v[136:139]
  v_mfma_f32_16x16x32_bf16 v[136:139], a[240:243], a[176:179], v[136:139]
  v_mfma_f32_16x16x32_bf16 v[136:139], a[244:247], a[180:183], v[136:139]
  v_mfma_f32_16x16x32_bf16 v[136:139], a[248:251], a[184:187], v[136:139]
  v_mfma_f32_16x16x32_bf16 v[136:139], a[252:255], a[188:191], v[136:139]
  v_mfma_f32_16x16x32_bf16 v[140:143], a[224:227], a[192:195], 0
  v_mfma_f32_16x16x32_bf16 v[140:143], a[228:231], a[196:199], v[140:143]
  v_mfma_f32_16x16x32_bf16 v[140:143], a[232:235], a[200:203], v[140:143]
  v_mfma_f32_16x16x32_bf16 v[140:143], a[236:239], a[204:207], v[140:143]
  v_mfma_f32_16x16x32_bf16 v[140:143], a[240:243], a[208:211], v[140:143]
  v_mfma_f32_16x16x32_bf16 v[140:143], a[244:247], a[212:215], v[140:143]
  v_mfma_f32_16x16x32_bf16 v[140:143], a[248:251], a[216:219], v[140:143]
  v_mfma_f32_16x16x32_bf16 v[140:143], a[252:255], a[220:223], v[140:143]
  s_nop 7
  v_max3_f32 v40, v40, v116, v117
  v_max3_f32 v40, v40, v118, v119
  v_max3_f32 v41, v41, v120, v121
  v_max3_f32 v41, v41, v122, v123
  v_max3_f32 v42, v42, v124, v125
  v_max3_f32 v42, v42, v126, v127
  v_max3_f32 v43, v43, v128, v129
  v_max3_f32 v43, v43, v130, v131
  v_max3_f32 v44, v44, v132, v133
  v_max3_f32 v44, v44, v134, v135
  v_max3_f32 v45, v45, v136, v137
  v_max3_f32 v45, v45, v138, v139
  v_max3_f32 v46, v46, v140, v141
  v_max3_f32 v46, v46, v142, v143
  s_sub_u32 s63, s63, 32768
  s_branch L_safe_loop
L_safe_done:
  s_waitcnt vmcnt(0) lgkmcnt(0)
  s_branch L_safe_ret0
L_exit:
  s_endpgm
.section .rodata,"a"
.p2align 6
.amdhsa_kernel concat_heads__gqa_block_cached__mha_block_cached__near_ridge_kernel
  .amdhsa_next_free_vgpr 512
  .amdhsa_next_free_sgpr 102
  .amdhsa_accum_offset 256
  .amdhsa_group_segment_fixed_size 0
  .amdhsa_kernarg_size 104
  .amdhsa_user_sgpr_count 2
  .amdhsa_user_sgpr_kernarg_segment_ptr 1
  .amdhsa_system_sgpr_workgroup_id_x 1
  .amdhsa_float_denorm_mode_32 3
.end_amdhsa_kernel
```
